```python
import torch

def _softmax(x, axis=-1):
    return torch.softmax(x, dim=axis)
def _gelu(x):
    return torch.nn.functional.gelu(x, approximate="tanh")
def _silu(x):
    return torch.nn.functional.silu(x)
def _sigmoid(x):
    return torch.sigmoid(x)
def _layernorm(x, axis=-1, eps=1e-5):
    m = x.mean(dim=axis, keepdim=True)
    v = x.var(dim=axis, keepdim=True, unbiased=False)
    return (x - m) / torch.sqrt(v + eps)
def _scatter_add(tgt, idx, src, axis=0):
    return tgt.clone().index_add_(axis, idx, src)
def _segment_sum(src, seg, n):
    out = torch.zeros((n,) + src.shape[1:], dtype=src.dtype)
    return out.index_add_(0, seg, src)
def _pad(x, pw):
    flat = tuple(v for pair in reversed(pw) for v in pair)
    return torch.nn.functional.pad(x, flat)

kernel_name = 'parallel_sum__sliding_block__dense_activation_gelu__prompt'

def setup_inputs():

    _w = (lambda a: (lambda t: t.to(torch.bfloat16) if t.is_floating_point() else t)(torch.as_tensor(a)))
    def _A_setup():
        B, S, D = 1, 2048, 512
        return {
            "x": _w((lambda *s: torch.randn(*s, dtype=torch.bfloat16) * 0.05)(B, S, D)),
            "wqkv": _w((lambda *s: torch.randn(*s, dtype=torch.bfloat16) * 0.05)(D, 3 * D)),
            "wo": _w((lambda *s: torch.randn(*s, dtype=torch.bfloat16) * 0.05)(D, D)),
        }
    _A_in = _A_setup()

    def _B_setup():
        B, S, D, F = 1, 2048, 512, 1792
        return {
            "x": _w((lambda *s: torch.randn(*s, dtype=torch.bfloat16) * 0.05)(B, S, D)),
            "w1": _w((lambda *s: torch.randn(*s, dtype=torch.bfloat16) * 0.8)(D, F) * (D ** -0.5)),
            "b1": _w((lambda *s: torch.randn(*s, dtype=torch.bfloat16) * 0.8)(F) * 0.01),
            "w2": _w((lambda *s: torch.randn(*s, dtype=torch.bfloat16) * 0.8)(F, D) * (F ** -0.5)),
            "b2": _w((lambda *s: torch.randn(*s, dtype=torch.bfloat16) * 0.8)(D) * 0.01),
        }
    _B_in = _B_setup()

    return {
        "A_x": _A_in["x"],
        "A_wqkv": _A_in["wqkv"],
        "A_wo": _A_in["wo"],
        "B_x": _B_in["x"],
        "B_w1": _B_in["w1"],
        "B_b1": _B_in["b1"],
        "B_w2": _B_in["w2"],
        "B_b2": _B_in["b2"],
    }

def reference(A_x, A_wqkv, A_wo, B_x, B_w1, B_b1, B_w2, B_b2):
    def _A_ref(x, wqkv, wo):
        B, S, D = x.shape
        H = 32; Dh = D // H; W = 256
        qkv = (lambda x, *d: x.permute(*d))((x @ wqkv).reshape(B, S, 3, H, Dh), 2, 0, 3, 1, 4)
        q, k, v = qkv[0], qkv[1], qkv[2]
        scores = torch.einsum("bhqd,bhkd->bhqk", q, k) * (Dh ** -0.5)
        idx = torch.arange(S)
        mask = (idx[:, None] - idx[None, :] >= 0) & (idx[:, None] - idx[None, :] < W)
        scores = torch.where(mask[None, None], scores, -1e9)
        p = _softmax(scores, axis=-1)
        o = torch.einsum("bhqk,bhkd->bhqd", p, v)
        return (lambda x, *d: x.permute(*d))(o, 0, 2, 1, 3).reshape(B, S, D) @ wo

    def _B_ref(x, w1, b1, w2, b2):
        h = torch.einsum("bsd,df->bsf", x, w1) + b1
        h = _gelu(h)
        return torch.einsum("bsf,fd->bsd", h, w2) + b2

    x = A_x
    xn = _layernorm(x, axis=-1)
    return x + _A_ref(xn, A_wqkv, A_wo) + _B_ref(xn, B_w1, B_b1, B_w2, B_b2)
```

```asm
; @launch grid=(256,1,1) block=(512,1,1) lds=163840
.amdgcn_target "amdgcn-amd-amdhsa--gfx950"
.text
.globl parallel_sum__sliding_block__dense_activation_gelu__prompt_kernel
.p2align 8
.type parallel_sum__sliding_block__dense_activation_gelu__prompt_kernel,@function
parallel_sum__sliding_block__dense_activation_gelu__prompt_kernel:
    s_load_dwordx8 s[68:75], s[0:1], 0
    s_load_dwordx8 s[76:83], s[0:1], 32
    s_load_dwordx4 s[84:87], s[0:1], 64
    s_load_dwordx2 s[88:89], s[0:1], 80
    s_cmp_ge_u32 s2, 256
    s_cbranch_scc1 L_end
    s_getpc_b64 s[96:97]
L_pc:
    s_sub_u32 s96, s96, L_pc-parallel_sum__sliding_block__dense_activation_gelu__prompt_kernel
    s_subb_u32 s97, s97, 0
    s_and_b32 s97, s97, 0xffff
    s_mov_b32 s98, L_code_end-parallel_sum__sliding_block__dense_activation_gelu__prompt_kernel
    s_mov_b32 s99, 0x20000
    v_lshrrev_b32 v9, 2, v0
    v_lshlrev_b32 v9, 7, v9
    s_bfe_u32 s11, s2, 0x20003
    s_lshl_b32 s11, s11, 14
    buffer_load_dword v255, v9, s[96:99], s11 offen
    v_lshrrev_b32 v10, 6, v0
    v_lshrrev_b32 v11, 3, v0
    v_lshlrev_b32 v11, 7, v11
    v_and_b32 v0, 63, v0
    v_mov_b32 v12, 0
    v_lshlrev_b32 v5, 2, v0
    v_add_u32 v5, 148992, v5
    ds_write_b32 v5, v12
    s_and_b32 s11, s2, 7
    s_lshr_b32 s12, s2, 3
    v_readfirstlane_b32 s7, v10
    s_and_b32 s13, s11, 1
    s_lshl_b32 s13, s13, 3
    s_and_b32 s14, s12, 7
    s_add_u32 s4, s13, s14
    s_lshr_b32 s13, s11, 1
    s_lshr_b32 s14, s12, 3
    s_lshr_b32 s6, s14, 1
    s_and_b32 s14, s14, 1
    s_lshl_b32 s13, s13, 1
    s_add_u32 s5, s13, s14
    v_lshlrev_b32 v1, 4, v0
    s_waitcnt lgkmcnt(0)
    s_barrier
    s_mov_b32 s28, s68
    s_and_b32 s29, s69, 0xffff
    s_mov_b32 s30, 2097152
    s_mov_b32 s31, 0x20000
    s_lshl_b32 s11, s6, 3
    s_add_u32 s11, s11, s5
    s_lshl_b32 s11, s11, 13
    s_lshl_b32 s12, s4, 17
    s_add_u32 s11, s11, s12
    buffer_load_dword v255, v11, s[28:31], s11 offen
    s_mov_b32 s32, s88
    s_and_b32 s33, s89, 0xffff
    s_mov_b32 s34, 16777216
    s_mov_b32 s35, 0x20000
    s_mov_b32 s36, s86
    s_and_b32 s37, s87, 0xffff
    s_mov_b32 s38, 256
    s_mov_b32 s39, 0x20000
    s_cmp_ge_u32 s7, 4
    s_cbranch_scc1 L_loader
    v_lshrrev_b32 v10, 4, v0
    v_and_b32 v11, 15, v0
    v_add_u32 v12, 0, v10
    v_xor_b32 v12, v12, v11
    v_lshlrev_b32 v12, 4, v12
    v_lshl_add_u32 v12, v10, 10, v12
    v_add_u32 v13, 4, v10
    v_xor_b32 v13, v13, v11
    v_lshlrev_b32 v13, 4, v13
    v_lshl_add_u32 v13, v10, 10, v13
    v_add_u32 v14, 8, v10
    v_xor_b32 v14, v14, v11
    v_lshlrev_b32 v14, 4, v14
    v_lshl_add_u32 v14, v10, 10, v14
    v_add_u32 v15, 12, v10
    v_xor_b32 v15, v15, v11
    v_lshlrev_b32 v15, 4, v15
    v_lshl_add_u32 v15, v10, 10, v15
    s_lshl_b32 s15, s7, 15
    s_lshl_b32 s16, s4, 17
    s_add_u32 s16, s16, s15
    s_lshl_b32 s15, s7, 13
    s_add_u32 s15, s15, 16384
    s_add_u32 m0, s15, 0
    s_add_u32 s11, s16, 0
    buffer_load_dwordx4 v12, s[28:31], s11 offen lds
    s_add_u32 m0, s15, 1024
    s_add_u32 s11, s16, 4096
    buffer_load_dwordx4 v13, s[28:31], s11 offen lds
    s_add_u32 m0, s15, 2048
    s_add_u32 s11, s16, 8192
    buffer_load_dwordx4 v14, s[28:31], s11 offen lds
    s_add_u32 m0, s15, 3072
    s_add_u32 s11, s16, 12288
    buffer_load_dwordx4 v15, s[28:31], s11 offen lds
    s_add_u32 m0, s15, 4096
    s_add_u32 s11, s16, 16384
    buffer_load_dwordx4 v12, s[28:31], s11 offen lds
    s_add_u32 m0, s15, 5120
    s_add_u32 s11, s16, 20480
    buffer_load_dwordx4 v13, s[28:31], s11 offen lds
    s_add_u32 m0, s15, 6144
    s_add_u32 s11, s16, 24576
    buffer_load_dwordx4 v14, s[28:31], s11 offen lds
    s_add_u32 m0, s15, 7168
    s_add_u32 s11, s16, 28672
    buffer_load_dwordx4 v15, s[28:31], s11 offen lds
    s_add_u32 m0, s15, 32768
    s_add_u32 s11, s16, 256
    buffer_load_dwordx4 v12, s[28:31], s11 offen lds
    s_add_u32 m0, s15, 33792
    s_add_u32 s11, s16, 4352
    buffer_load_dwordx4 v13, s[28:31], s11 offen lds
    s_add_u32 m0, s15, 34816
    s_add_u32 s11, s16, 8448
    buffer_load_dwordx4 v14, s[28:31], s11 offen lds
    s_add_u32 m0, s15, 35840
    s_add_u32 s11, s16, 12544
    buffer_load_dwordx4 v15, s[28:31], s11 offen lds
    s_add_u32 m0, s15, 36864
    s_add_u32 s11, s16, 16640
    buffer_load_dwordx4 v12, s[28:31], s11 offen lds
    s_add_u32 m0, s15, 37888
    s_add_u32 s11, s16, 20736
    buffer_load_dwordx4 v13, s[28:31], s11 offen lds
    s_add_u32 m0, s15, 38912
    s_add_u32 s11, s16, 24832
    buffer_load_dwordx4 v14, s[28:31], s11 offen lds
    s_add_u32 m0, s15, 39936
    s_add_u32 s11, s16, 28928
    buffer_load_dwordx4 v15, s[28:31], s11 offen lds
    s_add_u32 m0, s15, 65536
    s_add_u32 s11, s16, 512
    buffer_load_dwordx4 v12, s[28:31], s11 offen lds
    s_add_u32 m0, s15, 66560
    s_add_u32 s11, s16, 4608
    buffer_load_dwordx4 v13, s[28:31], s11 offen lds
    s_add_u32 m0, s15, 67584
    s_add_u32 s11, s16, 8704
    buffer_load_dwordx4 v14, s[28:31], s11 offen lds
    s_add_u32 m0, s15, 68608
    s_add_u32 s11, s16, 12800
    buffer_load_dwordx4 v15, s[28:31], s11 offen lds
    s_add_u32 m0, s15, 69632
    s_add_u32 s11, s16, 16896
    buffer_load_dwordx4 v12, s[28:31], s11 offen lds
    s_add_u32 m0, s15, 70656
    s_add_u32 s11, s16, 20992
    buffer_load_dwordx4 v13, s[28:31], s11 offen lds
    s_add_u32 m0, s15, 71680
    s_add_u32 s11, s16, 25088
    buffer_load_dwordx4 v14, s[28:31], s11 offen lds
    s_add_u32 m0, s15, 72704
    s_add_u32 s11, s16, 29184
    buffer_load_dwordx4 v15, s[28:31], s11 offen lds
    s_add_u32 m0, s15, 98304
    s_add_u32 s11, s16, 768
    buffer_load_dwordx4 v12, s[28:31], s11 offen lds
    s_add_u32 m0, s15, 99328
    s_add_u32 s11, s16, 4864
    buffer_load_dwordx4 v13, s[28:31], s11 offen lds
    s_add_u32 m0, s15, 100352
    s_add_u32 s11, s16, 8960
    buffer_load_dwordx4 v14, s[28:31], s11 offen lds
    s_add_u32 m0, s15, 101376
    s_add_u32 s11, s16, 13056
    buffer_load_dwordx4 v15, s[28:31], s11 offen lds
    s_add_u32 m0, s15, 102400
    s_add_u32 s11, s16, 17152
    buffer_load_dwordx4 v12, s[28:31], s11 offen lds
    s_add_u32 m0, s15, 103424
    s_add_u32 s11, s16, 21248
    buffer_load_dwordx4 v13, s[28:31], s11 offen lds
    s_add_u32 m0, s15, 104448
    s_add_u32 s11, s16, 25344
    buffer_load_dwordx4 v14, s[28:31], s11 offen lds
    s_add_u32 m0, s15, 105472
    s_add_u32 s11, s16, 29440
    buffer_load_dwordx4 v15, s[28:31], s11 offen lds
    s_setprio 2
    v_and_b32 v10, 31, v0
    v_lshrrev_b32 v11, 5, v0
    s_and_b32 s9, s2, 7
    s_lshr_b32 s8, s2, 3
    s_lshl_b32 s40, s9, 2
    s_add_u32 s40, s40, s7
    s_lshl_b32 s12, s8, 1
    s_sub_u32 s41, s12, 8
    s_lshl_b32 s42, s40, 16
    s_lshl_b32 s43, s12, 10
    s_add_u32 s43, s43, s42
    s_add_u32 s42, s42, 2097152
    s_lshr_b32 s44, s40, 1
    s_lshl_b32 s44, s44, 17
    s_add_u32 s44, s44, 4194304
    s_mul_i32 s45, s12, 147456
    s_lshl_b32 s11, s40, 10
    s_add_u32 s45, s45, s11
    s_add_u32 s45, s45, 6406144
    s_lshl_b32 s46, s8, 5
    s_add_u32 s46, s46, s40
    s_lshl_b32 s46, s46, 2
    s_add_u32 s46, s46, 15732736
    v_lshlrev_b32 v234, 9, v11
    s_lshl_b32 s11, s41, 10
    v_add_u32 v233, s11, v1
    s_and_b32 s12, s40, 1
    s_lshl_b32 s12, s12, 8
    s_lshl_b32 s11, s41, 11
    s_add_u32 s11, s11, s12
    v_add_u32 v235, s11, v1
    v_mov_b32 v232, 1
    v_min_u32 v12, 19, v0
    v_lshrrev_b32 v13, 1, v12
    v_add_u32 v13, s41, v13
    v_max_i32 v13, 0, v13
    v_and_b32 v12, 1, v12
    v_lshl_add_u32 v12, v13, 1, v12
    s_lshl_b32 s11, s9, 9
    s_add_u32 s11, s11, 15728640
    v_lshlrev_b32 v12, 2, v12
    v_add_u32 v236, s11, v12
    v_and_b32 v10, 31, v0
    v_lshrrev_b32 v11, 5, v0
    v_and_b32 v12, 15, v0
    v_xor_b32 v12, v12, v11
    v_lshlrev_b32 v12, 4, v12
    v_lshl_add_u32 v12, v10, 8, v12
    v_add_u32 v12, s15, v12
    v_xor_b32 v200, 0, v12
    v_add_u32 v208, 0x10000, v200
    v_xor_b32 v201, 32, v12
    v_add_u32 v209, 0x10000, v201
    v_xor_b32 v202, 64, v12
    v_add_u32 v210, 0x10000, v202
    v_xor_b32 v203, 96, v12
    v_add_u32 v211, 0x10000, v203
    v_xor_b32 v204, 128, v12
    v_add_u32 v212, 0x10000, v204
    v_xor_b32 v205, 160, v12
    v_add_u32 v213, 0x10000, v205
    v_xor_b32 v206, 192, v12
    v_add_u32 v214, 0x10000, v206
    v_xor_b32 v207, 224, v12
    v_add_u32 v215, 0x10000, v207
    v_and_b32 v13, 15, v0
    v_lshrrev_b32 v14, 2, v13
    v_and_b32 v15, 3, v0
    v_lshlrev_b32 v15, 3, v15
    v_bfe_u32 v10, v0, 4, 1
    v_lshl_add_u32 v15, v10, 5, v15
    v_lshl_add_u32 v2, v11, 10, v15
    v_lshl_add_u32 v2, v14, 7, v2
    v_bfe_u32 v10, v0, 3, 1
    v_lshl_add_u32 v2, v10, 6, v2
    v_xor_b32 v3, 64, v2
    v_lshl_add_u32 v4, v11, 9, v15
    v_lshl_add_u32 v4, v14, 6, v4
    v_lshlrev_b32 v8, 4, v11
    v_mov_b32 v9, 0xbdd2d3e8
    v_mov_b32 v216, 0
    v_mov_b32 v217, 0
    v_mov_b32 v218, 0
    v_mov_b32 v219, 0
    v_mov_b32 v220, 0
    v_mov_b32 v221, 0
    v_mov_b32 v222, 0
    v_mov_b32 v223, 0
    v_mov_b32 v224, 0x3f803f80
    v_mov_b32 v225, 0x00003f80
    v_mov_b32 v226, 0x3f800000
    v_add_u32 v8, 0x20000, v8
    s_lshl_b32 s17, s4, 2
    s_add_u32 s17, s17, s7
    s_cmp_eq_u32 s6, 1
    s_cbranch_scc1 L_cs_1
    s_lshl_b32 s18, s5, 18
    s_lshl_b32 s11, s17, 10
    s_add_u32 s18, s18, s11
    s_add_u32 s19, s18, 2097152
    s_mul_i32 s20, s17, 147456
    s_add_u32 s20, s20, 6291456
    s_lshl_b32 s11, s5, 11
    s_add_u32 s21, s20, s11
    s_add_u32 s21, s21, 98304
    s_lshl_b32 s11, s5, 12
    s_add_u32 s20, s20, s11
    s_lshl_b32 s22, s5, 6
    s_add_u32 s22, s22, s17
    s_lshl_b32 s22, s22, 3
    s_add_u32 s22, s22, 15728640
    s_lshr_b32 s23, s17, 1
    s_lshl_b32 s23, s23, 2
    s_lshr_b32 s11, s5, 1
    s_add_u32 s23, s23, s11
    s_lshl_b32 s23, s23, 7
    s_and_b32 s11, s17, 1
    s_lshl_b32 s11, s11, 6
    s_add_u32 s23, s23, s11
    s_and_b32 s11, s5, 1
    s_lshl_b32 s11, s11, 4
    s_add_u32 s23, s23, s11
    s_add_u32 s23, s23, 15736832
    s_branch L_csj_2
L_cs_1:
    s_lshl_b32 s18, s5, 18
    s_lshl_b32 s11, s17, 11
    s_add_u32 s18, s18, s11
    s_add_u32 s18, s18, 4194304
    s_mul_i32 s20, s17, 147456
    s_add_u32 s20, s20, 6324224
    s_lshl_b32 s11, s5, 13
    s_add_u32 s20, s20, s11
    s_add_u32 s21, s20, 4096
    s_lshl_b32 s22, s5, 6
    s_add_u32 s22, s22, s17
    s_lshl_b32 s22, s22, 3
    s_add_u32 s22, s22, 15728644
    s_lshr_b32 s23, s17, 1
    s_lshl_b32 s23, s23, 2
    s_lshr_b32 s11, s5, 1
    s_add_u32 s23, s23, s11
    s_lshl_b32 s23, s23, 7
    s_and_b32 s11, s17, 1
    s_lshl_b32 s11, s11, 6
    s_add_u32 s23, s23, s11
    s_and_b32 s11, s5, 1
    s_lshl_b32 s11, s11, 4
    s_add_u32 s23, s23, s11
    s_add_u32 s23, s23, 15736864
L_csj_2:
    s_waitcnt vmcnt(24)
    ds_read_b128 v[16:19], v200 offset:0
    ds_read_b128 v[20:23], v201 offset:0
    ds_read_b128 v[24:27], v202 offset:0
    ds_read_b128 v[28:31], v203 offset:0
    ds_read_b128 v[32:35], v204 offset:0
    ds_read_b128 v[36:39], v205 offset:0
    ds_read_b128 v[40:43], v206 offset:0
    ds_read_b128 v[44:47], v207 offset:0
    s_waitcnt lgkmcnt(0)
    s_mov_b64 exec, 1
    ds_add_u32 v8, v232 offset:18080
    s_mov_b64 exec, -1
    s_waitcnt vmcnt(16)
    ds_read_b128 v[48:51], v200 offset:32768
    ds_read_b128 v[52:55], v201 offset:32768
    ds_read_b128 v[56:59], v202 offset:32768
    ds_read_b128 v[60:63], v203 offset:32768
    ds_read_b128 v[64:67], v204 offset:32768
    ds_read_b128 v[68:71], v205 offset:32768
    ds_read_b128 v[72:75], v206 offset:32768
    ds_read_b128 v[76:79], v207 offset:32768
    v_dot2c_f32_bf16 v216, v16, v224
    v_dot2c_f32_bf16 v217, v17, v224
    v_dot2c_f32_bf16 v218, v18, v224
    v_dot2c_f32_bf16 v219, v19, v224
    v_dot2c_f32_bf16 v216, v20, v224
    v_dot2c_f32_bf16 v217, v21, v224
    v_dot2c_f32_bf16 v218, v22, v224
    v_dot2c_f32_bf16 v219, v23, v224
    v_dot2c_f32_bf16 v216, v24, v224
    v_dot2c_f32_bf16 v217, v25, v224
    v_dot2c_f32_bf16 v218, v26, v224
    v_dot2c_f32_bf16 v219, v27, v224
    v_dot2c_f32_bf16 v216, v28, v224
    v_dot2c_f32_bf16 v217, v29, v224
    v_dot2c_f32_bf16 v218, v30, v224
    v_dot2c_f32_bf16 v219, v31, v224
    v_dot2c_f32_bf16 v216, v32, v224
    v_dot2c_f32_bf16 v217, v33, v224
    v_dot2c_f32_bf16 v218, v34, v224
    v_dot2c_f32_bf16 v219, v35, v224
    v_dot2c_f32_bf16 v216, v36, v224
    v_dot2c_f32_bf16 v217, v37, v224
    v_dot2c_f32_bf16 v218, v38, v224
    v_dot2c_f32_bf16 v219, v39, v224
    v_dot2c_f32_bf16 v216, v40, v224
    v_dot2c_f32_bf16 v217, v41, v224
    v_dot2c_f32_bf16 v218, v42, v224
    v_dot2c_f32_bf16 v219, v43, v224
    v_dot2c_f32_bf16 v216, v44, v224
    v_dot2c_f32_bf16 v217, v45, v224
    v_dot2c_f32_bf16 v218, v46, v224
    v_dot2c_f32_bf16 v219, v47, v224
    s_waitcnt lgkmcnt(0)
    s_mov_b64 exec, 1
    ds_add_u32 v8, v232 offset:18084
    s_mov_b64 exec, -1
    s_waitcnt vmcnt(8)
    ds_read_b128 v[80:83], v208 offset:0
    ds_read_b128 v[84:87], v209 offset:0
    ds_read_b128 v[88:91], v210 offset:0
    ds_read_b128 v[92:95], v211 offset:0
    ds_read_b128 v[96:99], v212 offset:0
    ds_read_b128 v[100:103], v213 offset:0
    ds_read_b128 v[104:107], v214 offset:0
    ds_read_b128 v[108:111], v215 offset:0
    v_dot2c_f32_bf16 v216, v48, v224
    v_dot2c_f32_bf16 v217, v49, v224
    v_dot2c_f32_bf16 v218, v50, v224
    v_dot2c_f32_bf16 v219, v51, v224
    v_dot2c_f32_bf16 v216, v52, v224
    v_dot2c_f32_bf16 v217, v53, v224
    v_dot2c_f32_bf16 v218, v54, v224
    v_dot2c_f32_bf16 v219, v55, v224
    v_dot2c_f32_bf16 v216, v56, v224
    v_dot2c_f32_bf16 v217, v57, v224
    v_dot2c_f32_bf16 v218, v58, v224
    v_dot2c_f32_bf16 v219, v59, v224
    v_dot2c_f32_bf16 v216, v60, v224
    v_dot2c_f32_bf16 v217, v61, v224
    v_dot2c_f32_bf16 v218, v62, v224
    v_dot2c_f32_bf16 v219, v63, v224
    v_dot2c_f32_bf16 v216, v64, v224
    v_dot2c_f32_bf16 v217, v65, v224
    v_dot2c_f32_bf16 v218, v66, v224
    v_dot2c_f32_bf16 v219, v67, v224
    v_dot2c_f32_bf16 v216, v68, v224
    v_dot2c_f32_bf16 v217, v69, v224
    v_dot2c_f32_bf16 v218, v70, v224
    v_dot2c_f32_bf16 v219, v71, v224
    v_dot2c_f32_bf16 v216, v72, v224
    v_dot2c_f32_bf16 v217, v73, v224
    v_dot2c_f32_bf16 v218, v74, v224
    v_dot2c_f32_bf16 v219, v75, v224
    v_dot2c_f32_bf16 v216, v76, v224
    v_dot2c_f32_bf16 v217, v77, v224
    v_dot2c_f32_bf16 v218, v78, v224
    v_dot2c_f32_bf16 v219, v79, v224
    s_waitcnt lgkmcnt(0)
    s_mov_b64 exec, 1
    ds_add_u32 v8, v232 offset:18088
    s_mov_b64 exec, -1
    s_waitcnt vmcnt(0)
    ds_read_b128 v[112:115], v208 offset:32768
    ds_read_b128 v[116:119], v209 offset:32768
    ds_read_b128 v[120:123], v210 offset:32768
    ds_read_b128 v[124:127], v211 offset:32768
    ds_read_b128 v[128:131], v212 offset:32768
    ds_read_b128 v[132:135], v213 offset:32768
    ds_read_b128 v[136:139], v214 offset:32768
    ds_read_b128 v[140:143], v215 offset:32768
    v_dot2c_f32_bf16 v216, v80, v224
    v_dot2c_f32_bf16 v217, v81, v224
    v_dot2c_f32_bf16 v218, v82, v224
    v_dot2c_f32_bf16 v219, v83, v224
    v_dot2c_f32_bf16 v216, v84, v224
    v_dot2c_f32_bf16 v217, v85, v224
    v_dot2c_f32_bf16 v218, v86, v224
    v_dot2c_f32_bf16 v219, v87, v224
    v_dot2c_f32_bf16 v216, v88, v224
    v_dot2c_f32_bf16 v217, v89, v224
    v_dot2c_f32_bf16 v218, v90, v224
    v_dot2c_f32_bf16 v219, v91, v224
    v_dot2c_f32_bf16 v216, v92, v224
    v_dot2c_f32_bf16 v217, v93, v224
    v_dot2c_f32_bf16 v218, v94, v224
    v_dot2c_f32_bf16 v219, v95, v224
    v_dot2c_f32_bf16 v216, v96, v224
    v_dot2c_f32_bf16 v217, v97, v224
    v_dot2c_f32_bf16 v218, v98, v224
    v_dot2c_f32_bf16 v219, v99, v224
    v_dot2c_f32_bf16 v216, v100, v224
    v_dot2c_f32_bf16 v217, v101, v224
    v_dot2c_f32_bf16 v218, v102, v224
    v_dot2c_f32_bf16 v219, v103, v224
    v_dot2c_f32_bf16 v216, v104, v224
    v_dot2c_f32_bf16 v217, v105, v224
    v_dot2c_f32_bf16 v218, v106, v224
    v_dot2c_f32_bf16 v219, v107, v224
    v_dot2c_f32_bf16 v216, v108, v224
    v_dot2c_f32_bf16 v217, v109, v224
    v_dot2c_f32_bf16 v218, v110, v224
    v_dot2c_f32_bf16 v219, v111, v224
    s_waitcnt lgkmcnt(0)
    s_mov_b64 exec, 1
    ds_add_u32 v8, v232 offset:18092
    s_mov_b64 exec, -1
    v_dot2c_f32_bf16 v216, v112, v224
    v_dot2c_f32_bf16 v217, v113, v224
    v_dot2c_f32_bf16 v218, v114, v224
    v_dot2c_f32_bf16 v219, v115, v224
    v_dot2c_f32_bf16 v216, v116, v224
    v_dot2c_f32_bf16 v217, v117, v224
    v_dot2c_f32_bf16 v218, v118, v224
    v_dot2c_f32_bf16 v219, v119, v224
    v_dot2c_f32_bf16 v216, v120, v224
    v_dot2c_f32_bf16 v217, v121, v224
    v_dot2c_f32_bf16 v218, v122, v224
    v_dot2c_f32_bf16 v219, v123, v224
    v_dot2c_f32_bf16 v216, v124, v224
    v_dot2c_f32_bf16 v217, v125, v224
    v_dot2c_f32_bf16 v218, v126, v224
    v_dot2c_f32_bf16 v219, v127, v224
    v_dot2c_f32_bf16 v216, v128, v224
    v_dot2c_f32_bf16 v217, v129, v224
    v_dot2c_f32_bf16 v218, v130, v224
    v_dot2c_f32_bf16 v219, v131, v224
    v_dot2c_f32_bf16 v216, v132, v224
    v_dot2c_f32_bf16 v217, v133, v224
    v_dot2c_f32_bf16 v218, v134, v224
    v_dot2c_f32_bf16 v219, v135, v224
    v_dot2c_f32_bf16 v216, v136, v224
    v_dot2c_f32_bf16 v217, v137, v224
    v_dot2c_f32_bf16 v218, v138, v224
    v_dot2c_f32_bf16 v219, v139, v224
    v_dot2c_f32_bf16 v216, v140, v224
    v_dot2c_f32_bf16 v217, v141, v224
    v_dot2c_f32_bf16 v218, v142, v224
    v_dot2c_f32_bf16 v219, v143, v224
    s_nop 0
    v_add_f32 v216, v216, v217
    s_nop 0
    v_add_f32 v218, v218, v219
    v_add_f32 v220, v220, v221
    v_add_f32 v222, v222, v223
    v_add_f32 v10, v216, v218
    v_add_f32 v12, v220, v222
    v_mov_b32 v11, v10
    v_mov_b32 v13, v12
    s_nop 0
    v_permlane32_swap_b32 v10, v11
    v_permlane32_swap_b32 v12, v13
    v_add_f32 v10, v10, v11
    v_add_f32 v12, v12, v13
    v_mul_f32 v10, 0xbb000000, v10
    v_dot2_f32_bf16 v200, v16, v225, v10
    v_dot2_f32_bf16 v201, v16, v226, v10
    v_dot2_f32_bf16 v202, v17, v225, v10
    v_dot2_f32_bf16 v203, v17, v226, v10
    v_dot2_f32_bf16 v204, v18, v225, v10
    v_dot2_f32_bf16 v205, v18, v226, v10
    v_dot2_f32_bf16 v206, v19, v225, v10
    v_dot2_f32_bf16 v207, v19, v226, v10
    v_dot2_f32_bf16 v208, v20, v225, v10
    v_dot2_f32_bf16 v209, v20, v226, v10
    v_dot2_f32_bf16 v210, v21, v225, v10
    v_dot2_f32_bf16 v211, v21, v226, v10
    v_dot2_f32_bf16 v212, v22, v225, v10
    v_dot2_f32_bf16 v213, v22, v226, v10
    v_dot2_f32_bf16 v214, v23, v225, v10
    v_dot2_f32_bf16 v215, v23, v226, v10
    v_cvt_pk_bf16_f32 v16, v200, v201
    v_cvt_pk_bf16_f32 v17, v202, v203
    v_cvt_pk_bf16_f32 v18, v204, v205
    v_cvt_pk_bf16_f32 v19, v206, v207
    v_dot2_f32_bf16 v200, v24, v225, v10
    v_dot2_f32_bf16 v201, v24, v226, v10
    v_dot2_f32_bf16 v202, v25, v225, v10
    v_dot2_f32_bf16 v203, v25, v226, v10
    v_dot2_f32_bf16 v204, v26, v225, v10
    v_dot2_f32_bf16 v205, v26, v226, v10
    v_dot2_f32_bf16 v206, v27, v225, v10
    v_dot2_f32_bf16 v207, v27, v226, v10
    v_cvt_pk_bf16_f32 v20, v208, v209
    v_cvt_pk_bf16_f32 v21, v210, v211
    v_cvt_pk_bf16_f32 v22, v212, v213
    v_cvt_pk_bf16_f32 v23, v214, v215
    v_dot2c_f32_bf16 v220, v16, v16
    v_dot2c_f32_bf16 v221, v17, v17
    v_dot2c_f32_bf16 v222, v18, v18
    v_dot2c_f32_bf16 v223, v19, v19
    v_dot2_f32_bf16 v208, v28, v225, v10
    v_dot2_f32_bf16 v209, v28, v226, v10
    v_dot2_f32_bf16 v210, v29, v225, v10
    v_dot2_f32_bf16 v211, v29, v226, v10
    v_dot2_f32_bf16 v212, v30, v225, v10
    v_dot2_f32_bf16 v213, v30, v226, v10
    v_dot2_f32_bf16 v214, v31, v225, v10
    v_dot2_f32_bf16 v215, v31, v226, v10
    v_cvt_pk_bf16_f32 v24, v200, v201
    v_cvt_pk_bf16_f32 v25, v202, v203
    v_cvt_pk_bf16_f32 v26, v204, v205
    v_cvt_pk_bf16_f32 v27, v206, v207
    v_dot2c_f32_bf16 v220, v20, v20
    v_dot2c_f32_bf16 v221, v21, v21
    v_dot2c_f32_bf16 v222, v22, v22
    v_dot2c_f32_bf16 v223, v23, v23
    v_dot2_f32_bf16 v200, v32, v225, v10
    v_dot2_f32_bf16 v201, v32, v226, v10
    v_dot2_f32_bf16 v202, v33, v225, v10
    v_dot2_f32_bf16 v203, v33, v226, v10
    v_dot2_f32_bf16 v204, v34, v225, v10
    v_dot2_f32_bf16 v205, v34, v226, v10
    v_dot2_f32_bf16 v206, v35, v225, v10
    v_dot2_f32_bf16 v207, v35, v226, v10
    v_cvt_pk_bf16_f32 v28, v208, v209
    v_cvt_pk_bf16_f32 v29, v210, v211
    v_cvt_pk_bf16_f32 v30, v212, v213
    v_cvt_pk_bf16_f32 v31, v214, v215
    v_dot2c_f32_bf16 v220, v24, v24
    v_dot2c_f32_bf16 v221, v25, v25
    v_dot2c_f32_bf16 v222, v26, v26
    v_dot2c_f32_bf16 v223, v27, v27
    v_dot2_f32_bf16 v208, v36, v225, v10
    v_dot2_f32_bf16 v209, v36, v226, v10
    v_dot2_f32_bf16 v210, v37, v225, v10
    v_dot2_f32_bf16 v211, v37, v226, v10
    v_dot2_f32_bf16 v212, v38, v225, v10
    v_dot2_f32_bf16 v213, v38, v226, v10
    v_dot2_f32_bf16 v214, v39, v225, v10
    v_dot2_f32_bf16 v215, v39, v226, v10
    v_cvt_pk_bf16_f32 v32, v200, v201
    v_cvt_pk_bf16_f32 v33, v202, v203
    v_cvt_pk_bf16_f32 v34, v204, v205
    v_cvt_pk_bf16_f32 v35, v206, v207
    v_dot2c_f32_bf16 v220, v28, v28
    v_dot2c_f32_bf16 v221, v29, v29
    v_dot2c_f32_bf16 v222, v30, v30
    v_dot2c_f32_bf16 v223, v31, v31
    v_dot2_f32_bf16 v200, v40, v225, v10
    v_dot2_f32_bf16 v201, v40, v226, v10
    v_dot2_f32_bf16 v202, v41, v225, v10
    v_dot2_f32_bf16 v203, v41, v226, v10
    v_dot2_f32_bf16 v204, v42, v225, v10
    v_dot2_f32_bf16 v205, v42, v226, v10
    v_dot2_f32_bf16 v206, v43, v225, v10
    v_dot2_f32_bf16 v207, v43, v226, v10
    v_cvt_pk_bf16_f32 v36, v208, v209
    v_cvt_pk_bf16_f32 v37, v210, v211
    v_cvt_pk_bf16_f32 v38, v212, v213
    v_cvt_pk_bf16_f32 v39, v214, v215
    v_dot2c_f32_bf16 v220, v32, v32
    v_dot2c_f32_bf16 v221, v33, v33
    v_dot2c_f32_bf16 v222, v34, v34
    v_dot2c_f32_bf16 v223, v35, v35
    v_dot2_f32_bf16 v208, v44, v225, v10
    v_dot2_f32_bf16 v209, v44, v226, v10
    v_dot2_f32_bf16 v210, v45, v225, v10
    v_dot2_f32_bf16 v211, v45, v226, v10
    v_dot2_f32_bf16 v212, v46, v225, v10
    v_dot2_f32_bf16 v213, v46, v226, v10
    v_dot2_f32_bf16 v214, v47, v225, v10
    v_dot2_f32_bf16 v215, v47, v226, v10
    v_cvt_pk_bf16_f32 v40, v200, v201
    v_cvt_pk_bf16_f32 v41, v202, v203
    v_cvt_pk_bf16_f32 v42, v204, v205
    v_cvt_pk_bf16_f32 v43, v206, v207
    v_dot2c_f32_bf16 v220, v36, v36
    v_dot2c_f32_bf16 v221, v37, v37
    v_dot2c_f32_bf16 v222, v38, v38
    v_dot2c_f32_bf16 v223, v39, v39
    v_dot2_f32_bf16 v200, v48, v225, v10
    v_dot2_f32_bf16 v201, v48, v226, v10
    v_dot2_f32_bf16 v202, v49, v225, v10
    v_dot2_f32_bf16 v203, v49, v226, v10
    v_dot2_f32_bf16 v204, v50, v225, v10
    v_dot2_f32_bf16 v205, v50, v226, v10
    v_dot2_f32_bf16 v206, v51, v225, v10
    v_dot2_f32_bf16 v207, v51, v226, v10
    v_cvt_pk_bf16_f32 v44, v208, v209
    v_cvt_pk_bf16_f32 v45, v210, v211
    v_cvt_pk_bf16_f32 v46, v212, v213
    v_cvt_pk_bf16_f32 v47, v214, v215
    v_dot2c_f32_bf16 v220, v40, v40
    v_dot2c_f32_bf16 v221, v41, v41
    v_dot2c_f32_bf16 v222, v42, v42
    v_dot2c_f32_bf16 v223, v43, v43
    v_dot2_f32_bf16 v208, v52, v225, v10
    v_dot2_f32_bf16 v209, v52, v226, v10
    v_dot2_f32_bf16 v210, v53, v225, v10
    v_dot2_f32_bf16 v211, v53, v226, v10
    v_dot2_f32_bf16 v212, v54, v225, v10
    v_dot2_f32_bf16 v213, v54, v226, v10
    v_dot2_f32_bf16 v214, v55, v225, v10
    v_dot2_f32_bf16 v215, v55, v226, v10
    v_cvt_pk_bf16_f32 v48, v200, v201
    v_cvt_pk_bf16_f32 v49, v202, v203
    v_cvt_pk_bf16_f32 v50, v204, v205
    v_cvt_pk_bf16_f32 v51, v206, v207
    v_dot2c_f32_bf16 v220, v44, v44
    v_dot2c_f32_bf16 v221, v45, v45
    v_dot2c_f32_bf16 v222, v46, v46
    v_dot2c_f32_bf16 v223, v47, v47
    v_dot2_f32_bf16 v200, v56, v225, v10
    v_dot2_f32_bf16 v201, v56, v226, v10
    v_dot2_f32_bf16 v202, v57, v225, v10
    v_dot2_f32_bf16 v203, v57, v226, v10
    v_dot2_f32_bf16 v204, v58, v225, v10
    v_dot2_f32_bf16 v205, v58, v226, v10
    v_dot2_f32_bf16 v206, v59, v225, v10
    v_dot2_f32_bf16 v207, v59, v226, v10
    v_cvt_pk_bf16_f32 v52, v208, v209
    v_cvt_pk_bf16_f32 v53, v210, v211
    v_cvt_pk_bf16_f32 v54, v212, v213
    v_cvt_pk_bf16_f32 v55, v214, v215
    v_dot2c_f32_bf16 v220, v48, v48
    v_dot2c_f32_bf16 v221, v49, v49
    v_dot2c_f32_bf16 v222, v50, v50
    v_dot2c_f32_bf16 v223, v51, v51
    v_dot2_f32_bf16 v208, v60, v225, v10
    v_dot2_f32_bf16 v209, v60, v226, v10
    v_dot2_f32_bf16 v210, v61, v225, v10
    v_dot2_f32_bf16 v211, v61, v226, v10
    v_dot2_f32_bf16 v212, v62, v225, v10
    v_dot2_f32_bf16 v213, v62, v226, v10
    v_dot2_f32_bf16 v214, v63, v225, v10
    v_dot2_f32_bf16 v215, v63, v226, v10
    v_cvt_pk_bf16_f32 v56, v200, v201
    v_cvt_pk_bf16_f32 v57, v202, v203
    v_cvt_pk_bf16_f32 v58, v204, v205
    v_cvt_pk_bf16_f32 v59, v206, v207
    v_dot2c_f32_bf16 v220, v52, v52
    v_dot2c_f32_bf16 v221, v53, v53
    v_dot2c_f32_bf16 v222, v54, v54
    v_dot2c_f32_bf16 v223, v55, v55
    v_dot2_f32_bf16 v200, v64, v225, v10
    v_dot2_f32_bf16 v201, v64, v226, v10
    v_dot2_f32_bf16 v202, v65, v225, v10
    v_dot2_f32_bf16 v203, v65, v226, v10
    v_dot2_f32_bf16 v204, v66, v225, v10
    v_dot2_f32_bf16 v205, v66, v226, v10
    v_dot2_f32_bf16 v206, v67, v225, v10
    v_dot2_f32_bf16 v207, v67, v226, v10
    v_cvt_pk_bf16_f32 v60, v208, v209
    v_cvt_pk_bf16_f32 v61, v210, v211
    v_cvt_pk_bf16_f32 v62, v212, v213
    v_cvt_pk_bf16_f32 v63, v214, v215
    v_dot2c_f32_bf16 v220, v56, v56
    v_dot2c_f32_bf16 v221, v57, v57
    v_dot2c_f32_bf16 v222, v58, v58
    v_dot2c_f32_bf16 v223, v59, v59
    v_dot2_f32_bf16 v208, v68, v225, v10
    v_dot2_f32_bf16 v209, v68, v226, v10
    v_dot2_f32_bf16 v210, v69, v225, v10
    v_dot2_f32_bf16 v211, v69, v226, v10
    v_dot2_f32_bf16 v212, v70, v225, v10
    v_dot2_f32_bf16 v213, v70, v226, v10
    v_dot2_f32_bf16 v214, v71, v225, v10
    v_dot2_f32_bf16 v215, v71, v226, v10
    v_cvt_pk_bf16_f32 v64, v200, v201
    v_cvt_pk_bf16_f32 v65, v202, v203
    v_cvt_pk_bf16_f32 v66, v204, v205
    v_cvt_pk_bf16_f32 v67, v206, v207
    v_dot2c_f32_bf16 v220, v60, v60
    v_dot2c_f32_bf16 v221, v61, v61
    v_dot2c_f32_bf16 v222, v62, v62
    v_dot2c_f32_bf16 v223, v63, v63
    v_dot2_f32_bf16 v200, v72, v225, v10
    v_dot2_f32_bf16 v201, v72, v226, v10
    v_dot2_f32_bf16 v202, v73, v225, v10
    v_dot2_f32_bf16 v203, v73, v226, v10
    v_dot2_f32_bf16 v204, v74, v225, v10
    v_dot2_f32_bf16 v205, v74, v226, v10
    v_dot2_f32_bf16 v206, v75, v225, v10
    v_dot2_f32_bf16 v207, v75, v226, v10
    v_cvt_pk_bf16_f32 v68, v208, v209
    v_cvt_pk_bf16_f32 v69, v210, v211
    v_cvt_pk_bf16_f32 v70, v212, v213
    v_cvt_pk_bf16_f32 v71, v214, v215
    v_dot2c_f32_bf16 v220, v64, v64
    v_dot2c_f32_bf16 v221, v65, v65
    v_dot2c_f32_bf16 v222, v66, v66
    v_dot2c_f32_bf16 v223, v67, v67
    v_dot2_f32_bf16 v208, v76, v225, v10
    v_dot2_f32_bf16 v209, v76, v226, v10
    v_dot2_f32_bf16 v210, v77, v225, v10
    v_dot2_f32_bf16 v211, v77, v226, v10
    v_dot2_f32_bf16 v212, v78, v225, v10
    v_dot2_f32_bf16 v213, v78, v226, v10
    v_dot2_f32_bf16 v214, v79, v225, v10
    v_dot2_f32_bf16 v215, v79, v226, v10
    v_cvt_pk_bf16_f32 v72, v200, v201
    v_cvt_pk_bf16_f32 v73, v202, v203
    v_cvt_pk_bf16_f32 v74, v204, v205
    v_cvt_pk_bf16_f32 v75, v206, v207
    v_dot2c_f32_bf16 v220, v68, v68
    v_dot2c_f32_bf16 v221, v69, v69
    v_dot2c_f32_bf16 v222, v70, v70
    v_dot2c_f32_bf16 v223, v71, v71
    v_dot2_f32_bf16 v200, v80, v225, v10
    v_dot2_f32_bf16 v201, v80, v226, v10
    v_dot2_f32_bf16 v202, v81, v225, v10
    v_dot2_f32_bf16 v203, v81, v226, v10
    v_dot2_f32_bf16 v204, v82, v225, v10
    v_dot2_f32_bf16 v205, v82, v226, v10
    v_dot2_f32_bf16 v206, v83, v225, v10
    v_dot2_f32_bf16 v207, v83, v226, v10
    v_cvt_pk_bf16_f32 v76, v208, v209
    v_cvt_pk_bf16_f32 v77, v210, v211
    v_cvt_pk_bf16_f32 v78, v212, v213
    v_cvt_pk_bf16_f32 v79, v214, v215
    v_dot2c_f32_bf16 v220, v72, v72
    v_dot2c_f32_bf16 v221, v73, v73
    v_dot2c_f32_bf16 v222, v74, v74
    v_dot2c_f32_bf16 v223, v75, v75
    v_dot2_f32_bf16 v208, v84, v225, v10
    v_dot2_f32_bf16 v209, v84, v226, v10
    v_dot2_f32_bf16 v210, v85, v225, v10
    v_dot2_f32_bf16 v211, v85, v226, v10
    v_dot2_f32_bf16 v212, v86, v225, v10
    v_dot2_f32_bf16 v213, v86, v226, v10
    v_dot2_f32_bf16 v214, v87, v225, v10
    v_dot2_f32_bf16 v215, v87, v226, v10
    v_cvt_pk_bf16_f32 v80, v200, v201
    v_cvt_pk_bf16_f32 v81, v202, v203
    v_cvt_pk_bf16_f32 v82, v204, v205
    v_cvt_pk_bf16_f32 v83, v206, v207
    v_dot2c_f32_bf16 v220, v76, v76
    v_dot2c_f32_bf16 v221, v77, v77
    v_dot2c_f32_bf16 v222, v78, v78
    v_dot2c_f32_bf16 v223, v79, v79
    v_dot2_f32_bf16 v200, v88, v225, v10
    v_dot2_f32_bf16 v201, v88, v226, v10
    v_dot2_f32_bf16 v202, v89, v225, v10
    v_dot2_f32_bf16 v203, v89, v226, v10
    v_dot2_f32_bf16 v204, v90, v225, v10
    v_dot2_f32_bf16 v205, v90, v226, v10
    v_dot2_f32_bf16 v206, v91, v225, v10
    v_dot2_f32_bf16 v207, v91, v226, v10
    v_cvt_pk_bf16_f32 v84, v208, v209
    v_cvt_pk_bf16_f32 v85, v210, v211
    v_cvt_pk_bf16_f32 v86, v212, v213
    v_cvt_pk_bf16_f32 v87, v214, v215
    v_dot2c_f32_bf16 v220, v80, v80
    v_dot2c_f32_bf16 v221, v81, v81
    v_dot2c_f32_bf16 v222, v82, v82
    v_dot2c_f32_bf16 v223, v83, v83
    v_dot2_f32_bf16 v208, v92, v225, v10
    v_dot2_f32_bf16 v209, v92, v226, v10
    v_dot2_f32_bf16 v210, v93, v225, v10
    v_dot2_f32_bf16 v211, v93, v226, v10
    v_dot2_f32_bf16 v212, v94, v225, v10
    v_dot2_f32_bf16 v213, v94, v226, v10
    v_dot2_f32_bf16 v214, v95, v225, v10
    v_dot2_f32_bf16 v215, v95, v226, v10
    v_cvt_pk_bf16_f32 v88, v200, v201
    v_cvt_pk_bf16_f32 v89, v202, v203
    v_cvt_pk_bf16_f32 v90, v204, v205
    v_cvt_pk_bf16_f32 v91, v206, v207
    v_dot2c_f32_bf16 v220, v84, v84
    v_dot2c_f32_bf16 v221, v85, v85
    v_dot2c_f32_bf16 v222, v86, v86
    v_dot2c_f32_bf16 v223, v87, v87
    v_dot2_f32_bf16 v200, v96, v225, v10
    v_dot2_f32_bf16 v201, v96, v226, v10
    v_dot2_f32_bf16 v202, v97, v225, v10
    v_dot2_f32_bf16 v203, v97, v226, v10
    v_dot2_f32_bf16 v204, v98, v225, v10
    v_dot2_f32_bf16 v205, v98, v226, v10
    v_dot2_f32_bf16 v206, v99, v225, v10
    v_dot2_f32_bf16 v207, v99, v226, v10
    v_cvt_pk_bf16_f32 v92, v208, v209
    v_cvt_pk_bf16_f32 v93, v210, v211
    v_cvt_pk_bf16_f32 v94, v212, v213
    v_cvt_pk_bf16_f32 v95, v214, v215
    v_dot2c_f32_bf16 v220, v88, v88
    v_dot2c_f32_bf16 v221, v89, v89
    v_dot2c_f32_bf16 v222, v90, v90
    v_dot2c_f32_bf16 v223, v91, v91
    v_dot2_f32_bf16 v208, v100, v225, v10
    v_dot2_f32_bf16 v209, v100, v226, v10
    v_dot2_f32_bf16 v210, v101, v225, v10
    v_dot2_f32_bf16 v211, v101, v226, v10
    v_dot2_f32_bf16 v212, v102, v225, v10
    v_dot2_f32_bf16 v213, v102, v226, v10
    v_dot2_f32_bf16 v214, v103, v225, v10
    v_dot2_f32_bf16 v215, v103, v226, v10
    v_cvt_pk_bf16_f32 v96, v200, v201
    v_cvt_pk_bf16_f32 v97, v202, v203
    v_cvt_pk_bf16_f32 v98, v204, v205
    v_cvt_pk_bf16_f32 v99, v206, v207
    v_dot2c_f32_bf16 v220, v92, v92
    v_dot2c_f32_bf16 v221, v93, v93
    v_dot2c_f32_bf16 v222, v94, v94
    v_dot2c_f32_bf16 v223, v95, v95
    v_dot2_f32_bf16 v200, v104, v225, v10
    v_dot2_f32_bf16 v201, v104, v226, v10
    v_dot2_f32_bf16 v202, v105, v225, v10
    v_dot2_f32_bf16 v203, v105, v226, v10
    v_dot2_f32_bf16 v204, v106, v225, v10
    v_dot2_f32_bf16 v205, v106, v226, v10
    v_dot2_f32_bf16 v206, v107, v225, v10
    v_dot2_f32_bf16 v207, v107, v226, v10
    v_cvt_pk_bf16_f32 v100, v208, v209
    v_cvt_pk_bf16_f32 v101, v210, v211
    v_cvt_pk_bf16_f32 v102, v212, v213
    v_cvt_pk_bf16_f32 v103, v214, v215
    v_dot2c_f32_bf16 v220, v96, v96
    v_dot2c_f32_bf16 v221, v97, v97
    v_dot2c_f32_bf16 v222, v98, v98
    v_dot2c_f32_bf16 v223, v99, v99
    v_dot2_f32_bf16 v208, v108, v225, v10
    v_dot2_f32_bf16 v209, v108, v226, v10
    v_dot2_f32_bf16 v210, v109, v225, v10
    v_dot2_f32_bf16 v211, v109, v226, v10
    v_dot2_f32_bf16 v212, v110, v225, v10
    v_dot2_f32_bf16 v213, v110, v226, v10
    v_dot2_f32_bf16 v214, v111, v225, v10
    v_dot2_f32_bf16 v215, v111, v226, v10
    v_cvt_pk_bf16_f32 v104, v200, v201
    v_cvt_pk_bf16_f32 v105, v202, v203
    v_cvt_pk_bf16_f32 v106, v204, v205
    v_cvt_pk_bf16_f32 v107, v206, v207
    v_dot2c_f32_bf16 v220, v100, v100
    v_dot2c_f32_bf16 v221, v101, v101
    v_dot2c_f32_bf16 v222, v102, v102
    v_dot2c_f32_bf16 v223, v103, v103
    v_dot2_f32_bf16 v200, v112, v225, v10
    v_dot2_f32_bf16 v201, v112, v226, v10
    v_dot2_f32_bf16 v202, v113, v225, v10
    v_dot2_f32_bf16 v203, v113, v226, v10
    v_dot2_f32_bf16 v204, v114, v225, v10
    v_dot2_f32_bf16 v205, v114, v226, v10
    v_dot2_f32_bf16 v206, v115, v225, v10
    v_dot2_f32_bf16 v207, v115, v226, v10
    v_cvt_pk_bf16_f32 v108, v208, v209
    v_cvt_pk_bf16_f32 v109, v210, v211
    v_cvt_pk_bf16_f32 v110, v212, v213
    v_cvt_pk_bf16_f32 v111, v214, v215
    v_dot2c_f32_bf16 v220, v104, v104
    v_dot2c_f32_bf16 v221, v105, v105
    v_dot2c_f32_bf16 v222, v106, v106
    v_dot2c_f32_bf16 v223, v107, v107
    v_dot2_f32_bf16 v208, v116, v225, v10
    v_dot2_f32_bf16 v209, v116, v226, v10
    v_dot2_f32_bf16 v210, v117, v225, v10
    v_dot2_f32_bf16 v211, v117, v226, v10
    v_dot2_f32_bf16 v212, v118, v225, v10
    v_dot2_f32_bf16 v213, v118, v226, v10
    v_dot2_f32_bf16 v214, v119, v225, v10
    v_dot2_f32_bf16 v215, v119, v226, v10
    v_cvt_pk_bf16_f32 v112, v200, v201
    v_cvt_pk_bf16_f32 v113, v202, v203
    v_cvt_pk_bf16_f32 v114, v204, v205
    v_cvt_pk_bf16_f32 v115, v206, v207
    v_dot2c_f32_bf16 v220, v108, v108
    v_dot2c_f32_bf16 v221, v109, v109
    v_dot2c_f32_bf16 v222, v110, v110
    v_dot2c_f32_bf16 v223, v111, v111
    v_dot2_f32_bf16 v200, v120, v225, v10
    v_dot2_f32_bf16 v201, v120, v226, v10
    v_dot2_f32_bf16 v202, v121, v225, v10
    v_dot2_f32_bf16 v203, v121, v226, v10
    v_dot2_f32_bf16 v204, v122, v225, v10
    v_dot2_f32_bf16 v205, v122, v226, v10
    v_dot2_f32_bf16 v206, v123, v225, v10
    v_dot2_f32_bf16 v207, v123, v226, v10
    v_cvt_pk_bf16_f32 v116, v208, v209
    v_cvt_pk_bf16_f32 v117, v210, v211
    v_cvt_pk_bf16_f32 v118, v212, v213
    v_cvt_pk_bf16_f32 v119, v214, v215
    v_dot2c_f32_bf16 v220, v112, v112
    v_dot2c_f32_bf16 v221, v113, v113
    v_dot2c_f32_bf16 v222, v114, v114
    v_dot2c_f32_bf16 v223, v115, v115
    v_dot2_f32_bf16 v208, v124, v225, v10
    v_dot2_f32_bf16 v209, v124, v226, v10
    v_dot2_f32_bf16 v210, v125, v225, v10
    v_dot2_f32_bf16 v211, v125, v226, v10
    v_dot2_f32_bf16 v212, v126, v225, v10
    v_dot2_f32_bf16 v213, v126, v226, v10
    v_dot2_f32_bf16 v214, v127, v225, v10
    v_dot2_f32_bf16 v215, v127, v226, v10
    v_cvt_pk_bf16_f32 v120, v200, v201
    v_cvt_pk_bf16_f32 v121, v202, v203
    v_cvt_pk_bf16_f32 v122, v204, v205
    v_cvt_pk_bf16_f32 v123, v206, v207
    v_dot2c_f32_bf16 v220, v116, v116
    v_dot2c_f32_bf16 v221, v117, v117
    v_dot2c_f32_bf16 v222, v118, v118
    v_dot2c_f32_bf16 v223, v119, v119
    v_dot2_f32_bf16 v200, v128, v225, v10
    v_dot2_f32_bf16 v201, v128, v226, v10
    v_dot2_f32_bf16 v202, v129, v225, v10
    v_dot2_f32_bf16 v203, v129, v226, v10
    v_dot2_f32_bf16 v204, v130, v225, v10
    v_dot2_f32_bf16 v205, v130, v226, v10
    v_dot2_f32_bf16 v206, v131, v225, v10
    v_dot2_f32_bf16 v207, v131, v226, v10
    v_cvt_pk_bf16_f32 v124, v208, v209
    v_cvt_pk_bf16_f32 v125, v210, v211
    v_cvt_pk_bf16_f32 v126, v212, v213
    v_cvt_pk_bf16_f32 v127, v214, v215
    v_dot2c_f32_bf16 v220, v120, v120
    v_dot2c_f32_bf16 v221, v121, v121
    v_dot2c_f32_bf16 v222, v122, v122
    v_dot2c_f32_bf16 v223, v123, v123
    v_dot2_f32_bf16 v208, v132, v225, v10
    v_dot2_f32_bf16 v209, v132, v226, v10
    v_dot2_f32_bf16 v210, v133, v225, v10
    v_dot2_f32_bf16 v211, v133, v226, v10
    v_dot2_f32_bf16 v212, v134, v225, v10
    v_dot2_f32_bf16 v213, v134, v226, v10
    v_dot2_f32_bf16 v214, v135, v225, v10
    v_dot2_f32_bf16 v215, v135, v226, v10
    v_cvt_pk_bf16_f32 v128, v200, v201
    v_cvt_pk_bf16_f32 v129, v202, v203
    v_cvt_pk_bf16_f32 v130, v204, v205
    v_cvt_pk_bf16_f32 v131, v206, v207
    v_dot2c_f32_bf16 v220, v124, v124
    v_dot2c_f32_bf16 v221, v125, v125
    v_dot2c_f32_bf16 v222, v126, v126
    v_dot2c_f32_bf16 v223, v127, v127
    v_dot2_f32_bf16 v200, v136, v225, v10
    v_dot2_f32_bf16 v201, v136, v226, v10
    v_dot2_f32_bf16 v202, v137, v225, v10
    v_dot2_f32_bf16 v203, v137, v226, v10
    v_dot2_f32_bf16 v204, v138, v225, v10
    v_dot2_f32_bf16 v205, v138, v226, v10
    v_dot2_f32_bf16 v206, v139, v225, v10
    v_dot2_f32_bf16 v207, v139, v226, v10
    v_cvt_pk_bf16_f32 v132, v208, v209
    v_cvt_pk_bf16_f32 v133, v210, v211
    v_cvt_pk_bf16_f32 v134, v212, v213
    v_cvt_pk_bf16_f32 v135, v214, v215
    v_dot2c_f32_bf16 v220, v128, v128
    v_dot2c_f32_bf16 v221, v129, v129
    v_dot2c_f32_bf16 v222, v130, v130
    v_dot2c_f32_bf16 v223, v131, v131
    v_dot2_f32_bf16 v208, v140, v225, v10
    v_dot2_f32_bf16 v209, v140, v226, v10
    v_dot2_f32_bf16 v210, v141, v225, v10
    v_dot2_f32_bf16 v211, v141, v226, v10
    v_dot2_f32_bf16 v212, v142, v225, v10
    v_dot2_f32_bf16 v213, v142, v226, v10
    v_dot2_f32_bf16 v214, v143, v225, v10
    v_dot2_f32_bf16 v215, v143, v226, v10
    v_cvt_pk_bf16_f32 v136, v200, v201
    v_cvt_pk_bf16_f32 v137, v202, v203
    v_cvt_pk_bf16_f32 v138, v204, v205
    v_cvt_pk_bf16_f32 v139, v206, v207
    v_dot2c_f32_bf16 v220, v132, v132
    v_dot2c_f32_bf16 v221, v133, v133
    v_dot2c_f32_bf16 v222, v134, v134
    v_dot2c_f32_bf16 v223, v135, v135
    v_cvt_pk_bf16_f32 v140, v208, v209
    v_cvt_pk_bf16_f32 v141, v210, v211
    v_cvt_pk_bf16_f32 v142, v212, v213
    v_cvt_pk_bf16_f32 v143, v214, v215
    v_dot2c_f32_bf16 v220, v136, v136
    v_dot2c_f32_bf16 v221, v137, v137
    v_dot2c_f32_bf16 v222, v138, v138
    v_dot2c_f32_bf16 v223, v139, v139
    v_dot2c_f32_bf16 v220, v140, v140
    v_dot2c_f32_bf16 v221, v141, v141
    v_dot2c_f32_bf16 v222, v142, v142
    v_dot2c_f32_bf16 v223, v143, v143
    s_nop 0
    v_add_f32 v220, v220, v221
    s_nop 0
    v_add_f32 v222, v222, v223
    v_add_f32 v12, v220, v222
    v_mov_b32 v13, v12
    s_nop 1
    v_permlane32_swap_b32 v12, v13
    v_add_f32 v12, v12, v13
    v_mul_f32 v12, 0x3b000000, v12
    v_add_f32 v11, 0x3727c5ac, v12
    v_rsq_f32 v6, v11
    v_and_b32 v12, 31, v0
    v_lshlrev_b32 v12, 2, v12
    s_lshl_b32 s11, s7, 7
    s_add_u32 s11, s11, 148480
    v_add_u32 v12, s11, v12
    v_mul_f32 v7, 0x3eb8aa3b, v6
    ds_write_b32 v12, v6
    s_sub_u32 s11, s11, 0x20000
    v_add_u32 v10, s11, v8
    v_mov_b32 v12, 0
    v_mov_b32 v13, v236
    s_cmp_eq_u32 s6, 1
    s_cbranch_scc1 L_cB
    ds_read_b32 v15, v8 offset:17964
    s_waitcnt lgkmcnt(0)
    s_mov_b32 s11, 0
L_lp_4:
    v_readfirstlane_b32 s12, v15
    s_add_u32 s11, s11, 1
    s_nop 0
    s_cmp_ge_u32 s12, 4
    s_cbranch_scc1 L_lok_3
    s_sleep 1
    ds_read_b32 v15, v8 offset:17964
    s_waitcnt lgkmcnt(0)
    s_cmp_lt_u32 s11, 2097152
    s_cbranch_scc1 L_lp_4
L_lok_3:
    v_add_u32 v5, 0, v2
    ds_read_b64_tr_b16 v[176:177], v5 offset:0
    ds_read_b64_tr_b16 v[178:179], v5 offset:512
    ds_read_b64_tr_b16 v[180:181], v5 offset:2048
    ds_read_b64_tr_b16 v[182:183], v5 offset:2560
    ds_read_b64_tr_b16 v[184:185], v5 offset:4096
    ds_read_b64_tr_b16 v[186:187], v5 offset:4608
    ds_read_b64_tr_b16 v[188:189], v5 offset:6144
    ds_read_b64_tr_b16 v[190:191], v5 offset:6656
    ds_read_b32 v15, v8 offset:17920
    ds_read_b64_tr_b16 v[192:193], v5 offset:8192
    ds_read_b64_tr_b16 v[194:195], v5 offset:8704
    s_waitcnt lgkmcnt(7)
    v_mfma_f32_32x32x16_bf16 v[144:159], v[176:179], v[16:19], 0
    ds_read_b64_tr_b16 v[196:197], v5 offset:10240
    ds_read_b64_tr_b16 v[198:199], v5 offset:10752
    v_mfma_f32_32x32x16_bf16 v[144:159], v[180:183], v[20:23], v[144:159]
    ds_read_b64_tr_b16 v[176:177], v5 offset:12288
    ds_read_b64_tr_b16 v[178:179], v5 offset:12800
    s_waitcnt lgkmcnt(7)
    v_mfma_f32_32x32x16_bf16 v[144:159], v[184:187], v[24:27], v[144:159]
    ds_read_b64_tr_b16 v[180:181], v5 offset:14336
    ds_read_b64_tr_b16 v[182:183], v5 offset:14848
    v_mfma_f32_32x32x16_bf16 v[144:159], v[188:191], v[28:31], v[144:159]
    s_waitcnt lgkmcnt(8)
    s_mov_b32 s11, 0
L_lp_6:
    v_readfirstlane_b32 s12, v15
    s_add_u32 s11, s11, 1
    s_nop 0
    s_cmp_ge_u32 s12, 4
    s_cbranch_scc1 L_lok_5
    s_sleep 1
    ds_read_b32 v15, v8 offset:17920
    s_waitcnt lgkmcnt(0)
    s_cmp_lt_u32 s11, 2097152
    s_cbranch_scc1 L_lp_6
L_lok_5:
    v_add_u32 v5, 16384, v2
    ds_read_b64_tr_b16 v[184:185], v5 offset:0
    ds_read_b64_tr_b16 v[186:187], v5 offset:512
    s_waitcnt lgkmcnt(6)
    v_mfma_f32_32x32x16_bf16 v[144:159], v[192:195], v[32:35], v[144:159]
    ds_read_b64_tr_b16 v[188:189], v5 offset:2048
    ds_read_b64_tr_b16 v[190:191], v5 offset:2560
    v_mfma_f32_32x32x16_bf16 v[144:159], v[196:199], v[36:39], v[144:159]
    ds_read_b64_tr_b16 v[192:193], v5 offset:4096
    ds_read_b64_tr_b16 v[194:195], v5 offset:4608
    s_waitcnt lgkmcnt(6)
    v_mfma_f32_32x32x16_bf16 v[144:159], v[176:179], v[40:43], v[144:159]
    ds_read_b64_tr_b16 v[196:197], v5 offset:6144
    ds_read_b64_tr_b16 v[198:199], v5 offset:6656
    v_mfma_f32_32x32x16_bf16 v[144:159], v[180:183], v[44:47], v[144:159]
    ds_read_b32 v15, v8 offset:17924
    ds_read_b64_tr_b16 v[176:177], v5 offset:8192
    ds_read_b64_tr_b16 v[178:179], v5 offset:8704
    s_waitcnt lgkmcnt(7)
    v_mfma_f32_32x32x16_bf16 v[144:159], v[184:187], v[48:51], v[144:159]
    ds_read_b64_tr_b16 v[180:181], v5 offset:10240
    ds_read_b64_tr_b16 v[182:183], v5 offset:10752
    v_mfma_f32_32x32x16_bf16 v[144:159], v[188:191], v[52:55], v[144:159]
    ds_read_b64_tr_b16 v[184:185], v5 offset:12288
    ds_read_b64_tr_b16 v[186:187], v5 offset:12800
    s_waitcnt lgkmcnt(7)
    v_mfma_f32_32x32x16_bf16 v[144:159], v[192:195], v[56:59], v[144:159]
    ds_read_b64_tr_b16 v[188:189], v5 offset:14336
    ds_read_b64_tr_b16 v[190:191], v5 offset:14848
    v_mfma_f32_32x32x16_bf16 v[144:159], v[196:199], v[60:63], v[144:159]
    s_waitcnt lgkmcnt(8)
    s_mov_b32 s11, 0
L_lp_8:
    v_readfirstlane_b32 s12, v15
    s_add_u32 s11, s11, 1
    s_nop 0
    s_cmp_ge_u32 s12, 4
    s_cbranch_scc1 L_lok_7
    s_sleep 1
    ds_read_b32 v15, v8 offset:17924
    s_waitcnt lgkmcnt(0)
    s_cmp_lt_u32 s11, 2097152
    s_cbranch_scc1 L_lp_8
L_lok_7:
    v_add_u32 v5, 32768, v2
    ds_read_b64_tr_b16 v[192:193], v5 offset:0
    ds_read_b64_tr_b16 v[194:195], v5 offset:512
    s_waitcnt lgkmcnt(6)
    v_mfma_f32_32x32x16_bf16 v[144:159], v[176:179], v[64:67], v[144:159]
    ds_read_b64_tr_b16 v[196:197], v5 offset:2048
    ds_read_b64_tr_b16 v[198:199], v5 offset:2560
    v_mfma_f32_32x32x16_bf16 v[144:159], v[180:183], v[68:71], v[144:159]
    ds_read_b64_tr_b16 v[176:177], v5 offset:4096
    ds_read_b64_tr_b16 v[178:179], v5 offset:4608
    s_waitcnt lgkmcnt(6)
    v_mfma_f32_32x32x16_bf16 v[144:159], v[184:187], v[72:75], v[144:159]
    ds_read_b64_tr_b16 v[180:181], v5 offset:6144
    ds_read_b64_tr_b16 v[182:183], v5 offset:6656
    v_mfma_f32_32x32x16_bf16 v[144:159], v[188:191], v[76:79], v[144:159]
    ds_read_b64_tr_b16 v[184:185], v5 offset:8192
    ds_read_b64_tr_b16 v[186:187], v5 offset:8704
    s_waitcnt lgkmcnt(6)
    v_mfma_f32_32x32x16_bf16 v[144:159], v[192:195], v[80:83], v[144:159]
    ds_read_b64_tr_b16 v[188:189], v5 offset:10240
    ds_read_b64_tr_b16 v[190:191], v5 offset:10752
    v_mfma_f32_32x32x16_bf16 v[144:159], v[196:199], v[84:87], v[144:159]
    ds_read_b64_tr_b16 v[192:193], v5 offset:12288
    ds_read_b64_tr_b16 v[194:195], v5 offset:12800
    s_waitcnt lgkmcnt(6)
    v_mfma_f32_32x32x16_bf16 v[144:159], v[176:179], v[88:91], v[144:159]
    ds_read_b64_tr_b16 v[196:197], v5 offset:14336
    ds_read_b64_tr_b16 v[198:199], v5 offset:14848
    v_mfma_f32_32x32x16_bf16 v[144:159], v[180:183], v[92:95], v[144:159]
    v_add_u32 v5, 49152, v2
    ds_read_b64_tr_b16 v[176:177], v5 offset:0
    ds_read_b64_tr_b16 v[178:179], v5 offset:512
    s_waitcnt lgkmcnt(6)
    v_mfma_f32_32x32x16_bf16 v[144:159], v[184:187], v[96:99], v[144:159]
    ds_read_b64_tr_b16 v[180:181], v5 offset:2048
    ds_read_b64_tr_b16 v[182:183], v5 offset:2560
    v_mfma_f32_32x32x16_bf16 v[144:159], v[188:191], v[100:103], v[144:159]
    ds_read_b64_tr_b16 v[184:185], v5 offset:4096
    ds_read_b64_tr_b16 v[186:187], v5 offset:4608
    s_waitcnt lgkmcnt(6)
    v_mfma_f32_32x32x16_bf16 v[144:159], v[192:195], v[104:107], v[144:159]
    ds_read_b64_tr_b16 v[188:189], v5 offset:6144
    ds_read_b64_tr_b16 v[190:191], v5 offset:6656
    v_mfma_f32_32x32x16_bf16 v[144:159], v[196:199], v[108:111], v[144:159]
    ds_read_b64_tr_b16 v[192:193], v5 offset:8192
    ds_read_b64_tr_b16 v[194:195], v5 offset:8704
    s_waitcnt lgkmcnt(6)
    v_mfma_f32_32x32x16_bf16 v[144:159], v[176:179], v[112:115], v[144:159]
    ds_read_b64_tr_b16 v[196:197], v5 offset:10240
    ds_read_b64_tr_b16 v[198:199], v5 offset:10752
    v_mfma_f32_32x32x16_bf16 v[144:159], v[180:183], v[116:119], v[144:159]
    ds_read_b64_tr_b16 v[176:177], v5 offset:12288
    ds_read_b64_tr_b16 v[178:179], v5 offset:12800
    s_waitcnt lgkmcnt(6)
    v_mfma_f32_32x32x16_bf16 v[144:159], v[184:187], v[120:123], v[144:159]
    ds_read_b64_tr_b16 v[180:181], v5 offset:14336
    ds_read_b64_tr_b16 v[182:183], v5 offset:14848
    v_mfma_f32_32x32x16_bf16 v[144:159], v[188:191], v[124:127], v[144:159]
    v_add_u32 v5, 0, v3
    ds_read_b64_tr_b16 v[184:185], v5 offset:0
    ds_read_b64_tr_b16 v[186:187], v5 offset:512
    s_waitcnt lgkmcnt(6)
    v_mfma_f32_32x32x16_bf16 v[144:159], v[192:195], v[128:131], v[144:159]
    ds_read_b64_tr_b16 v[188:189], v5 offset:2048
    ds_read_b64_tr_b16 v[190:191], v5 offset:2560
    v_mfma_f32_32x32x16_bf16 v[144:159], v[196:199], v[132:135], v[144:159]
    ds_read_b64_tr_b16 v[192:193], v5 offset:4096
    ds_read_b64_tr_b16 v[194:195], v5 offset:4608
    s_waitcnt lgkmcnt(6)
    v_mfma_f32_32x32x16_bf16 v[144:159], v[176:179], v[136:139], v[144:159]
    ds_read_b64_tr_b16 v[196:197], v5 offset:6144
    ds_read_b64_tr_b16 v[198:199], v5 offset:6656
    v_mfma_f32_32x32x16_bf16 v[144:159], v[180:183], v[140:143], v[144:159]
    ds_read_b64_tr_b16 v[176:177], v5 offset:8192
    ds_read_b64_tr_b16 v[178:179], v5 offset:8704
    s_waitcnt lgkmcnt(6)
    v_mfma_f32_32x32x16_bf16 v[160:175], v[184:187], v[16:19], 0
    ds_read_b64_tr_b16 v[180:181], v5 offset:10240
    ds_read_b64_tr_b16 v[182:183], v5 offset:10752
    buffer_load_dword v14, v12, s[36:39], 0 offen sc1
    v_mfma_f32_32x32x16_bf16 v[160:175], v[188:191], v[20:23], v[160:175]
    ds_read_b64_tr_b16 v[184:185], v5 offset:12288
    ds_read_b64_tr_b16 v[186:187], v5 offset:12800
    s_waitcnt lgkmcnt(6)
    v_mfma_f32_32x32x16_bf16 v[160:175], v[192:195], v[24:27], v[160:175]
    ds_read_b64_tr_b16 v[188:189], v5 offset:14336
    ds_read_b64_tr_b16 v[190:191], v5 offset:14848
    v_mfma_f32_32x32x16_bf16 v[160:175], v[196:199], v[28:31], v[160:175]
    v_add_u32 v5, 16384, v3
    ds_read_b64_tr_b16 v[192:193], v5 offset:0
    ds_read_b64_tr_b16 v[194:195], v5 offset:512
    v_mul_f32 v200, v7, v144
    v_mul_f32 v201, v7, v145
    v_mul_f32 v202, v7, v146
    s_waitcnt lgkmcnt(6)
    v_mfma_f32_32x32x16_bf16 v[160:175], v[176:179], v[32:35], v[160:175]
    ds_read_b64_tr_b16 v[196:197], v5 offset:2048
    ds_read_b64_tr_b16 v[198:199], v5 offset:2560
    v_mul_f32 v203, v7, v147
    v_mul_f32 v204, v7, v148
    v_mul_f32 v205, v7, v149
    v_mfma_f32_32x32x16_bf16 v[160:175], v[180:183], v[36:39], v[160:175]
    ds_read_b64_tr_b16 v[176:177], v5 offset:4096
    ds_read_b64_tr_b16 v[178:179], v5 offset:4608
    v_mul_f32 v206, v7, v150
    v_mul_f32 v207, v7, v151
    v_cvt_pk_bf16_f32 v224, v200, v201
    s_waitcnt lgkmcnt(6)
    v_mfma_f32_32x32x16_bf16 v[160:175], v[184:187], v[40:43], v[160:175]
    ds_read_b64_tr_b16 v[180:181], v5 offset:6144
    ds_read_b64_tr_b16 v[182:183], v5 offset:6656
    v_cvt_pk_bf16_f32 v225, v202, v203
    v_cvt_pk_bf16_f32 v226, v204, v205
    v_cvt_pk_bf16_f32 v227, v206, v207
    v_mfma_f32_32x32x16_bf16 v[160:175], v[188:191], v[44:47], v[160:175]
    ds_read_b64_tr_b16 v[184:185], v5 offset:8192
    ds_read_b64_tr_b16 v[186:187], v5 offset:8704
    s_add_u32 s26, s18, 0
    buffer_store_dwordx4 v[224:227], v1, s[32:35], s26 offen sc1
    v_mul_f32 v208, v7, v152
    v_mul_f32 v209, v7, v153
    s_waitcnt lgkmcnt(6)
    v_mfma_f32_32x32x16_bf16 v[160:175], v[192:195], v[48:51], v[160:175]
    ds_read_b64_tr_b16 v[188:189], v5 offset:10240
    ds_read_b64_tr_b16 v[190:191], v5 offset:10752
    v_mul_f32 v210, v7, v154
    v_mul_f32 v211, v7, v155
    v_mul_f32 v212, v7, v156
    v_mfma_f32_32x32x16_bf16 v[160:175], v[196:199], v[52:55], v[160:175]
    ds_read_b64_tr_b16 v[192:193], v5 offset:12288
    ds_read_b64_tr_b16 v[194:195], v5 offset:12800
    v_mul_f32 v213, v7, v157
    v_mul_f32 v214, v7, v158
    v_mul_f32 v215, v7, v159
    s_waitcnt lgkmcnt(6)
    v_mfma_f32_32x32x16_bf16 v[160:175], v[176:179], v[56:59], v[160:175]
    ds_read_b64_tr_b16 v[196:197], v5 offset:14336
    ds_read_b64_tr_b16 v[198:199], v5 offset:14848
    v_cvt_pk_bf16_f32 v228, v208, v209
    v_cvt_pk_bf16_f32 v229, v210, v211
    v_cvt_pk_bf16_f32 v230, v212, v213
    v_mfma_f32_32x32x16_bf16 v[160:175], v[180:183], v[60:63], v[160:175]
    v_add_u32 v5, 32768, v3
    ds_read_b64_tr_b16 v[176:177], v5 offset:0
    ds_read_b64_tr_b16 v[178:179], v5 offset:512
    v_cvt_pk_bf16_f32 v231, v214, v215
    s_add_u32 s26, s18, 65536
    buffer_store_dwordx4 v[228:231], v1, s[32:35], s26 offen sc1
    s_waitcnt lgkmcnt(6)
    v_mfma_f32_32x32x16_bf16 v[160:175], v[184:187], v[64:67], v[160:175]
    ds_read_b64_tr_b16 v[180:181], v5 offset:2048
    ds_read_b64_tr_b16 v[182:183], v5 offset:2560
    v_and_b32 v237, 31, v0
    v_lshrrev_b32 v238, 5, v0
    v_mfma_f32_32x32x16_bf16 v[160:175], v[188:191], v[68:71], v[160:175]
    ds_read_b64_tr_b16 v[184:185], v5 offset:4096
    ds_read_b64_tr_b16 v[186:187], v5 offset:4608
    v_lshlrev_b32 v238, 2, v238
    v_sub_u32 v237, v237, v238
    v_cmp_le_i32 s[64:65], 0, v237
    s_waitcnt lgkmcnt(6)
    v_mfma_f32_32x32x16_bf16 v[160:175], v[192:195], v[72:75], v[160:175]
    ds_read_b64_tr_b16 v[188:189], v5 offset:6144
    ds_read_b64_tr_b16 v[190:191], v5 offset:6656
    v_cmp_le_i32 s[66:67], 1, v237
    v_cmp_le_i32 s[68:69], 2, v237
    v_mfma_f32_32x32x16_bf16 v[160:175], v[196:199], v[76:79], v[160:175]
    ds_read_b64_tr_b16 v[192:193], v5 offset:8192
    ds_read_b64_tr_b16 v[194:195], v5 offset:8704
    v_cmp_le_i32 s[70:71], 3, v237
    v_cmp_le_i32 s[72:73], 8, v237
    s_waitcnt lgkmcnt(6)
    v_mfma_f32_32x32x16_bf16 v[160:175], v[176:179], v[80:83], v[160:175]
    ds_read_b64_tr_b16 v[196:197], v5 offset:10240
    ds_read_b64_tr_b16 v[198:199], v5 offset:10752
    v_cmp_le_i32 s[74:75], 9, v237
    v_cmp_le_i32 s[76:77], 10, v237
    v_cmp_le_i32 s[78:79], 11, v237
    v_mfma_f32_32x32x16_bf16 v[160:175], v[180:183], v[84:87], v[160:175]
    ds_read_b64_tr_b16 v[176:177], v5 offset:12288
    ds_read_b64_tr_b16 v[178:179], v5 offset:12800
    v_cmp_le_i32 s[80:81], 16, v237
    v_cmp_le_i32 s[82:83], 17, v237
    s_waitcnt lgkmcnt(6)
    v_mfma_f32_32x32x16_bf16 v[160:175], v[184:187], v[88:91], v[160:175]
    ds_read_b64_tr_b16 v[180:181], v5 offset:14336
    ds_read_b64_tr_b16 v[182:183], v5 offset:14848
    v_cmp_le_i32 s[84:85], 18, v237
    v_cmp_le_i32 s[86:87], 19, v237
    v_mfma_f32_32x32x16_bf16 v[160:175], v[188:191], v[92:95], v[160:175]
    v_add_u32 v5, 49152, v3
    ds_read_b64_tr_b16 v[184:185], v5 offset:0
    ds_read_b64_tr_b16 v[186:187], v5 offset:512
    v_cmp_le_i32 s[88:89], 24, v237
    v_cmp_le_i32 s[90:91], 25, v237
    s_waitcnt lgkmcnt(6)
    v_mfma_f32_32x32x16_bf16 v[160:175], v[192:195], v[96:99], v[160:175]
    ds_read_b64_tr_b16 v[188:189], v5 offset:2048
    ds_read_b64_tr_b16 v[190:191], v5 offset:2560
    v_cmp_le_i32 s[92:93], 26, v237
    v_cmp_le_i32 s[94:95], 27, v237
    v_mov_b32 v238, 0xffff
    v_mfma_f32_32x32x16_bf16 v[160:175], v[196:199], v[100:103], v[160:175]
    ds_read_b64_tr_b16 v[192:193], v5 offset:4096
    ds_read_b64_tr_b16 v[194:195], v5 offset:4608
    v_mov_b32 v239, 0xffff0000
    v_cndmask_b32 v240, 0, v238, s[64:65]
    s_waitcnt lgkmcnt(6)
    v_mfma_f32_32x32x16_bf16 v[160:175], v[176:179], v[104:107], v[160:175]
    ds_read_b64_tr_b16 v[196:197], v5 offset:6144
    ds_read_b64_tr_b16 v[198:199], v5 offset:6656
    v_cndmask_b32 v248, 0, v239, s[66:67]
    v_or_b32 v240, v240, v248
    v_mfma_f32_32x32x16_bf16 v[160:175], v[180:183], v[108:111], v[160:175]
    ds_read_b32 v15, v8 offset:17928
    ds_read_b64_tr_b16 v[176:177], v5 offset:8192
    ds_read_b64_tr_b16 v[178:179], v5 offset:8704
    v_cndmask_b32 v241, 0, v238, s[68:69]
    v_cndmask_b32 v248, 0, v239, s[70:71]
    v_or_b32 v241, v241, v248
    s_waitcnt lgkmcnt(7)
    v_mfma_f32_32x32x16_bf16 v[160:175], v[184:187], v[112:115], v[160:175]
    ds_read_b64_tr_b16 v[180:181], v5 offset:10240
    ds_read_b64_tr_b16 v[182:183], v5 offset:10752
    v_cndmask_b32 v242, 0, v238, s[72:73]
    v_cndmask_b32 v248, 0, v239, s[74:75]
    v_mfma_f32_32x32x16_bf16 v[160:175], v[188:191], v[116:119], v[160:175]
    ds_read_b64_tr_b16 v[184:185], v5 offset:12288
    ds_read_b64_tr_b16 v[186:187], v5 offset:12800
    v_or_b32 v242, v242, v248
    v_cndmask_b32 v243, 0, v238, s[76:77]
    s_waitcnt lgkmcnt(7)
    v_mfma_f32_32x32x16_bf16 v[160:175], v[192:195], v[120:123], v[160:175]
    ds_read_b64_tr_b16 v[188:189], v5 offset:14336
    ds_read_b64_tr_b16 v[190:191], v5 offset:14848
    v_cndmask_b32 v248, 0, v239, s[78:79]
    v_or_b32 v243, v243, v248
    v_cndmask_b32 v244, 0, v238, s[80:81]
    v_mfma_f32_32x32x16_bf16 v[160:175], v[196:199], v[124:127], v[160:175]
    s_waitcnt lgkmcnt(8)
    s_mov_b32 s11, 0
L_lp_10:
    v_readfirstlane_b32 s12, v15
    s_add_u32 s11, s11, 1
    s_nop 0
    s_cmp_ge_u32 s12, 4
    s_cbranch_scc1 L_lok_9
    s_sleep 1
    ds_read_b32 v15, v8 offset:17928
    s_waitcnt lgkmcnt(0)
    s_cmp_lt_u32 s11, 2097152
    s_cbranch_scc1 L_lp_10
L_lok_9:
    v_add_u32 v5, 65536, v2
    ds_read_b64_tr_b16 v[192:193], v5 offset:0
    ds_read_b64_tr_b16 v[194:195], v5 offset:512
    v_cndmask_b32 v248, 0, v239, s[82:83]
    v_or_b32 v244, v244, v248
    s_waitcnt lgkmcnt(6)
    v_mfma_f32_32x32x16_bf16 v[160:175], v[176:179], v[128:131], v[160:175]
    ds_read_b64_tr_b16 v[196:197], v5 offset:2048
    ds_read_b64_tr_b16 v[198:199], v5 offset:2560
    v_cndmask_b32 v245, 0, v238, s[84:85]
    v_cndmask_b32 v248, 0, v239, s[86:87]
    v_mfma_f32_32x32x16_bf16 v[160:175], v[180:183], v[132:135], v[160:175]
    ds_read_b64_tr_b16 v[176:177], v5 offset:4096
    ds_read_b64_tr_b16 v[178:179], v5 offset:4608
    v_or_b32 v245, v245, v248
    v_cndmask_b32 v246, 0, v238, s[88:89]
    s_waitcnt lgkmcnt(6)
    v_mfma_f32_32x32x16_bf16 v[160:175], v[184:187], v[136:139], v[160:175]
    ds_read_b64_tr_b16 v[180:181], v5 offset:6144
    ds_read_b64_tr_b16 v[182:183], v5 offset:6656
    v_cndmask_b32 v248, 0, v239, s[90:91]
    v_or_b32 v246, v246, v248
    v_cndmask_b32 v247, 0, v238, s[92:93]
    v_mfma_f32_32x32x16_bf16 v[160:175], v[188:191], v[140:143], v[160:175]
    ds_read_b64_tr_b16 v[184:185], v5 offset:8192
    ds_read_b64_tr_b16 v[186:187], v5 offset:8704
    v_cndmask_b32 v248, 0, v239, s[94:95]
    v_or_b32 v247, v247, v248
    s_waitcnt lgkmcnt(6)
    v_mfma_f32_32x32x16_bf16 v[144:159], v[192:195], v[16:19], 0
    ds_read_b64_tr_b16 v[188:189], v5 offset:10240
    ds_read_b64_tr_b16 v[190:191], v5 offset:10752
    v_mfma_f32_32x32x16_bf16 v[144:159], v[196:199], v[20:23], v[144:159]
    ds_read_b64_tr_b16 v[192:193], v5 offset:12288
    ds_read_b64_tr_b16 v[194:195], v5 offset:12800
    s_waitcnt lgkmcnt(6)
    v_mfma_f32_32x32x16_bf16 v[144:159], v[176:179], v[24:27], v[144:159]
    ds_read_b64_tr_b16 v[196:197], v5 offset:14336
    ds_read_b64_tr_b16 v[198:199], v5 offset:14848
    v_mfma_f32_32x32x16_bf16 v[144:159], v[180:183], v[28:31], v[144:159]
    v_add_u32 v5, 81920, v2
    ds_read_b64_tr_b16 v[176:177], v5 offset:0
    ds_read_b64_tr_b16 v[178:179], v5 offset:512
    v_mul_f32 v200, v7, v160
    v_mul_f32 v201, v7, v161
    v_mul_f32 v202, v7, v162
    s_waitcnt lgkmcnt(6)
    v_mfma_f32_32x32x16_bf16 v[144:159], v[184:187], v[32:35], v[144:159]
    ds_read_b64_tr_b16 v[180:181], v5 offset:2048
    ds_read_b64_tr_b16 v[182:183], v5 offset:2560
    v_mul_f32 v203, v7, v163
    v_mul_f32 v204, v7, v164
    v_mul_f32 v205, v7, v165
    v_mfma_f32_32x32x16_bf16 v[144:159], v[188:191], v[36:39], v[144:159]
    ds_read_b64_tr_b16 v[184:185], v5 offset:4096
    ds_read_b64_tr_b16 v[186:187], v5 offset:4608
    v_mul_f32 v206, v7, v166
    v_mul_f32 v207, v7, v167
    v_cvt_pk_bf16_f32 v224, v200, v201
    s_waitcnt lgkmcnt(6)
    v_mfma_f32_32x32x16_bf16 v[144:159], v[192:195], v[40:43], v[144:159]
    ds_read_b64_tr_b16 v[188:189], v5 offset:6144
    ds_read_b64_tr_b16 v[190:191], v5 offset:6656
    v_cvt_pk_bf16_f32 v225, v202, v203
    v_cvt_pk_bf16_f32 v226, v204, v205
    v_cvt_pk_bf16_f32 v227, v206, v207
    v_mfma_f32_32x32x16_bf16 v[144:159], v[196:199], v[44:47], v[144:159]
    ds_read_b32 v15, v8 offset:17932
    ds_read_b64_tr_b16 v[192:193], v5 offset:8192
    ds_read_b64_tr_b16 v[194:195], v5 offset:8704
    s_add_u32 s26, s18, 131072
    buffer_store_dwordx4 v[224:227], v1, s[32:35], s26 offen sc1
    v_mul_f32 v208, v7, v168
    v_mul_f32 v209, v7, v169
    s_waitcnt lgkmcnt(7)
    v_mfma_f32_32x32x16_bf16 v[144:159], v[176:179], v[48:51], v[144:159]
    ds_read_b64_tr_b16 v[196:197], v5 offset:10240
    ds_read_b64_tr_b16 v[198:199], v5 offset:10752
    v_mul_f32 v210, v7, v170
    v_mul_f32 v211, v7, v171
    v_mul_f32 v212, v7, v172
    v_mfma_f32_32x32x16_bf16 v[144:159], v[180:183], v[52:55], v[144:159]
    ds_read_b64_tr_b16 v[176:177], v5 offset:12288
    ds_read_b64_tr_b16 v[178:179], v5 offset:12800
    v_mul_f32 v213, v7, v173
    v_mul_f32 v214, v7, v174
    v_mul_f32 v215, v7, v175
    s_waitcnt lgkmcnt(7)
    v_mfma_f32_32x32x16_bf16 v[144:159], v[184:187], v[56:59], v[144:159]
    ds_read_b64_tr_b16 v[180:181], v5 offset:14336
    ds_read_b64_tr_b16 v[182:183], v5 offset:14848
    v_cvt_pk_bf16_f32 v228, v208, v209
    v_cvt_pk_bf16_f32 v229, v210, v211
    v_cvt_pk_bf16_f32 v230, v212, v213
    v_mfma_f32_32x32x16_bf16 v[144:159], v[188:191], v[60:63], v[144:159]
    s_waitcnt lgkmcnt(8)
    s_mov_b32 s11, 0
L_lp_12:
    v_readfirstlane_b32 s12, v15
    s_add_u32 s11, s11, 1
    s_nop 0
    s_cmp_ge_u32 s12, 4
    s_cbranch_scc1 L_lok_11
    s_sleep 1
    ds_read_b32 v15, v8 offset:17932
    s_waitcnt lgkmcnt(0)
    s_cmp_lt_u32 s11, 2097152
    s_cbranch_scc1 L_lp_12
L_lok_11:
    v_add_u32 v5, 98304, v2
    ds_read_b64_tr_b16 v[184:185], v5 offset:0
    ds_read_b64_tr_b16 v[186:187], v5 offset:512
    v_cvt_pk_bf16_f32 v231, v214, v215
    s_add_u32 s26, s18, 196608
    buffer_store_dwordx4 v[228:231], v1, s[32:35], s26 offen sc1
    s_waitcnt lgkmcnt(6)
    v_mfma_f32_32x32x16_bf16 v[144:159], v[192:195], v[64:67], v[144:159]
    ds_read_b64_tr_b16 v[188:189], v5 offset:2048
    ds_read_b64_tr_b16 v[190:191], v5 offset:2560
    s_mov_b64 exec, 1
    ds_add_u32 v8, v232 offset:17984
    s_mov_b64 exec, -1
    v_mfma_f32_32x32x16_bf16 v[144:159], v[196:199], v[68:71], v[144:159]
    ds_read_b64_tr_b16 v[192:193], v5 offset:4096
    ds_read_b64_tr_b16 v[194:195], v5 offset:4608
    s_waitcnt lgkmcnt(7)
    v_mfma_f32_32x32x16_bf16 v[144:159], v[176:179], v[72:75], v[144:159]
    ds_read_b64_tr_b16 v[196:197], v5 offset:6144
    ds_read_b64_tr_b16 v[198:199], v5 offset:6656
    v_mfma_f32_32x32x16_bf16 v[144:159], v[180:183], v[76:79], v[144:159]
    ds_read_b64_tr_b16 v[176:177], v5 offset:8192
    ds_read_b64_tr_b16 v[178:179], v5 offset:8704
    s_waitcnt lgkmcnt(7)
    v_mfma_f32_32x32x16_bf16 v[144:159], v[184:187], v[80:83], v[144:159]
    ds_read_b64_tr_b16 v[180:181], v5 offset:10240
    ds_read_b64_tr_b16 v[182:183], v5 offset:10752
    v_mfma_f32_32x32x16_bf16 v[144:159], v[188:191], v[84:87], v[144:159]
    ds_read_b64_tr_b16 v[184:185], v5 offset:12288
    ds_read_b64_tr_b16 v[186:187], v5 offset:12800
    s_waitcnt lgkmcnt(6)
    v_mfma_f32_32x32x16_bf16 v[144:159], v[192:195], v[88:91], v[144:159]
    ds_read_b64_tr_b16 v[188:189], v5 offset:14336
    ds_read_b64_tr_b16 v[190:191], v5 offset:14848
    v_mfma_f32_32x32x16_bf16 v[144:159], v[196:199], v[92:95], v[144:159]
    v_add_u32 v5, 114688, v2
    ds_read_b64_tr_b16 v[192:193], v5 offset:0
    ds_read_b64_tr_b16 v[194:195], v5 offset:512
    s_waitcnt lgkmcnt(6)
    v_mfma_f32_32x32x16_bf16 v[144:159], v[176:179], v[96:99], v[144:159]
    ds_read_b64_tr_b16 v[196:197], v5 offset:2048
    ds_read_b64_tr_b16 v[198:199], v5 offset:2560
    s_waitcnt vmcnt(4)
    v_readfirstlane_b32 s10, v14
    s_nop 1
    s_cmp_lg_u32 s10, 0
    s_cbranch_scc1 L_eok_13
    s_mov_b32 s11, 0
L_ep_14:
    buffer_load_dword v14, v12, s[36:39], 0 offen sc1
    s_waitcnt vmcnt(0)
    v_readfirstlane_b32 s10, v14
    s_add_u32 s11, s11, 1
    s_nop 0
    s_cmp_lg_u32 s10, 0
    s_cbranch_scc1 L_epd_15
    s_sleep 2
    s_cmp_lt_u32 s11, 131072
    s_cbranch_scc1 L_ep_14
L_epd_15:
L_eok_13:
    v_mov_b32 v11, s10
    v_mfma_f32_32x32x16_bf16 v[144:159], v[180:183], v[100:103], v[144:159]
    ds_read_b64_tr_b16 v[176:177], v5 offset:4096
    ds_read_b64_tr_b16 v[178:179], v5 offset:4608
    s_waitcnt lgkmcnt(6)
    v_mfma_f32_32x32x16_bf16 v[144:159], v[184:187], v[104:107], v[144:159]
    ds_read_b64_tr_b16 v[180:181], v5 offset:6144
    ds_read_b64_tr_b16 v[182:183], v5 offset:6656
    v_mfma_f32_32x32x16_bf16 v[144:159], v[188:191], v[108:111], v[144:159]
    ds_read_b64_tr_b16 v[184:185], v5 offset:8192
    ds_read_b64_tr_b16 v[186:187], v5 offset:8704
    s_waitcnt lgkmcnt(6)
    v_mfma_f32_32x32x16_bf16 v[144:159], v[192:195], v[112:115], v[144:159]
    ds_read_b64_tr_b16 v[188:189], v5 offset:10240
    ds_read_b64_tr_b16 v[190:191], v5 offset:10752
    v_mfma_f32_32x32x16_bf16 v[144:159], v[196:199], v[116:119], v[144:159]
    ds_read_b64_tr_b16 v[192:193], v5 offset:12288
    ds_read_b64_tr_b16 v[194:195], v5 offset:12800
    s_waitcnt lgkmcnt(6)
    v_mfma_f32_32x32x16_bf16 v[144:159], v[176:179], v[120:123], v[144:159]
    ds_read_b64_tr_b16 v[196:197], v5 offset:14336
    ds_read_b64_tr_b16 v[198:199], v5 offset:14848
    v_mfma_f32_32x32x16_bf16 v[144:159], v[180:183], v[124:127], v[144:159]
    v_add_u32 v5, 65536, v3
    ds_read_b64_tr_b16 v[176:177], v5 offset:0
    ds_read_b64_tr_b16 v[178:179], v5 offset:512
    s_waitcnt lgkmcnt(6)
    v_mfma_f32_32x32x16_bf16 v[144:159], v[184:187], v[128:131], v[144:159]
    ds_read_b64_tr_b16 v[180:181], v5 offset:2048
    ds_read_b64_tr_b16 v[182:183], v5 offset:2560
    v_mfma_f32_32x32x16_bf16 v[144:159], v[188:191], v[132:135], v[144:159]
    ds_read_b64_tr_b16 v[184:185], v5 offset:4096
    ds_read_b64_tr_b16 v[186:187], v5 offset:4608
    s_waitcnt lgkmcnt(6)
    v_mfma_f32_32x32x16_bf16 v[144:159], v[192:195], v[136:139], v[144:159]
    ds_read_b64_tr_b16 v[188:189], v5 offset:6144
    ds_read_b64_tr_b16 v[190:191], v5 offset:6656
    v_mfma_f32_32x32x16_bf16 v[144:159], v[196:199], v[140:143], v[144:159]
    ds_read_b64_tr_b16 v[192:193], v5 offset:8192
    ds_read_b64_tr_b16 v[194:195], v5 offset:8704
    s_waitcnt lgkmcnt(6)
    v_mfma_f32_32x32x16_bf16 v[160:175], v[176:179], v[16:19], 0
    ds_read_b64_tr_b16 v[196:197], v5 offset:10240
    ds_read_b64_tr_b16 v[198:199], v5 offset:10752
    v_mfma_f32_32x32x16_bf16 v[160:175], v[180:183], v[20:23], v[160:175]
    ds_read_b64_tr_b16 v[176:177], v5 offset:12288
    ds_read_b64_tr_b16 v[178:179], v5 offset:12800
    s_waitcnt lgkmcnt(6)
    v_mfma_f32_32x32x16_bf16 v[160:175], v[184:187], v[24:27], v[160:175]
    ds_read_b64_tr_b16 v[180:181], v5 offset:14336
    ds_read_b64_tr_b16 v[182:183], v5 offset:14848
    v_mfma_f32_32x32x16_bf16 v[160:175], v[188:191], v[28:31], v[160:175]
    v_add_u32 v5, 81920, v3
    ds_read_b64_tr_b16 v[184:185], v5 offset:0
    ds_read_b64_tr_b16 v[186:187], v5 offset:512
    v_mul_f32 v200, v6, v144
    v_mul_f32 v201, v6, v145
    v_mul_f32 v202, v6, v146
    s_waitcnt lgkmcnt(6)
    v_mfma_f32_32x32x16_bf16 v[160:175], v[192:195], v[32:35], v[160:175]
    ds_read_b64_tr_b16 v[188:189], v5 offset:2048
    ds_read_b64_tr_b16 v[190:191], v5 offset:2560
    v_mul_f32 v203, v6, v147
    v_mul_f32 v204, v6, v148
    v_mul_f32 v205, v6, v149
    v_mfma_f32_32x32x16_bf16 v[160:175], v[196:199], v[36:39], v[160:175]
    ds_read_b64_tr_b16 v[192:193], v5 offset:4096
    ds_read_b64_tr_b16 v[194:195], v5 offset:4608
    v_mul_f32 v206, v6, v150
    v_mul_f32 v207, v6, v151
    v_cvt_pk_bf16_f32 v224, v200, v201
    s_waitcnt lgkmcnt(6)
    v_mfma_f32_32x32x16_bf16 v[160:175], v[176:179], v[40:43], v[160:175]
    ds_read_b64_tr_b16 v[196:197], v5 offset:6144
    ds_read_b64_tr_b16 v[198:199], v5 offset:6656
    v_cvt_pk_bf16_f32 v225, v202, v203
    v_cvt_pk_bf16_f32 v226, v204, v205
    v_cvt_pk_bf16_f32 v227, v206, v207
    v_mfma_f32_32x32x16_bf16 v[160:175], v[180:183], v[44:47], v[160:175]
    ds_read_b64_tr_b16 v[176:177], v5 offset:8192
    ds_read_b64_tr_b16 v[178:179], v5 offset:8704
    s_add_u32 s26, s19, 0
    buffer_store_dwordx4 v[224:227], v1, s[32:35], s26 offen sc1
    v_mul_f32 v208, v6, v152
    v_mul_f32 v209, v6, v153
    s_waitcnt lgkmcnt(6)
    v_mfma_f32_32x32x16_bf16 v[160:175], v[184:187], v[48:51], v[160:175]
    ds_read_b64_tr_b16 v[180:181], v5 offset:10240
    ds_read_b64_tr_b16 v[182:183], v5 offset:10752
    v_mul_f32 v210, v6, v154
    v_mul_f32 v211, v6, v155
    v_mul_f32 v212, v6, v156
    v_mfma_f32_32x32x16_bf16 v[160:175], v[188:191], v[52:55], v[160:175]
    ds_read_b64_tr_b16 v[184:185], v5 offset:12288
    ds_read_b64_tr_b16 v[186:187], v5 offset:12800
    v_mul_f32 v213, v6, v157
    v_mul_f32 v214, v6, v158
    v_mul_f32 v215, v6, v159
    s_waitcnt lgkmcnt(6)
    v_mfma_f32_32x32x16_bf16 v[160:175], v[192:195], v[56:59], v[160:175]
    ds_read_b64_tr_b16 v[188:189], v5 offset:14336
    ds_read_b64_tr_b16 v[190:191], v5 offset:14848
    v_cvt_pk_bf16_f32 v228, v208, v209
    v_cvt_pk_bf16_f32 v229, v210, v211
    v_cvt_pk_bf16_f32 v230, v212, v213
    v_mfma_f32_32x32x16_bf16 v[160:175], v[196:199], v[60:63], v[160:175]
    v_add_u32 v5, 98304, v3
    ds_read_b64_tr_b16 v[192:193], v5 offset:0
    ds_read_b64_tr_b16 v[194:195], v5 offset:512
    v_cvt_pk_bf16_f32 v231, v214, v215
    s_add_u32 s26, s19, 65536
    buffer_store_dwordx4 v[228:231], v1, s[32:35], s26 offen sc1
    s_waitcnt lgkmcnt(6)
    v_mfma_f32_32x32x16_bf16 v[160:175], v[176:179], v[64:67], v[160:175]
    ds_read_b64_tr_b16 v[196:197], v5 offset:2048
    ds_read_b64_tr_b16 v[198:199], v5 offset:2560
    v_mfma_f32_32x32x16_bf16 v[160:175], v[180:183], v[68:71], v[160:175]
    ds_read_b64_tr_b16 v[176:177], v5 offset:4096
    ds_read_b64_tr_b16 v[178:179], v5 offset:4608
    s_waitcnt lgkmcnt(6)
    v_mfma_f32_32x32x16_bf16 v[160:175], v[184:187], v[72:75], v[160:175]
    ds_read_b64_tr_b16 v[180:181], v5 offset:6144
    ds_read_b64_tr_b16 v[182:183], v5 offset:6656
    v_mfma_f32_32x32x16_bf16 v[160:175], v[188:191], v[76:79], v[160:175]
    ds_read_b64_tr_b16 v[184:185], v5 offset:8192
    ds_read_b64_tr_b16 v[186:187], v5 offset:8704
    s_waitcnt lgkmcnt(6)
    v_mfma_f32_32x32x16_bf16 v[160:175], v[192:195], v[80:83], v[160:175]
    ds_read_b64_tr_b16 v[188:189], v5 offset:10240
    ds_read_b64_tr_b16 v[190:191], v5 offset:10752
    v_mfma_f32_32x32x16_bf16 v[160:175], v[196:199], v[84:87], v[160:175]
    ds_read_b64_tr_b16 v[192:193], v5 offset:12288
    ds_read_b64_tr_b16 v[194:195], v5 offset:12800
    s_waitcnt lgkmcnt(6)
    v_mfma_f32_32x32x16_bf16 v[160:175], v[176:179], v[88:91], v[160:175]
    ds_read_b64_tr_b16 v[196:197], v5 offset:14336
    ds_read_b64_tr_b16 v[198:199], v5 offset:14848
    v_mfma_f32_32x32x16_bf16 v[160:175], v[180:183], v[92:95], v[160:175]
    v_add_u32 v5, 114688, v3
    ds_read_b64_tr_b16 v[176:177], v5 offset:0
    ds_read_b64_tr_b16 v[178:179], v5 offset:512
    s_waitcnt lgkmcnt(6)
    v_mfma_f32_32x32x16_bf16 v[160:175], v[184:187], v[96:99], v[160:175]
    ds_read_b64_tr_b16 v[180:181], v5 offset:2048
    ds_read_b64_tr_b16 v[182:183], v5 offset:2560
    v_mfma_f32_32x32x16_bf16 v[160:175], v[188:191], v[100:103], v[160:175]
    ds_read_b64_tr_b16 v[184:185], v5 offset:4096
    ds_read_b64_tr_b16 v[186:187], v5 offset:4608
    s_waitcnt lgkmcnt(6)
    v_mfma_f32_32x32x16_bf16 v[160:175], v[192:195], v[104:107], v[160:175]
    ds_read_b64_tr_b16 v[188:189], v5 offset:6144
    ds_read_b64_tr_b16 v[190:191], v5 offset:6656
    v_mfma_f32_32x32x16_bf16 v[160:175], v[196:199], v[108:111], v[160:175]
    ds_read_b64_tr_b16 v[192:193], v5 offset:8192
    ds_read_b64_tr_b16 v[194:195], v5 offset:8704
    s_waitcnt lgkmcnt(6)
    v_mfma_f32_32x32x16_bf16 v[160:175], v[176:179], v[112:115], v[160:175]
    ds_read_b64_tr_b16 v[196:197], v5 offset:10240
    ds_read_b64_tr_b16 v[198:199], v5 offset:10752
    v_mfma_f32_32x32x16_bf16 v[160:175], v[180:183], v[116:119], v[160:175]
    ds_read_b64_tr_b16 v[176:177], v5 offset:12288
    ds_read_b64_tr_b16 v[178:179], v5 offset:12800
    s_waitcnt lgkmcnt(6)
    v_mfma_f32_32x32x16_bf16 v[160:175], v[184:187], v[120:123], v[160:175]
    ds_read_b64_tr_b16 v[180:181], v5 offset:14336
    ds_read_b64_tr_b16 v[182:183], v5 offset:14848
    v_mfma_f32_32x32x16_bf16 v[160:175], v[188:191], v[124:127], v[160:175]
    v_add_u32 v5, 131072, v2
    ds_read_b64_tr_b16 v[184:185], v5 offset:0
    ds_read_b64_tr_b16 v[186:187], v5 offset:512
    s_waitcnt lgkmcnt(6)
    v_mfma_f32_32x32x16_bf16 v[160:175], v[192:195], v[128:131], v[160:175]
    ds_read_b64_tr_b16 v[188:189], v5 offset:2048
    ds_read_b64_tr_b16 v[190:191], v5 offset:2560
    v_mfma_f32_32x32x16_bf16 v[160:175], v[196:199], v[132:135], v[160:175]
    ds_read_b64_tr_b16 v[192:193], v5 offset:4096
    ds_read_b64_tr_b16 v[194:195], v5 offset:4608
    s_waitcnt lgkmcnt(6)
    v_mfma_f32_32x32x16_bf16 v[160:175], v[176:179], v[136:139], v[160:175]
    ds_read_b64_tr_b16 v[196:197], v5 offset:6144
    ds_read_b64_tr_b16 v[198:199], v5 offset:6656
    v_mfma_f32_32x32x16_bf16 v[160:175], v[180:183], v[140:143], v[160:175]
    ds_read_b32 v15, v8 offset:17952
    ds_read_b64_tr_b16 v[176:177], v5 offset:8192
    ds_read_b64_tr_b16 v[178:179], v5 offset:8704
    s_waitcnt lgkmcnt(7)
    v_mfma_f32_32x32x16_bf16 v[144:159], v[184:187], v[16:19], 0
    ds_read_b64_tr_b16 v[180:181], v5 offset:10240
    ds_read_b64_tr_b16 v[182:183], v5 offset:10752
    v_mfma_f32_32x32x16_bf16 v[144:159], v[188:191], v[20:23], v[144:159]
    ds_read_b64_tr_b16 v[184:185], v5 offset:12288
    ds_read_b64_tr_b16 v[186:187], v5 offset:12800
    s_waitcnt lgkmcnt(7)
    v_mfma_f32_32x32x16_bf16 v[144:159], v[192:195], v[24:27], v[144:159]
    ds_read_b64_tr_b16 v[188:189], v5 offset:14336
    ds_read_b64_tr_b16 v[190:191], v5 offset:14848
    v_mfma_f32_32x32x16_bf16 v[144:159], v[196:199], v[28:31], v[144:159]
    s_waitcnt lgkmcnt(8)
    s_mov_b32 s11, 0
L_lp_17:
    v_readfirstlane_b32 s12, v15
    s_add_u32 s11, s11, 1
    s_nop 0
    s_cmp_ge_u32 s12, 4
    s_cbranch_scc1 L_lok_16
    s_sleep 1
    ds_read_b32 v15, v8 offset:17952
    s_waitcnt lgkmcnt(0)
    s_cmp_lt_u32 s11, 2097152
    s_cbranch_scc1 L_lp_17
L_lok_16:
    v_add_u32 v5, 0, v2
    ds_read_b64_tr_b16 v[192:193], v5 offset:0
    ds_read_b64_tr_b16 v[194:195], v5 offset:512
    v_mul_f32 v200, v6, v160
    v_mul_f32 v201, v6, v161
    v_mul_f32 v202, v6, v162
    s_waitcnt lgkmcnt(6)
    v_mfma_f32_32x32x16_bf16 v[144:159], v[176:179], v[32:35], v[144:159]
    ds_read_b64_tr_b16 v[196:197], v5 offset:2048
    ds_read_b64_tr_b16 v[198:199], v5 offset:2560
    v_mul_f32 v203, v6, v163
    v_mul_f32 v204, v6, v164
    v_mul_f32 v205, v6, v165
    v_mfma_f32_32x32x16_bf16 v[144:159], v[180:183], v[36:39], v[144:159]
    ds_read_b64_tr_b16 v[176:177], v5 offset:4096
    ds_read_b64_tr_b16 v[178:179], v5 offset:4608
    v_mul_f32 v206, v6, v166
    v_mul_f32 v207, v6, v167
    v_cvt_pk_bf16_f32 v224, v200, v201
    s_waitcnt lgkmcnt(6)
    v_mfma_f32_32x32x16_bf16 v[144:159], v[184:187], v[40:43], v[144:159]
    ds_read_b64_tr_b16 v[180:181], v5 offset:6144
    ds_read_b64_tr_b16 v[182:183], v5 offset:6656
    v_cvt_pk_bf16_f32 v225, v202, v203
    v_cvt_pk_bf16_f32 v226, v204, v205
    v_cvt_pk_bf16_f32 v227, v206, v207
    v_mfma_f32_32x32x16_bf16 v[144:159], v[188:191], v[44:47], v[144:159]
    ds_read_b64_tr_b16 v[184:185], v5 offset:8192
    ds_read_b64_tr_b16 v[186:187], v5 offset:8704
    s_add_u32 s26, s19, 131072
    buffer_store_dwordx4 v[224:227], v1, s[32:35], s26 offen sc1
    v_mul_f32 v208, v6, v168
    v_mul_f32 v209, v6, v169
    s_waitcnt lgkmcnt(6)
    v_mfma_f32_32x32x16_bf16 v[144:159], v[192:195], v[48:51], v[144:159]
    ds_read_b64_tr_b16 v[188:189], v5 offset:10240
    ds_read_b64_tr_b16 v[190:191], v5 offset:10752
    v_mul_f32 v210, v6, v170
    v_mul_f32 v211, v6, v171
    v_mul_f32 v212, v6, v172
    v_mfma_f32_32x32x16_bf16 v[144:159], v[196:199], v[52:55], v[144:159]
    ds_read_b64_tr_b16 v[192:193], v5 offset:12288
    ds_read_b64_tr_b16 v[194:195], v5 offset:12800
    v_mul_f32 v213, v6, v173
    v_mul_f32 v214, v6, v174
    v_mul_f32 v215, v6, v175
    s_waitcnt lgkmcnt(6)
    v_mfma_f32_32x32x16_bf16 v[144:159], v[176:179], v[56:59], v[144:159]
    ds_read_b64_tr_b16 v[196:197], v5 offset:14336
    ds_read_b64_tr_b16 v[198:199], v5 offset:14848
    v_cvt_pk_bf16_f32 v228, v208, v209
    v_cvt_pk_bf16_f32 v229, v210, v211
    v_cvt_pk_bf16_f32 v230, v212, v213
    v_mfma_f32_32x32x16_bf16 v[144:159], v[180:183], v[60:63], v[144:159]
    v_add_u32 v5, 16384, v2
    ds_read_b64_tr_b16 v[176:177], v5 offset:0
    ds_read_b64_tr_b16 v[178:179], v5 offset:512
    v_cvt_pk_bf16_f32 v231, v214, v215
    s_add_u32 s26, s19, 196608
    buffer_store_dwordx4 v[228:231], v1, s[32:35], s26 offen sc1
    s_waitcnt lgkmcnt(6)
    v_mfma_f32_32x32x16_bf16 v[144:159], v[184:187], v[64:67], v[144:159]
    ds_read_b64_tr_b16 v[180:181], v5 offset:2048
    ds_read_b64_tr_b16 v[182:183], v5 offset:2560
    s_mov_b64 exec, 1
    ds_add_u32 v8, v232 offset:18016
    s_mov_b64 exec, -1
    v_mfma_f32_32x32x16_bf16 v[144:159], v[188:191], v[68:71], v[144:159]
    ds_read_b64_tr_b16 v[184:185], v5 offset:4096
    ds_read_b64_tr_b16 v[186:187], v5 offset:4608
    s_waitcnt lgkmcnt(7)
    v_mfma_f32_32x32x16_bf16 v[144:159], v[192:195], v[72:75], v[144:159]
    ds_read_b64_tr_b16 v[188:189], v5 offset:6144
    ds_read_b64_tr_b16 v[190:191], v5 offset:6656
    v_mfma_f32_32x32x16_bf16 v[144:159], v[196:199], v[76:79], v[144:159]
    ds_read_b32 v15, v8 offset:17956
    ds_read_b64_tr_b16 v[192:193], v5 offset:8192
    ds_read_b64_tr_b16 v[194:195], v5 offset:8704
    s_waitcnt lgkmcnt(8)
    v_mfma_f32_32x32x16_bf16 v[144:159], v[176:179], v[80:83], v[144:159]
    ds_read_b64_tr_b16 v[196:197], v5 offset:10240
    ds_read_b64_tr_b16 v[198:199], v5 offset:10752
    v_mfma_f32_32x32x16_bf16 v[144:159], v[180:183], v[84:87], v[144:159]
    ds_read_b64_tr_b16 v[176:177], v5 offset:12288
    ds_read_b64_tr_b16 v[178:179], v5 offset:12800
    s_waitcnt lgkmcnt(7)
    v_mfma_f32_32x32x16_bf16 v[144:159], v[184:187], v[88:91], v[144:159]
    ds_read_b64_tr_b16 v[180:181], v5 offset:14336
    ds_read_b64_tr_b16 v[182:183], v5 offset:14848
    v_mfma_f32_32x32x16_bf16 v[144:159], v[188:191], v[92:95], v[144:159]
    s_waitcnt lgkmcnt(8)
    s_mov_b32 s11, 0
L_lp_19:
    v_readfirstlane_b32 s12, v15
    s_add_u32 s11, s11, 1
    s_nop 0
    s_cmp_ge_u32 s12, 4
    s_cbranch_scc1 L_lok_18
    s_sleep 1
    ds_read_b32 v15, v8 offset:17956
    s_waitcnt lgkmcnt(0)
    s_cmp_lt_u32 s11, 2097152
    s_cbranch_scc1 L_lp_19
L_lok_18:
    v_add_u32 v5, 32768, v2
    ds_read_b64_tr_b16 v[184:185], v5 offset:0
    ds_read_b64_tr_b16 v[186:187], v5 offset:512
    s_waitcnt lgkmcnt(6)
    v_mfma_f32_32x32x16_bf16 v[144:159], v[192:195], v[96:99], v[144:159]
    ds_read_b64_tr_b16 v[188:189], v5 offset:2048
    ds_read_b64_tr_b16 v[190:191], v5 offset:2560
    v_mfma_f32_32x32x16_bf16 v[144:159], v[196:199], v[100:103], v[144:159]
    ds_read_b64_tr_b16 v[192:193], v5 offset:4096
    ds_read_b64_tr_b16 v[194:195], v5 offset:4608
    s_waitcnt lgkmcnt(6)
    v_mfma_f32_32x32x16_bf16 v[144:159], v[176:179], v[104:107], v[144:159]
    ds_read_b64_tr_b16 v[196:197], v5 offset:6144
    ds_read_b64_tr_b16 v[198:199], v5 offset:6656
    v_mfma_f32_32x32x16_bf16 v[144:159], v[180:183], v[108:111], v[144:159]
    ds_read_b64_tr_b16 v[176:177], v5 offset:8192
    ds_read_b64_tr_b16 v[178:179], v5 offset:8704
    s_waitcnt lgkmcnt(6)
    v_mfma_f32_32x32x16_bf16 v[144:159], v[184:187], v[112:115], v[144:159]
    ds_read_b64_tr_b16 v[180:181], v5 offset:10240
    ds_read_b64_tr_b16 v[182:183], v5 offset:10752
    v_mfma_f32_32x32x16_bf16 v[144:159], v[188:191], v[116:119], v[144:159]
    ds_read_b64_tr_b16 v[184:185], v5 offset:12288
    ds_read_b64_tr_b16 v[186:187], v5 offset:12800
    s_waitcnt lgkmcnt(6)
    v_mfma_f32_32x32x16_bf16 v[144:159], v[192:195], v[120:123], v[144:159]
    ds_read_b64_tr_b16 v[188:189], v5 offset:14336
    ds_read_b64_tr_b16 v[190:191], v5 offset:14848
    s_waitcnt vmcnt(0)
    buffer_store_dword v11, v12, s[32:35], s22 offen offset:0 sc1
    v_mfma_f32_32x32x16_bf16 v[144:159], v[196:199], v[124:127], v[144:159]
    v_add_u32 v5, 131072, v3
    ds_read_b64_tr_b16 v[192:193], v5 offset:0
    ds_read_b64_tr_b16 v[194:195], v5 offset:512
    s_waitcnt lgkmcnt(6)
    v_mfma_f32_32x32x16_bf16 v[144:159], v[176:179], v[128:131], v[144:159]
    ds_read_b64_tr_b16 v[196:197], v5 offset:2048
    ds_read_b64_tr_b16 v[198:199], v5 offset:2560
    v_mfma_f32_32x32x16_bf16 v[144:159], v[180:183], v[132:135], v[144:159]
    ds_read_b64_tr_b16 v[176:177], v5 offset:4096
    ds_read_b64_tr_b16 v[178:179], v5 offset:4608
    s_waitcnt lgkmcnt(6)
    v_mfma_f32_32x32x16_bf16 v[144:159], v[184:187], v[136:139], v[144:159]
    ds_read_b64_tr_b16 v[180:181], v5 offset:6144
    ds_read_b64_tr_b16 v[182:183], v5 offset:6656
    v_mfma_f32_32x32x16_bf16 v[144:159], v[188:191], v[140:143], v[144:159]
    ds_read_b64_tr_b16 v[184:185], v5 offset:8192
    ds_read_b64_tr_b16 v[186:187], v5 offset:8704
    s_waitcnt lgkmcnt(6)
    v_mfma_f32_32x32x16_bf16 v[160:175], v[192:195], v[16:19], 0
    ds_read_b64_tr_b16 v[188:189], v5 offset:10240
    ds_read_b64_tr_b16 v[190:191], v5 offset:10752
    v_mfma_f32_32x32x16_bf16 v[160:175], v[196:199], v[20:23], v[160:175]
    ds_read_b64_tr_b16 v[192:193], v5 offset:12288
    ds_read_b64_tr_b16 v[194:195], v5 offset:12800
    s_waitcnt lgkmcnt(6)
    v_mfma_f32_32x32x16_bf16 v[160:175], v[176:179], v[24:27], v[160:175]
    ds_read_b64_tr_b16 v[196:197], v5 offset:14336
    ds_read_b64_tr_b16 v[198:199], v5 offset:14848
    v_mfma_f32_32x32x16_bf16 v[160:175], v[180:183], v[28:31], v[160:175]
    v_add_u32 v5, 0, v3
    ds_read_b64_tr_b16 v[176:177], v5 offset:0
    ds_read_b64_tr_b16 v[178:179], v5 offset:512
    ds_read_b128 v[200:203], v8 offset:16384
    ds_read_b128 v[204:207], v8 offset:16416
    ds_read_b128 v[208:211], v8 offset:16448
    ds_read_b128 v[212:215], v8 offset:16480
    s_waitcnt lgkmcnt(3)
    v_fma_f32 v200, v144, v6, v200
    v_mfma_f32_32x32x16_bf16 v[160:175], v[184:187], v[32:35], v[160:175]
    ds_read_b64_tr_b16 v[180:181], v5 offset:2048
    ds_read_b64_tr_b16 v[182:183], v5 offset:2560
    v_fma_f32 v201, v145, v6, v201
    v_fma_f32 v202, v146, v6, v202
    v_fma_f32 v203, v147, v6, v203
    v_mul_f32 v216, v200, v200
    v_mul_f32 v217, v201, v201
    v_mul_f32 v218, v202, v202
    v_mfma_f32_32x32x16_bf16 v[160:175], v[188:191], v[36:39], v[160:175]
    ds_read_b64_tr_b16 v[184:185], v5 offset:4096
    ds_read_b64_tr_b16 v[186:187], v5 offset:4608
    v_mul_f32 v219, v203, v203
    v_fmaak_f32 v216, v216, v9, 0xc0135761
    v_fmaak_f32 v217, v217, v9, 0xc0135761
    v_fmaak_f32 v218, v218, v9, 0xc0135761
    v_fmaak_f32 v219, v219, v9, 0xc0135761
    v_mul_f32 v216, v216, v200
    v_mul_f32 v217, v217, v201
    v_mfma_f32_32x32x16_bf16 v[160:175], v[192:195], v[40:43], v[160:175]
    ds_read_b64_tr_b16 v[188:189], v5 offset:6144
    ds_read_b64_tr_b16 v[190:191], v5 offset:6656
    v_mul_f32 v218, v218, v202
    v_mul_f32 v219, v219, v203
    v_exp_f32 v216, v216
    v_exp_f32 v217, v217
    v_mfma_f32_32x32x16_bf16 v[160:175], v[196:199], v[44:47], v[160:175]
    ds_read_b64_tr_b16 v[192:193], v5 offset:8192
    ds_read_b64_tr_b16 v[194:195], v5 offset:8704
    v_exp_f32 v218, v218
    v_exp_f32 v219, v219
    v_add_f32 v216, 1.0, v216
    v_add_f32 v217, 1.0, v217
    s_waitcnt lgkmcnt(6)
    v_mfma_f32_32x32x16_bf16 v[160:175], v[176:179], v[48:51], v[160:175]
    ds_read_b64_tr_b16 v[196:197], v5 offset:10240
    ds_read_b64_tr_b16 v[198:199], v5 offset:10752
    v_add_f32 v218, 1.0, v218
    v_add_f32 v219, 1.0, v219
    v_rcp_f32 v216, v216
    v_rcp_f32 v217, v217
    v_mfma_f32_32x32x16_bf16 v[160:175], v[180:183], v[52:55], v[160:175]
    ds_read_b64_tr_b16 v[176:177], v5 offset:12288
    ds_read_b64_tr_b16 v[178:179], v5 offset:12800
    v_rcp_f32 v218, v218
    v_rcp_f32 v219, v219
    v_mul_f32 v200, v200, v216
    v_mul_f32 v201, v201, v217
    s_waitcnt lgkmcnt(6)
    v_mfma_f32_32x32x16_bf16 v[160:175], v[184:187], v[56:59], v[160:175]
    ds_read_b64_tr_b16 v[180:181], v5 offset:14336
    ds_read_b64_tr_b16 v[182:183], v5 offset:14848
    v_mul_f32 v202, v202, v218
    v_mul_f32 v203, v203, v219
    v_cvt_pk_bf16_f32 v224, v200, v201
    v_cvt_pk_bf16_f32 v225, v202, v203
    v_fma_f32 v204, v148, v6, v204
    v_fma_f32 v205, v149, v6, v205
    v_mfma_f32_32x32x16_bf16 v[160:175], v[188:191], v[60:63], v[160:175]
    v_add_u32 v5, 16384, v3
    ds_read_b64_tr_b16 v[184:185], v5 offset:0
    ds_read_b64_tr_b16 v[186:187], v5 offset:512
    v_fma_f32 v206, v150, v6, v206
    v_fma_f32 v207, v151, v6, v207
    v_mul_f32 v220, v204, v204
    v_mul_f32 v221, v205, v205
    v_mul_f32 v222, v206, v206
    v_mul_f32 v223, v207, v207
    s_waitcnt lgkmcnt(6)
    v_mfma_f32_32x32x16_bf16 v[160:175], v[192:195], v[64:67], v[160:175]
    ds_read_b64_tr_b16 v[188:189], v5 offset:2048
    ds_read_b64_tr_b16 v[190:191], v5 offset:2560
    v_fmaak_f32 v220, v220, v9, 0xc0135761
    v_fmaak_f32 v221, v221, v9, 0xc0135761
    v_fmaak_f32 v222, v222, v9, 0xc0135761
    v_fmaak_f32 v223, v223, v9, 0xc0135761
    v_mul_f32 v220, v220, v204
    v_mul_f32 v221, v221, v205
    v_mfma_f32_32x32x16_bf16 v[160:175], v[196:199], v[68:71], v[160:175]
    ds_read_b64_tr_b16 v[192:193], v5 offset:4096
    ds_read_b64_tr_b16 v[194:195], v5 offset:4608
    v_mul_f32 v222, v222, v206
    v_mul_f32 v223, v223, v207
    v_exp_f32 v220, v220
    v_exp_f32 v221, v221
    s_waitcnt lgkmcnt(6)
    v_mfma_f32_32x32x16_bf16 v[160:175], v[176:179], v[72:75], v[160:175]
    ds_read_b64_tr_b16 v[196:197], v5 offset:6144
    ds_read_b64_tr_b16 v[198:199], v5 offset:6656
    v_exp_f32 v222, v222
    v_exp_f32 v223, v223
    v_add_f32 v220, 1.0, v220
    v_add_f32 v221, 1.0, v221
    v_mfma_f32_32x32x16_bf16 v[160:175], v[180:183], v[76:79], v[160:175]
    ds_read_b64_tr_b16 v[176:177], v5 offset:8192
    ds_read_b64_tr_b16 v[178:179], v5 offset:8704
    v_add_f32 v222, 1.0, v222
    v_add_f32 v223, 1.0, v223
    v_rcp_f32 v220, v220
    v_rcp_f32 v221, v221
    s_waitcnt lgkmcnt(6)
    v_mfma_f32_32x32x16_bf16 v[160:175], v[184:187], v[80:83], v[160:175]
    ds_read_b64_tr_b16 v[180:181], v5 offset:10240
    ds_read_b64_tr_b16 v[182:183], v5 offset:10752
    v_rcp_f32 v222, v222
    v_rcp_f32 v223, v223
    v_mul_f32 v204, v204, v220
    v_mul_f32 v205, v205, v221
    v_mul_f32 v206, v206, v222
    v_mfma_f32_32x32x16_bf16 v[160:175], v[188:191], v[84:87], v[160:175]
    ds_read_b64_tr_b16 v[184:185], v5 offset:12288
    ds_read_b64_tr_b16 v[186:187], v5 offset:12800
    v_mul_f32 v207, v207, v223
    v_cvt_pk_bf16_f32 v226, v204, v205
    v_cvt_pk_bf16_f32 v227, v206, v207
    s_add_u32 s26, s20, 0
    buffer_store_dwordx4 v[224:227], v1, s[32:35], s26 offen sc1
    s_waitcnt lgkmcnt(6)
    v_mfma_f32_32x32x16_bf16 v[160:175], v[192:195], v[88:91], v[160:175]
    ds_read_b64_tr_b16 v[188:189], v5 offset:14336
    ds_read_b64_tr_b16 v[190:191], v5 offset:14848
    v_fma_f32 v208, v152, v6, v208
    v_fma_f32 v209, v153, v6, v209
    v_fma_f32 v210, v154, v6, v210
    v_fma_f32 v211, v155, v6, v211
    v_mul_f32 v216, v208, v208
    v_mul_f32 v217, v209, v209
    v_mfma_f32_32x32x16_bf16 v[160:175], v[196:199], v[92:95], v[160:175]
    v_add_u32 v5, 32768, v3
    ds_read_b64_tr_b16 v[192:193], v5 offset:0
    ds_read_b64_tr_b16 v[194:195], v5 offset:512
    v_mul_f32 v218, v210, v210
    v_mul_f32 v219, v211, v211
    v_fmaak_f32 v216, v216, v9, 0xc0135761
    v_fmaak_f32 v217, v217, v9, 0xc0135761
    v_fmaak_f32 v218, v218, v9, 0xc0135761
    v_fmaak_f32 v219, v219, v9, 0xc0135761
    v_mul_f32 v216, v216, v208
    s_waitcnt lgkmcnt(6)
    v_mfma_f32_32x32x16_bf16 v[160:175], v[176:179], v[96:99], v[160:175]
    ds_read_b64_tr_b16 v[196:197], v5 offset:2048
    ds_read_b64_tr_b16 v[198:199], v5 offset:2560
    v_mul_f32 v217, v217, v209
    v_mul_f32 v218, v218, v210
    v_mul_f32 v219, v219, v211
    v_exp_f32 v216, v216
    v_mfma_f32_32x32x16_bf16 v[160:175], v[180:183], v[100:103], v[160:175]
    ds_read_b64_tr_b16 v[176:177], v5 offset:4096
    ds_read_b64_tr_b16 v[178:179], v5 offset:4608
    v_exp_f32 v217, v217
    v_exp_f32 v218, v218
    v_exp_f32 v219, v219
    v_add_f32 v216, 1.0, v216
    s_waitcnt lgkmcnt(6)
    v_mfma_f32_32x32x16_bf16 v[160:175], v[184:187], v[104:107], v[160:175]
    ds_read_b64_tr_b16 v[180:181], v5 offset:6144
    ds_read_b64_tr_b16 v[182:183], v5 offset:6656
    v_add_f32 v217, 1.0, v217
    v_add_f32 v218, 1.0, v218
    v_add_f32 v219, 1.0, v219
    v_rcp_f32 v216, v216
    v_mfma_f32_32x32x16_bf16 v[160:175], v[188:191], v[108:111], v[160:175]
    ds_read_b64_tr_b16 v[184:185], v5 offset:8192
    ds_read_b64_tr_b16 v[186:187], v5 offset:8704
    v_rcp_f32 v217, v217
    v_rcp_f32 v218, v218
    v_rcp_f32 v219, v219
    v_mul_f32 v208, v208, v216
    s_waitcnt lgkmcnt(6)
    v_mfma_f32_32x32x16_bf16 v[160:175], v[192:195], v[112:115], v[160:175]
    ds_read_b64_tr_b16 v[188:189], v5 offset:10240
    ds_read_b64_tr_b16 v[190:191], v5 offset:10752
    v_mul_f32 v209, v209, v217
    v_mul_f32 v210, v210, v218
    v_mul_f32 v211, v211, v219
    v_cvt_pk_bf16_f32 v228, v208, v209
    v_cvt_pk_bf16_f32 v229, v210, v211
    v_fma_f32 v212, v156, v6, v212
    v_mfma_f32_32x32x16_bf16 v[160:175], v[196:199], v[116:119], v[160:175]
    ds_read_b64_tr_b16 v[192:193], v5 offset:12288
    ds_read_b64_tr_b16 v[194:195], v5 offset:12800
    v_fma_f32 v213, v157, v6, v213
    v_fma_f32 v214, v158, v6, v214
    v_fma_f32 v215, v159, v6, v215
    v_mul_f32 v220, v212, v212
    v_mul_f32 v221, v213, v213
    v_mul_f32 v222, v214, v214
    s_waitcnt lgkmcnt(6)
    v_mfma_f32_32x32x16_bf16 v[160:175], v[176:179], v[120:123], v[160:175]
    ds_read_b64_tr_b16 v[196:197], v5 offset:14336
    ds_read_b64_tr_b16 v[198:199], v5 offset:14848
    v_mul_f32 v223, v215, v215
    v_fmaak_f32 v220, v220, v9, 0xc0135761
    v_fmaak_f32 v221, v221, v9, 0xc0135761
    v_fmaak_f32 v222, v222, v9, 0xc0135761
    v_fmaak_f32 v223, v223, v9, 0xc0135761
    v_mul_f32 v220, v220, v212
    v_mfma_f32_32x32x16_bf16 v[160:175], v[180:183], v[124:127], v[160:175]
    v_add_u32 v5, 49152, v4
    ds_read_b64_tr_b16 v[176:177], v5 offset:0
    ds_read_b64_tr_b16 v[178:179], v5 offset:256
    v_mul_f32 v221, v221, v213
    v_mul_f32 v222, v222, v214
    v_mul_f32 v223, v223, v215
    v_exp_f32 v220, v220
    s_waitcnt lgkmcnt(6)
    v_mfma_f32_32x32x16_bf16 v[160:175], v[184:187], v[128:131], v[160:175]
    ds_read_b64_tr_b16 v[180:181], v5 offset:1024
    ds_read_b64_tr_b16 v[182:183], v5 offset:1280
    v_exp_f32 v221, v221
    v_exp_f32 v222, v222
    v_exp_f32 v223, v223
    v_add_f32 v220, 1.0, v220
    v_mfma_f32_32x32x16_bf16 v[160:175], v[188:191], v[132:135], v[160:175]
    ds_read_b64_tr_b16 v[184:185], v5 offset:2048
    ds_read_b64_tr_b16 v[186:187], v5 offset:2304
    v_add_f32 v221, 1.0, v221
    v_add_f32 v222, 1.0, v222
    v_add_f32 v223, 1.0, v223
    v_rcp_f32 v220, v220
    v_rcp_f32 v221, v221
    s_waitcnt lgkmcnt(6)
    v_mfma_f32_32x32x16_bf16 v[160:175], v[192:195], v[136:139], v[160:175]
    ds_read_b64_tr_b16 v[188:189], v5 offset:3072
    ds_read_b64_tr_b16 v[190:191], v5 offset:3328
    v_rcp_f32 v222, v222
    v_rcp_f32 v223, v223
    v_mul_f32 v212, v212, v220
    v_mul_f32 v213, v213, v221
    v_mfma_f32_32x32x16_bf16 v[160:175], v[196:199], v[140:143], v[160:175]
    ds_read_b64_tr_b16 v[192:193], v5 offset:4096
    ds_read_b64_tr_b16 v[194:195], v5 offset:4352
    v_mul_f32 v214, v214, v222
    v_mul_f32 v215, v215, v223
    v_cvt_pk_bf16_f32 v230, v212, v213
    v_cvt_pk_bf16_f32 v231, v214, v215
    s_add_u32 s26, s20, 1024
    buffer_store_dwordx4 v[228:231], v1, s[32:35], s26 offen sc1
    s_waitcnt lgkmcnt(6)
    v_mfma_f32_32x32x16_bf16 v[144:159], v[176:179], v[16:19], 0
    ds_read_b64_tr_b16 v[196:197], v5 offset:5120
    ds_read_b64_tr_b16 v[198:199], v5 offset:5376
    v_mfma_f32_32x32x16_bf16 v[144:159], v[180:183], v[20:23], v[144:159]
    ds_read_b64_tr_b16 v[176:177], v5 offset:6144
    ds_read_b64_tr_b16 v[178:179], v5 offset:6400
    s_waitcnt lgkmcnt(6)
    v_mfma_f32_32x32x16_bf16 v[144:159], v[184:187], v[24:27], v[144:159]
    ds_read_b64_tr_b16 v[180:181], v5 offset:7168
    ds_read_b64_tr_b16 v[182:183], v5 offset:7424
    v_mfma_f32_32x32x16_bf16 v[144:159], v[188:191], v[28:31], v[144:159]
    v_add_u32 v5, 57344, v4
    ds_read_b64_tr_b16 v[184:185], v5 offset:0
    ds_read_b64_tr_b16 v[186:187], v5 offset:256
    buffer_load_dword v14, v13, s[32:35], 0 offen sc1
    ds_read_b128 v[200:203], v8 offset:16512
    ds_read_b128 v[204:207], v8 offset:16544
    ds_read_b128 v[208:211], v8 offset:16576
    ds_read_b128 v[212:215], v8 offset:16608
    s_waitcnt lgkmcnt(3)
    v_fma_f32 v200, v160, v6, v200
    v_mfma_f32_32x32x16_bf16 v[144:159], v[192:195], v[32:35], v[144:159]
    ds_read_b64_tr_b16 v[188:189], v5 offset:1024
    ds_read_b64_tr_b16 v[190:191], v5 offset:1280
    v_fma_f32 v201, v161, v6, v201
    v_fma_f32 v202, v162, v6, v202
    v_fma_f32 v203, v163, v6, v203
    v_mul_f32 v216, v200, v200
    v_mul_f32 v217, v201, v201
    v_mul_f32 v218, v202, v202
    v_mfma_f32_32x32x16_bf16 v[144:159], v[196:199], v[36:39], v[144:159]
    ds_read_b64_tr_b16 v[192:193], v5 offset:2048
    ds_read_b64_tr_b16 v[194:195], v5 offset:2304
    v_mul_f32 v219, v203, v203
    v_fmaak_f32 v216, v216, v9, 0xc0135761
    v_fmaak_f32 v217, v217, v9, 0xc0135761
    v_fmaak_f32 v218, v218, v9, 0xc0135761
    v_fmaak_f32 v219, v219, v9, 0xc0135761
    v_mul_f32 v216, v216, v200
    v_mul_f32 v217, v217, v201
    v_mfma_f32_32x32x16_bf16 v[144:159], v[176:179], v[40:43], v[144:159]
    ds_read_b64_tr_b16 v[196:197], v5 offset:3072
    ds_read_b64_tr_b16 v[198:199], v5 offset:3328
    v_mul_f32 v218, v218, v202
    v_mul_f32 v219, v219, v203
    v_exp_f32 v216, v216
    v_exp_f32 v217, v217
    v_mfma_f32_32x32x16_bf16 v[144:159], v[180:183], v[44:47], v[144:159]
    ds_read_b32 v15, v8 offset:17960
    ds_read_b64_tr_b16 v[176:177], v5 offset:4096
    ds_read_b64_tr_b16 v[178:179], v5 offset:4352
    v_exp_f32 v218, v218
    v_exp_f32 v219, v219
    v_add_f32 v216, 1.0, v216
    v_add_f32 v217, 1.0, v217
    s_waitcnt lgkmcnt(7)
    v_mfma_f32_32x32x16_bf16 v[144:159], v[184:187], v[48:51], v[144:159]
    ds_read_b64_tr_b16 v[180:181], v5 offset:5120
    ds_read_b64_tr_b16 v[182:183], v5 offset:5376
    v_add_f32 v218, 1.0, v218
    v_add_f32 v219, 1.0, v219
    v_rcp_f32 v216, v216
    v_rcp_f32 v217, v217
    v_mfma_f32_32x32x16_bf16 v[144:159], v[188:191], v[52:55], v[144:159]
    ds_read_b64_tr_b16 v[184:185], v5 offset:6144
    ds_read_b64_tr_b16 v[186:187], v5 offset:6400
    v_rcp_f32 v218, v218
    v_rcp_f32 v219, v219
    v_mul_f32 v200, v200, v216
    v_mul_f32 v201, v201, v217
    s_waitcnt lgkmcnt(7)
    v_mfma_f32_32x32x16_bf16 v[144:159], v[192:195], v[56:59], v[144:159]
    ds_read_b64_tr_b16 v[188:189], v5 offset:7168
    ds_read_b64_tr_b16 v[190:191], v5 offset:7424
    v_mul_f32 v202, v202, v218
    v_mul_f32 v203, v203, v219
    v_cvt_pk_bf16_f32 v224, v200, v201
    v_cvt_pk_bf16_f32 v225, v202, v203
    v_fma_f32 v204, v164, v6, v204
    v_fma_f32 v205, v165, v6, v205
    v_mfma_f32_32x32x16_bf16 v[144:159], v[196:199], v[60:63], v[144:159]
    s_waitcnt lgkmcnt(8)
    s_mov_b32 s11, 0
L_lp_21:
    v_readfirstlane_b32 s12, v15
    s_add_u32 s11, s11, 1
    s_nop 0
    s_cmp_ge_u32 s12, 4
    s_cbranch_scc1 L_lok_20
    s_sleep 1
    ds_read_b32 v15, v8 offset:17960
    s_waitcnt lgkmcnt(0)
    s_cmp_lt_u32 s11, 2097152
    s_cbranch_scc1 L_lp_21
L_lok_20:
    v_add_u32 v5, 65536, v4
    ds_read_b64_tr_b16 v[192:193], v5 offset:0
    ds_read_b64_tr_b16 v[194:195], v5 offset:256
    s_waitcnt vmcnt(0)
    v_cmp_ne_u32 vcc, s10, v14
    s_nop 1
    s_cmp_eq_u64 vcc, 0
    s_cbranch_scc1 L_ok_22
    s_mov_b32 s11, 0
L_pl_23:
    buffer_load_dword v14, v13, s[32:35], 0 offen sc1
    s_waitcnt vmcnt(0)
    v_cmp_ne_u32 vcc, s10, v14
    s_add_u32 s11, s11, 1
    s_nop 0
    s_cmp_eq_u64 vcc, 0
    s_cbranch_scc1 L_pld_24
    s_sleep 4
    s_cmp_lt_u32 s11, 131072
    s_cbranch_scc1 L_pl_23
L_pld_24:
L_ok_22:
    buffer_load_dwordx4 v[248:251], v1, s[32:35], s43 offen sc1
    buffer_load_dwordx4 v[252:255], v1, s[32:35], s43 offen offset:1024 sc1
    v_fma_f32 v206, v166, v6, v206
    v_fma_f32 v207, v167, v6, v207
    v_mul_f32 v220, v204, v204
    v_mul_f32 v221, v205, v205
    v_mul_f32 v222, v206, v206
    v_mul_f32 v223, v207, v207
    s_waitcnt lgkmcnt(6)
    v_mfma_f32_32x32x16_bf16 v[144:159], v[176:179], v[64:67], v[144:159]
    ds_read_b64_tr_b16 v[196:197], v5 offset:1024
    ds_read_b64_tr_b16 v[198:199], v5 offset:1280
    buffer_store_dword v11, v12, s[32:35], s23 offen offset:0 sc1
    v_add_u32 v236, 0, v233
    v_max_i32 v236, v236, v234
    buffer_load_dwordx4 v[16:19], v236, s[32:35], s42 offen sc1
    v_fmaak_f32 v220, v220, v9, 0xc0135761
    v_fmaak_f32 v221, v221, v9, 0xc0135761
    v_fmaak_f32 v222, v222, v9, 0xc0135761
    v_fmaak_f32 v223, v223, v9, 0xc0135761
    v_mul_f32 v220, v220, v204
    v_mul_f32 v221, v221, v205
    v_mfma_f32_32x32x16_bf16 v[144:159], v[180:183], v[68:71], v[144:159]
    ds_read_b64_tr_b16 v[176:177], v5 offset:2048
    ds_read_b64_tr_b16 v[178:179], v5 offset:2304
    v_mul_f32 v222, v222, v206
    v_mul_f32 v223, v223, v207
    v_exp_f32 v220, v220
    v_exp_f32 v221, v221
    s_waitcnt lgkmcnt(6)
    v_mfma_f32_32x32x16_bf16 v[144:159], v[184:187], v[72:75], v[144:159]
    ds_read_b64_tr_b16 v[180:181], v5 offset:3072
    ds_read_b64_tr_b16 v[182:183], v5 offset:3328
    v_add_u32 v236, 8192, v233
    v_max_i32 v236, v236, v234
    buffer_load_dwordx4 v[48:51], v236, s[32:35], s42 offen sc1
    v_exp_f32 v222, v222
    v_exp_f32 v223, v223
    v_add_f32 v220, 1.0, v220
    v_add_f32 v221, 1.0, v221
    v_mfma_f32_32x32x16_bf16 v[144:159], v[188:191], v[76:79], v[144:159]
    ds_read_b64_tr_b16 v[184:185], v5 offset:4096
    ds_read_b64_tr_b16 v[186:187], v5 offset:4352
    v_add_f32 v222, 1.0, v222
    v_add_f32 v223, 1.0, v223
    v_rcp_f32 v220, v220
    v_rcp_f32 v221, v221
    s_waitcnt lgkmcnt(6)
    v_mfma_f32_32x32x16_bf16 v[144:159], v[192:195], v[80:83], v[144:159]
    ds_read_b64_tr_b16 v[188:189], v5 offset:5120
    ds_read_b64_tr_b16 v[190:191], v5 offset:5376
    v_add_u32 v237, 1024, v233
    v_max_i32 v237, v237, v234
    buffer_load_dwordx4 v[20:23], v237, s[32:35], s42 offen sc1
    v_rcp_f32 v222, v222
    v_rcp_f32 v223, v223
    v_mul_f32 v204, v204, v220
    v_mul_f32 v205, v205, v221
    v_mul_f32 v206, v206, v222
    v_mfma_f32_32x32x16_bf16 v[144:159], v[196:199], v[84:87], v[144:159]
    ds_read_b64_tr_b16 v[192:193], v5 offset:6144
    ds_read_b64_tr_b16 v[194:195], v5 offset:6400
    v_mul_f32 v207, v207, v223
    v_cvt_pk_bf16_f32 v226, v204, v205
    v_cvt_pk_bf16_f32 v227, v206, v207
    s_add_u32 s26, s20, 2048
    buffer_store_dwordx4 v[224:227], v1, s[32:35], s26 offen sc1
    s_waitcnt lgkmcnt(6)
    v_mfma_f32_32x32x16_bf16 v[144:159], v[176:179], v[88:91], v[144:159]
    ds_read_b64_tr_b16 v[196:197], v5 offset:7168
    ds_read_b64_tr_b16 v[198:199], v5 offset:7424
    v_add_u32 v238, 2048, v233
    v_max_i32 v238, v238, v234
    buffer_load_dwordx4 v[24:27], v238, s[32:35], s42 offen sc1
    v_fma_f32 v208, v168, v6, v208
    v_fma_f32 v209, v169, v6, v209
    v_fma_f32 v210, v170, v6, v210
    v_fma_f32 v211, v171, v6, v211
    v_mul_f32 v216, v208, v208
    v_mul_f32 v217, v209, v209
    v_mfma_f32_32x32x16_bf16 v[144:159], v[180:183], v[92:95], v[144:159]
    v_add_u32 v5, 73728, v4
    ds_read_b64_tr_b16 v[176:177], v5 offset:0
    ds_read_b64_tr_b16 v[178:179], v5 offset:256
    v_mul_f32 v218, v210, v210
    v_mul_f32 v219, v211, v211
    v_fmaak_f32 v216, v216, v9, 0xc0135761
    v_fmaak_f32 v217, v217, v9, 0xc0135761
    v_fmaak_f32 v218, v218, v9, 0xc0135761
    v_fmaak_f32 v219, v219, v9, 0xc0135761
    v_mul_f32 v216, v216, v208
    s_waitcnt lgkmcnt(6)
    v_mfma_f32_32x32x16_bf16 v[144:159], v[184:187], v[96:99], v[144:159]
    ds_read_b64_tr_b16 v[180:181], v5 offset:1024
    ds_read_b64_tr_b16 v[182:183], v5 offset:1280
    v_add_u32 v239, 3072, v233
    v_max_i32 v239, v239, v234
    buffer_load_dwordx4 v[28:31], v239, s[32:35], s42 offen sc1
    v_mul_f32 v217, v217, v209
    v_mul_f32 v218, v218, v210
    v_mul_f32 v219, v219, v211
    v_exp_f32 v216, v216
    v_mfma_f32_32x32x16_bf16 v[144:159], v[188:191], v[100:103], v[144:159]
    ds_read_b64_tr_b16 v[184:185], v5 offset:2048
    ds_read_b64_tr_b16 v[186:187], v5 offset:2304
    v_exp_f32 v217, v217
    v_exp_f32 v218, v218
    v_exp_f32 v219, v219
    v_add_f32 v216, 1.0, v216
    s_waitcnt lgkmcnt(6)
    v_mfma_f32_32x32x16_bf16 v[144:159], v[192:195], v[104:107], v[144:159]
    ds_read_b64_tr_b16 v[188:189], v5 offset:3072
    ds_read_b64_tr_b16 v[190:191], v5 offset:3328
    v_add_u32 v236, 4096, v233
    v_max_i32 v236, v236, v234
    buffer_load_dwordx4 v[32:35], v236, s[32:35], s42 offen sc1
    v_add_f32 v217, 1.0, v217
    v_add_f32 v218, 1.0, v218
    v_add_f32 v219, 1.0, v219
    v_rcp_f32 v216, v216
    v_mfma_f32_32x32x16_bf16 v[144:159], v[196:199], v[108:111], v[144:159]
    ds_read_b64_tr_b16 v[192:193], v5 offset:4096
    ds_read_b64_tr_b16 v[194:195], v5 offset:4352
    v_rcp_f32 v217, v217
    v_rcp_f32 v218, v218
    v_rcp_f32 v219, v219
    v_mul_f32 v208, v208, v216
    s_waitcnt lgkmcnt(6)
    v_mfma_f32_32x32x16_bf16 v[144:159], v[176:179], v[112:115], v[144:159]
    ds_read_b64_tr_b16 v[196:197], v5 offset:5120
    ds_read_b64_tr_b16 v[198:199], v5 offset:5376
    v_add_u32 v237, 5120, v233
    v_max_i32 v237, v237, v234
    buffer_load_dwordx4 v[36:39], v237, s[32:35], s42 offen sc1
    v_mul_f32 v209, v209, v217
    v_mul_f32 v210, v210, v218
    v_mul_f32 v211, v211, v219
    v_cvt_pk_bf16_f32 v228, v208, v209
    v_cvt_pk_bf16_f32 v229, v210, v211
    v_fma_f32 v212, v172, v6, v212
    v_mfma_f32_32x32x16_bf16 v[144:159], v[180:183], v[116:119], v[144:159]
    ds_read_b64_tr_b16 v[176:177], v5 offset:6144
    ds_read_b64_tr_b16 v[178:179], v5 offset:6400
    v_fma_f32 v213, v173, v6, v213
    v_fma_f32 v214, v174, v6, v214
    v_fma_f32 v215, v175, v6, v215
    v_mul_f32 v220, v212, v212
    v_mul_f32 v221, v213, v213
    v_mul_f32 v222, v214, v214
    s_waitcnt lgkmcnt(6)
    v_mfma_f32_32x32x16_bf16 v[144:159], v[184:187], v[120:123], v[144:159]
    ds_read_b64_tr_b16 v[180:181], v5 offset:7168
    ds_read_b64_tr_b16 v[182:183], v5 offset:7424
    v_add_u32 v238, 6144, v233
    v_max_i32 v238, v238, v234
    buffer_load_dwordx4 v[40:43], v238, s[32:35], s42 offen sc1
    v_mul_f32 v223, v215, v215
    v_fmaak_f32 v220, v220, v9, 0xc0135761
    v_fmaak_f32 v221, v221, v9, 0xc0135761
    v_fmaak_f32 v222, v222, v9, 0xc0135761
    v_fmaak_f32 v223, v223, v9, 0xc0135761
    v_mul_f32 v220, v220, v212
    v_mfma_f32_32x32x16_bf16 v[144:159], v[188:191], v[124:127], v[144:159]
    v_mul_f32 v221, v221, v213
    v_mul_f32 v222, v222, v214
    v_mul_f32 v223, v223, v215
    v_exp_f32 v220, v220
    s_waitcnt lgkmcnt(4)
    v_mfma_f32_32x32x16_bf16 v[144:159], v[192:195], v[128:131], v[144:159]
    v_add_u32 v239, 7168, v233
    v_max_i32 v239, v239, v234
    buffer_load_dwordx4 v[44:47], v239, s[32:35], s42 offen sc1
    v_exp_f32 v221, v221
    v_exp_f32 v222, v222
    v_exp_f32 v223, v223
    v_add_f32 v220, 1.0, v220
    v_mfma_f32_32x32x16_bf16 v[144:159], v[196:199], v[132:135], v[144:159]
    v_add_f32 v221, 1.0, v221
    v_add_f32 v222, 1.0, v222
    v_add_f32 v223, 1.0, v223
    v_rcp_f32 v220, v220
    v_rcp_f32 v221, v221
    s_waitcnt lgkmcnt(0)
    v_mfma_f32_32x32x16_bf16 v[144:159], v[176:179], v[136:139], v[144:159]
    v_add_u32 v237, 9216, v233
    v_max_i32 v237, v237, v234
    buffer_load_dwordx4 v[52:55], v237, s[32:35], s42 offen sc1
    v_rcp_f32 v222, v222
    v_rcp_f32 v223, v223
    v_mul_f32 v212, v212, v220
    v_mul_f32 v213, v213, v221
    v_mfma_f32_32x32x16_bf16 v[144:159], v[180:183], v[140:143], v[144:159]
    v_mul_f32 v214, v214, v222
    v_mul_f32 v215, v215, v223
    v_cvt_pk_bf16_f32 v230, v212, v213
    v_cvt_pk_bf16_f32 v231, v214, v215
    s_add_u32 s26, s20, 3072
    buffer_store_dwordx4 v[228:231], v1, s[32:35], s26 offen sc1
    ds_read_b128 v[200:203], v8 offset:16640
    ds_read_b128 v[204:207], v8 offset:16672
    ds_read_b128 v[208:211], v8 offset:16704
    ds_read_b128 v[212:215], v8 offset:16736
    s_waitcnt lgkmcnt(3)
    s_nop 0
    v_fma_f32 v200, v144, v6, v200
    v_fma_f32 v201, v145, v6, v201
    v_fma_f32 v202, v146, v6, v202
    v_fma_f32 v203, v147, v6, v203
    v_mul_f32 v216, v200, v200
    v_mul_f32 v217, v201, v201
    v_mul_f32 v218, v202, v202
    v_mul_f32 v219, v203, v203
    v_fmaak_f32 v216, v216, v9, 0xc0135761
    v_fmaak_f32 v217, v217, v9, 0xc0135761
    v_fmaak_f32 v218, v218, v9, 0xc0135761
    v_fmaak_f32 v219, v219, v9, 0xc0135761
    v_mul_f32 v216, v216, v200
    v_mul_f32 v217, v217, v201
    v_mul_f32 v218, v218, v202
    v_mul_f32 v219, v219, v203
    v_exp_f32 v216, v216
    v_exp_f32 v217, v217
    v_exp_f32 v218, v218
    v_exp_f32 v219, v219
    v_add_f32 v216, 1.0, v216
    v_add_f32 v217, 1.0, v217
    v_add_f32 v218, 1.0, v218
    v_add_f32 v219, 1.0, v219
    v_rcp_f32 v216, v216
    v_rcp_f32 v217, v217
    v_rcp_f32 v218, v218
    v_rcp_f32 v219, v219
    v_mul_f32 v200, v200, v216
    v_mul_f32 v201, v201, v217
    v_mul_f32 v202, v202, v218
    v_mul_f32 v203, v203, v219
    v_cvt_pk_bf16_f32 v224, v200, v201
    v_cvt_pk_bf16_f32 v225, v202, v203
    s_waitcnt lgkmcnt(2)
    v_fma_f32 v204, v148, v6, v204
    v_fma_f32 v205, v149, v6, v205
    v_fma_f32 v206, v150, v6, v206
    v_fma_f32 v207, v151, v6, v207
    v_mul_f32 v220, v204, v204
    v_mul_f32 v221, v205, v205
    v_mul_f32 v222, v206, v206
    v_mul_f32 v223, v207, v207
    v_fmaak_f32 v220, v220, v9, 0xc0135761
    v_fmaak_f32 v221, v221, v9, 0xc0135761
    v_fmaak_f32 v222, v222, v9, 0xc0135761
    v_fmaak_f32 v223, v223, v9, 0xc0135761
    v_mul_f32 v220, v220, v204
    v_mul_f32 v221, v221, v205
    v_mul_f32 v222, v222, v206
    v_mul_f32 v223, v223, v207
    v_exp_f32 v220, v220
    v_exp_f32 v221, v221
    v_exp_f32 v222, v222
    v_exp_f32 v223, v223
    v_add_f32 v220, 1.0, v220
    v_add_f32 v221, 1.0, v221
    v_add_f32 v222, 1.0, v222
    v_add_f32 v223, 1.0, v223
    v_rcp_f32 v220, v220
    v_rcp_f32 v221, v221
    v_rcp_f32 v222, v222
    v_rcp_f32 v223, v223
    v_mul_f32 v204, v204, v220
    v_mul_f32 v205, v205, v221
    s_waitcnt vmcnt(0)
    buffer_store_dword v11, v12, s[32:35], s23 offen offset:4 sc1
    v_mul_f32 v206, v206, v222
    v_mul_f32 v207, v207, v223
    v_cvt_pk_bf16_f32 v226, v204, v205
    v_cvt_pk_bf16_f32 v227, v206, v207
    s_add_u32 s26, s21, 0
    buffer_store_dwordx4 v[224:227], v1, s[32:35], s26 offen sc1
    s_waitcnt lgkmcnt(1)
    v_fma_f32 v208, v152, v6, v208
    v_fma_f32 v209, v153, v6, v209
    v_fma_f32 v210, v154, v6, v210
    v_fma_f32 v211, v155, v6, v211
    v_mul_f32 v216, v208, v208
    v_mul_f32 v217, v209, v209
    v_mul_f32 v218, v210, v210
    v_mul_f32 v219, v211, v211
    v_fmaak_f32 v216, v216, v9, 0xc0135761
    v_fmaak_f32 v217, v217, v9, 0xc0135761
    v_fmaak_f32 v218, v218, v9, 0xc0135761
    v_fmaak_f32 v219, v219, v9, 0xc0135761
    v_mul_f32 v216, v216, v208
    v_mul_f32 v217, v217, v209
    v_mul_f32 v218, v218, v210
    v_mul_f32 v219, v219, v211
    v_exp_f32 v216, v216
    v_exp_f32 v217, v217
    v_exp_f32 v218, v218
    v_exp_f32 v219, v219
    v_add_f32 v216, 1.0, v216
    v_add_f32 v217, 1.0, v217
    v_add_f32 v218, 1.0, v218
    v_add_f32 v219, 1.0, v219
    v_rcp_f32 v216, v216
    v_rcp_f32 v217, v217
    v_rcp_f32 v218, v218
    v_rcp_f32 v219, v219
    v_mul_f32 v208, v208, v216
    v_mul_f32 v209, v209, v217
    v_mul_f32 v210, v210, v218
    v_mul_f32 v211, v211, v219
    v_cvt_pk_bf16_f32 v228, v208, v209
    v_cvt_pk_bf16_f32 v229, v210, v211
    s_waitcnt lgkmcnt(0)
    v_fma_f32 v212, v156, v6, v212
    v_fma_f32 v213, v157, v6, v213
    v_fma_f32 v214, v158, v6, v214
    v_fma_f32 v215, v159, v6, v215
    v_mul_f32 v220, v212, v212
    v_mul_f32 v221, v213, v213
    v_mul_f32 v222, v214, v214
    v_mul_f32 v223, v215, v215
    v_fmaak_f32 v220, v220, v9, 0xc0135761
    v_fmaak_f32 v221, v221, v9, 0xc0135761
    v_fmaak_f32 v222, v222, v9, 0xc0135761
    v_fmaak_f32 v223, v223, v9, 0xc0135761
    v_mul_f32 v220, v220, v212
    v_mul_f32 v221, v221, v213
    v_mul_f32 v222, v222, v214
    v_mul_f32 v223, v223, v215
    v_exp_f32 v220, v220
    v_exp_f32 v221, v221
    v_exp_f32 v222, v222
    v_exp_f32 v223, v223
    v_add_f32 v220, 1.0, v220
    v_add_f32 v221, 1.0, v221
    v_add_f32 v222, 1.0, v222
    v_add_f32 v223, 1.0, v223
    v_rcp_f32 v220, v220
    v_rcp_f32 v221, v221
    v_rcp_f32 v222, v222
    v_rcp_f32 v223, v223
    v_mul_f32 v212, v212, v220
    v_mul_f32 v213, v213, v221
    v_mul_f32 v214, v214, v222
    v_mul_f32 v215, v215, v223
    v_cvt_pk_bf16_f32 v230, v212, v213
    v_cvt_pk_bf16_f32 v231, v214, v215
    s_add_u32 s26, s21, 1024
    buffer_store_dwordx4 v[228:231], v1, s[32:35], s26 offen sc1
    s_add_u32 s23, s23, 8
    s_branch L_attn
L_cB:
    s_nop 4
    ds_read_b32 v15, v8 offset:17964
    s_waitcnt lgkmcnt(0)
    s_mov_b32 s11, 0
L_lp_26:
    v_readfirstlane_b32 s12, v15
    s_add_u32 s11, s11, 1
    s_nop 0
    s_cmp_ge_u32 s12, 4
    s_cbranch_scc1 L_lok_25
    s_sleep 1
    ds_read_b32 v15, v8 offset:17964
    s_waitcnt lgkmcnt(0)
    s_cmp_lt_u32 s11, 2097152
    s_cbranch_scc1 L_lp_26
L_lok_25:
    v_add_u32 v5, 0, v2
    ds_read_b64_tr_b16 v[176:177], v5 offset:0
    ds_read_b64_tr_b16 v[178:179], v5 offset:512
    ds_read_b64_tr_b16 v[180:181], v5 offset:2048
    ds_read_b64_tr_b16 v[182:183], v5 offset:2560
    ds_read_b64_tr_b16 v[184:185], v5 offset:4096
    ds_read_b64_tr_b16 v[186:187], v5 offset:4608
    ds_read_b64_tr_b16 v[188:189], v5 offset:6144
    ds_read_b64_tr_b16 v[190:191], v5 offset:6656
    ds_read_b32 v15, v8 offset:17920
    ds_read_b64_tr_b16 v[192:193], v5 offset:8192
    ds_read_b64_tr_b16 v[194:195], v5 offset:8704
    s_waitcnt lgkmcnt(7)
    v_mfma_f32_32x32x16_bf16 v[144:159], v[16:19], v[176:179], 0
    ds_read_b64_tr_b16 v[196:197], v5 offset:10240
    ds_read_b64_tr_b16 v[198:199], v5 offset:10752
    v_mfma_f32_32x32x16_bf16 v[144:159], v[20:23], v[180:183], v[144:159]
    ds_read_b64_tr_b16 v[176:177], v5 offset:12288
    ds_read_b64_tr_b16 v[178:179], v5 offset:12800
    s_waitcnt lgkmcnt(7)
    v_mfma_f32_32x32x16_bf16 v[144:159], v[24:27], v[184:187], v[144:159]
    ds_read_b64_tr_b16 v[180:181], v5 offset:14336
    ds_read_b64_tr_b16 v[182:183], v5 offset:14848
    v_mfma_f32_32x32x16_bf16 v[144:159], v[28:31], v[188:191], v[144:159]
    s_waitcnt lgkmcnt(8)
    s_mov_b32 s11, 0
L_lp_28:
    v_readfirstlane_b32 s12, v15
    s_add_u32 s11, s11, 1
    s_nop 0
    s_cmp_ge_u32 s12, 4
    s_cbranch_scc1 L_lok_27
    s_sleep 1
    ds_read_b32 v15, v8 offset:17920
    s_waitcnt lgkmcnt(0)
    s_cmp_lt_u32 s11, 2097152
    s_cbranch_scc1 L_lp_28
L_lok_27:
    v_add_u32 v5, 16384, v2
    ds_read_b64_tr_b16 v[184:185], v5 offset:0
    ds_read_b64_tr_b16 v[186:187], v5 offset:512
    s_waitcnt lgkmcnt(6)
    v_mfma_f32_32x32x16_bf16 v[144:159], v[32:35], v[192:195], v[144:159]
    ds_read_b64_tr_b16 v[188:189], v5 offset:2048
    ds_read_b64_tr_b16 v[190:191], v5 offset:2560
    v_mfma_f32_32x32x16_bf16 v[144:159], v[36:39], v[196:199], v[144:159]
    ds_read_b64_tr_b16 v[192:193], v5 offset:4096
    ds_read_b64_tr_b16 v[194:195], v5 offset:4608
    s_waitcnt lgkmcnt(6)
    v_mfma_f32_32x32x16_bf16 v[144:159], v[40:43], v[176:179], v[144:159]
    ds_read_b64_tr_b16 v[196:197], v5 offset:6144
    ds_read_b64_tr_b16 v[198:199], v5 offset:6656
    v_mfma_f32_32x32x16_bf16 v[144:159], v[44:47], v[180:183], v[144:159]
    ds_read_b32 v15, v8 offset:17924
    ds_read_b64_tr_b16 v[176:177], v5 offset:8192
    ds_read_b64_tr_b16 v[178:179], v5 offset:8704
    s_waitcnt lgkmcnt(7)
    v_mfma_f32_32x32x16_bf16 v[144:159], v[48:51], v[184:187], v[144:159]
    ds_read_b64_tr_b16 v[180:181], v5 offset:10240
    ds_read_b64_tr_b16 v[182:183], v5 offset:10752
    v_mfma_f32_32x32x16_bf16 v[144:159], v[52:55], v[188:191], v[144:159]
    ds_read_b64_tr_b16 v[184:185], v5 offset:12288
    ds_read_b64_tr_b16 v[186:187], v5 offset:12800
    s_waitcnt lgkmcnt(7)
    v_mfma_f32_32x32x16_bf16 v[144:159], v[56:59], v[192:195], v[144:159]
    ds_read_b64_tr_b16 v[188:189], v5 offset:14336
    ds_read_b64_tr_b16 v[190:191], v5 offset:14848
    v_mfma_f32_32x32x16_bf16 v[144:159], v[60:63], v[196:199], v[144:159]
    s_waitcnt lgkmcnt(8)
    s_mov_b32 s11, 0
L_lp_30:
    v_readfirstlane_b32 s12, v15
    s_add_u32 s11, s11, 1
    s_nop 0
    s_cmp_ge_u32 s12, 4
    s_cbranch_scc1 L_lok_29
    s_sleep 1
    ds_read_b32 v15, v8 offset:17924
    s_waitcnt lgkmcnt(0)
    s_cmp_lt_u32 s11, 2097152
    s_cbranch_scc1 L_lp_30
L_lok_29:
    v_add_u32 v5, 32768, v2
    ds_read_b64_tr_b16 v[192:193], v5 offset:0
    ds_read_b64_tr_b16 v[194:195], v5 offset:512
    s_waitcnt lgkmcnt(6)
    v_mfma_f32_32x32x16_bf16 v[144:159], v[64:67], v[176:179], v[144:159]
    ds_read_b64_tr_b16 v[196:197], v5 offset:2048
    ds_read_b64_tr_b16 v[198:199], v5 offset:2560
    v_mfma_f32_32x32x16_bf16 v[144:159], v[68:71], v[180:183], v[144:159]
    ds_read_b64_tr_b16 v[176:177], v5 offset:4096
    ds_read_b64_tr_b16 v[178:179], v5 offset:4608
    s_waitcnt lgkmcnt(6)
    v_mfma_f32_32x32x16_bf16 v[144:159], v[72:75], v[184:187], v[144:159]
    ds_read_b64_tr_b16 v[180:181], v5 offset:6144
    ds_read_b64_tr_b16 v[182:183], v5 offset:6656
    v_mfma_f32_32x32x16_bf16 v[144:159], v[76:79], v[188:191], v[144:159]
    ds_read_b64_tr_b16 v[184:185], v5 offset:8192
    ds_read_b64_tr_b16 v[186:187], v5 offset:8704
    s_waitcnt lgkmcnt(6)
    v_mfma_f32_32x32x16_bf16 v[144:159], v[80:83], v[192:195], v[144:159]
    ds_read_b64_tr_b16 v[188:189], v5 offset:10240
    ds_read_b64_tr_b16 v[190:191], v5 offset:10752
    v_mfma_f32_32x32x16_bf16 v[144:159], v[84:87], v[196:199], v[144:159]
    ds_read_b64_tr_b16 v[192:193], v5 offset:12288
    ds_read_b64_tr_b16 v[194:195], v5 offset:12800
    s_waitcnt lgkmcnt(6)
    v_mfma_f32_32x32x16_bf16 v[144:159], v[88:91], v[176:179], v[144:159]
    ds_read_b64_tr_b16 v[196:197], v5 offset:14336
    ds_read_b64_tr_b16 v[198:199], v5 offset:14848
    v_mfma_f32_32x32x16_bf16 v[144:159], v[92:95], v[180:183], v[144:159]
    v_add_u32 v5, 49152, v2
    ds_read_b64_tr_b16 v[176:177], v5 offset:0
    ds_read_b64_tr_b16 v[178:179], v5 offset:512
    s_waitcnt lgkmcnt(6)
    v_mfma_f32_32x32x16_bf16 v[144:159], v[96:99], v[184:187], v[144:159]
    ds_read_b64_tr_b16 v[180:181], v5 offset:2048
    ds_read_b64_tr_b16 v[182:183], v5 offset:2560
    v_mfma_f32_32x32x16_bf16 v[144:159], v[100:103], v[188:191], v[144:159]
    ds_read_b64_tr_b16 v[184:185], v5 offset:4096
    ds_read_b64_tr_b16 v[186:187], v5 offset:4608
    s_waitcnt lgkmcnt(6)
    v_mfma_f32_32x32x16_bf16 v[144:159], v[104:107], v[192:195], v[144:159]
    ds_read_b64_tr_b16 v[188:189], v5 offset:6144
    ds_read_b64_tr_b16 v[190:191], v5 offset:6656
    v_mfma_f32_32x32x16_bf16 v[144:159], v[108:111], v[196:199], v[144:159]
    ds_read_b64_tr_b16 v[192:193], v5 offset:8192
    ds_read_b64_tr_b16 v[194:195], v5 offset:8704
    s_waitcnt lgkmcnt(6)
    v_mfma_f32_32x32x16_bf16 v[144:159], v[112:115], v[176:179], v[144:159]
    ds_read_b64_tr_b16 v[196:197], v5 offset:10240
    ds_read_b64_tr_b16 v[198:199], v5 offset:10752
    v_mfma_f32_32x32x16_bf16 v[144:159], v[116:119], v[180:183], v[144:159]
    ds_read_b64_tr_b16 v[176:177], v5 offset:12288
    ds_read_b64_tr_b16 v[178:179], v5 offset:12800
    s_waitcnt lgkmcnt(6)
    v_mfma_f32_32x32x16_bf16 v[144:159], v[120:123], v[184:187], v[144:159]
    ds_read_b64_tr_b16 v[180:181], v5 offset:14336
    ds_read_b64_tr_b16 v[182:183], v5 offset:14848
    v_mfma_f32_32x32x16_bf16 v[144:159], v[124:127], v[188:191], v[144:159]
    v_add_u32 v5, 0, v3
    ds_read_b64_tr_b16 v[184:185], v5 offset:0
    ds_read_b64_tr_b16 v[186:187], v5 offset:512
    s_waitcnt lgkmcnt(6)
    v_mfma_f32_32x32x16_bf16 v[144:159], v[128:131], v[192:195], v[144:159]
    ds_read_b64_tr_b16 v[188:189], v5 offset:2048
    ds_read_b64_tr_b16 v[190:191], v5 offset:2560
    v_mfma_f32_32x32x16_bf16 v[144:159], v[132:135], v[196:199], v[144:159]
    ds_read_b64_tr_b16 v[192:193], v5 offset:4096
    ds_read_b64_tr_b16 v[194:195], v5 offset:4608
    s_waitcnt lgkmcnt(6)
    v_mfma_f32_32x32x16_bf16 v[144:159], v[136:139], v[176:179], v[144:159]
    ds_read_b64_tr_b16 v[196:197], v5 offset:6144
    ds_read_b64_tr_b16 v[198:199], v5 offset:6656
    v_mfma_f32_32x32x16_bf16 v[144:159], v[140:143], v[180:183], v[144:159]
    ds_read_b64_tr_b16 v[176:177], v5 offset:8192
    ds_read_b64_tr_b16 v[178:179], v5 offset:8704
    s_waitcnt lgkmcnt(6)
    v_mfma_f32_32x32x16_bf16 v[160:175], v[16:19], v[184:187], 0
    ds_read_b64_tr_b16 v[180:181], v5 offset:10240
    ds_read_b64_tr_b16 v[182:183], v5 offset:10752
    buffer_load_dword v14, v12, s[36:39], 0 offen sc1
    v_mfma_f32_32x32x16_bf16 v[160:175], v[20:23], v[188:191], v[160:175]
    ds_read_b64_tr_b16 v[184:185], v5 offset:12288
    ds_read_b64_tr_b16 v[186:187], v5 offset:12800
    s_waitcnt lgkmcnt(6)
    v_mfma_f32_32x32x16_bf16 v[160:175], v[24:27], v[192:195], v[160:175]
    ds_read_b64_tr_b16 v[188:189], v5 offset:14336
    ds_read_b64_tr_b16 v[190:191], v5 offset:14848
    v_mfma_f32_32x32x16_bf16 v[160:175], v[28:31], v[196:199], v[160:175]
    v_add_u32 v5, 16384, v3
    ds_read_b64_tr_b16 v[192:193], v5 offset:0
    ds_read_b64_tr_b16 v[194:195], v5 offset:512
    ds_read_b128 v[200:203], v10 offset:0
    ds_read_b128 v[204:207], v10 offset:32
    ds_read_b128 v[208:211], v10 offset:64
    ds_read_b128 v[212:215], v10 offset:96
    s_waitcnt lgkmcnt(10)
    v_mfma_f32_32x32x16_bf16 v[160:175], v[32:35], v[176:179], v[160:175]
    ds_read_b64_tr_b16 v[196:197], v5 offset:2048
    ds_read_b64_tr_b16 v[198:199], v5 offset:2560
    s_waitcnt lgkmcnt(4)
    v_mul_f32 v200, v200, v144
    v_mul_f32 v201, v201, v145
    v_mul_f32 v202, v202, v146
    v_mfma_f32_32x32x16_bf16 v[160:175], v[36:39], v[180:183], v[160:175]
    ds_read_b64_tr_b16 v[176:177], v5 offset:4096
    ds_read_b64_tr_b16 v[178:179], v5 offset:4608
    v_mul_f32 v203, v203, v147
    v_mul_f32 v204, v204, v148
    v_mul_f32 v205, v205, v149
    v_mfma_f32_32x32x16_bf16 v[160:175], v[40:43], v[184:187], v[160:175]
    ds_read_b64_tr_b16 v[180:181], v5 offset:6144
    ds_read_b64_tr_b16 v[182:183], v5 offset:6656
    v_mul_f32 v206, v206, v150
    v_mul_f32 v207, v207, v151
    v_cvt_pk_bf16_f32 v224, v200, v201
    v_cvt_pk_bf16_f32 v225, v202, v203
    v_mfma_f32_32x32x16_bf16 v[160:175], v[44:47], v[188:191], v[160:175]
    ds_read_b64_tr_b16 v[184:185], v5 offset:8192
    ds_read_b64_tr_b16 v[186:187], v5 offset:8704
    v_cvt_pk_bf16_f32 v226, v204, v205
    v_cvt_pk_bf16_f32 v227, v206, v207
    s_add_u32 s26, s18, 0
    buffer_store_dwordx4 v[224:227], v1, s[32:35], s26 offen sc1
    s_waitcnt lgkmcnt(6)
    v_mfma_f32_32x32x16_bf16 v[160:175], v[48:51], v[192:195], v[160:175]
    ds_read_b64_tr_b16 v[188:189], v5 offset:10240
    ds_read_b64_tr_b16 v[190:191], v5 offset:10752
    v_mul_f32 v208, v208, v152
    v_mul_f32 v209, v209, v153
    v_mul_f32 v210, v210, v154
    v_mfma_f32_32x32x16_bf16 v[160:175], v[52:55], v[196:199], v[160:175]
    ds_read_b64_tr_b16 v[192:193], v5 offset:12288
    ds_read_b64_tr_b16 v[194:195], v5 offset:12800
    v_mul_f32 v211, v211, v155
    v_mul_f32 v212, v212, v156
    v_mul_f32 v213, v213, v157
    s_waitcnt lgkmcnt(6)
    v_mfma_f32_32x32x16_bf16 v[160:175], v[56:59], v[176:179], v[160:175]
    ds_read_b64_tr_b16 v[196:197], v5 offset:14336
    ds_read_b64_tr_b16 v[198:199], v5 offset:14848
    v_mul_f32 v214, v214, v158
    v_mul_f32 v215, v215, v159
    v_cvt_pk_bf16_f32 v228, v208, v209
    v_cvt_pk_bf16_f32 v229, v210, v211
    v_mfma_f32_32x32x16_bf16 v[160:175], v[60:63], v[180:183], v[160:175]
    v_add_u32 v5, 32768, v3
    ds_read_b64_tr_b16 v[176:177], v5 offset:0
    ds_read_b64_tr_b16 v[178:179], v5 offset:512
    v_cvt_pk_bf16_f32 v230, v212, v213
    v_cvt_pk_bf16_f32 v231, v214, v215
    s_add_u32 s26, s18, 1024
    buffer_store_dwordx4 v[228:231], v1, s[32:35], s26 offen sc1
    s_waitcnt lgkmcnt(6)
    v_mfma_f32_32x32x16_bf16 v[160:175], v[64:67], v[184:187], v[160:175]
    ds_read_b64_tr_b16 v[180:181], v5 offset:2048
    ds_read_b64_tr_b16 v[182:183], v5 offset:2560
    v_and_b32 v237, 31, v0
    v_lshrrev_b32 v238, 5, v0
    v_mfma_f32_32x32x16_bf16 v[160:175], v[68:71], v[188:191], v[160:175]
    ds_read_b64_tr_b16 v[184:185], v5 offset:4096
    ds_read_b64_tr_b16 v[186:187], v5 offset:4608
    v_lshlrev_b32 v238, 2, v238
    v_sub_u32 v237, v237, v238
    v_cmp_le_i32 s[64:65], 0, v237
    s_waitcnt lgkmcnt(6)
    v_mfma_f32_32x32x16_bf16 v[160:175], v[72:75], v[192:195], v[160:175]
    ds_read_b64_tr_b16 v[188:189], v5 offset:6144
    ds_read_b64_tr_b16 v[190:191], v5 offset:6656
    v_cmp_le_i32 s[66:67], 1, v237
    v_cmp_le_i32 s[68:69], 2, v237
    v_mfma_f32_32x32x16_bf16 v[160:175], v[76:79], v[196:199], v[160:175]
    ds_read_b64_tr_b16 v[192:193], v5 offset:8192
    ds_read_b64_tr_b16 v[194:195], v5 offset:8704
    v_cmp_le_i32 s[70:71], 3, v237
    v_cmp_le_i32 s[72:73], 8, v237
    s_waitcnt lgkmcnt(6)
    v_mfma_f32_32x32x16_bf16 v[160:175], v[80:83], v[176:179], v[160:175]
    ds_read_b64_tr_b16 v[196:197], v5 offset:10240
    ds_read_b64_tr_b16 v[198:199], v5 offset:10752
    v_cmp_le_i32 s[74:75], 9, v237
    v_cmp_le_i32 s[76:77], 10, v237
    v_cmp_le_i32 s[78:79], 11, v237
    v_mfma_f32_32x32x16_bf16 v[160:175], v[84:87], v[180:183], v[160:175]
    ds_read_b64_tr_b16 v[176:177], v5 offset:12288
    ds_read_b64_tr_b16 v[178:179], v5 offset:12800
    v_cmp_le_i32 s[80:81], 16, v237
    v_cmp_le_i32 s[82:83], 17, v237
    s_waitcnt lgkmcnt(6)
    v_mfma_f32_32x32x16_bf16 v[160:175], v[88:91], v[184:187], v[160:175]
    ds_read_b64_tr_b16 v[180:181], v5 offset:14336
    ds_read_b64_tr_b16 v[182:183], v5 offset:14848
    v_cmp_le_i32 s[84:85], 18, v237
    v_cmp_le_i32 s[86:87], 19, v237
    v_mfma_f32_32x32x16_bf16 v[160:175], v[92:95], v[188:191], v[160:175]
    v_add_u32 v5, 49152, v3
    ds_read_b64_tr_b16 v[184:185], v5 offset:0
    ds_read_b64_tr_b16 v[186:187], v5 offset:512
    v_cmp_le_i32 s[88:89], 24, v237
    v_cmp_le_i32 s[90:91], 25, v237
    s_waitcnt lgkmcnt(6)
    v_mfma_f32_32x32x16_bf16 v[160:175], v[96:99], v[192:195], v[160:175]
    ds_read_b64_tr_b16 v[188:189], v5 offset:2048
    ds_read_b64_tr_b16 v[190:191], v5 offset:2560
    v_cmp_le_i32 s[92:93], 26, v237
    v_cmp_le_i32 s[94:95], 27, v237
    v_mov_b32 v238, 0xffff
    v_mfma_f32_32x32x16_bf16 v[160:175], v[100:103], v[196:199], v[160:175]
    ds_read_b64_tr_b16 v[192:193], v5 offset:4096
    ds_read_b64_tr_b16 v[194:195], v5 offset:4608
    v_mov_b32 v239, 0xffff0000
    v_cndmask_b32 v240, 0, v238, s[64:65]
    s_waitcnt lgkmcnt(6)
    v_mfma_f32_32x32x16_bf16 v[160:175], v[104:107], v[176:179], v[160:175]
    ds_read_b64_tr_b16 v[196:197], v5 offset:6144
    ds_read_b64_tr_b16 v[198:199], v5 offset:6656
    v_cndmask_b32 v248, 0, v239, s[66:67]
    v_or_b32 v240, v240, v248
    v_mfma_f32_32x32x16_bf16 v[160:175], v[108:111], v[180:183], v[160:175]
    ds_read_b32 v15, v8 offset:17928
    ds_read_b64_tr_b16 v[176:177], v5 offset:8192
    ds_read_b64_tr_b16 v[178:179], v5 offset:8704
    v_cndmask_b32 v241, 0, v238, s[68:69]
    v_cndmask_b32 v248, 0, v239, s[70:71]
    v_or_b32 v241, v241, v248
    s_waitcnt lgkmcnt(7)
    v_mfma_f32_32x32x16_bf16 v[160:175], v[112:115], v[184:187], v[160:175]
    ds_read_b64_tr_b16 v[180:181], v5 offset:10240
    ds_read_b64_tr_b16 v[182:183], v5 offset:10752
    v_cndmask_b32 v242, 0, v238, s[72:73]
    v_cndmask_b32 v248, 0, v239, s[74:75]
    v_mfma_f32_32x32x16_bf16 v[160:175], v[116:119], v[188:191], v[160:175]
    ds_read_b64_tr_b16 v[184:185], v5 offset:12288
    ds_read_b64_tr_b16 v[186:187], v5 offset:12800
    v_or_b32 v242, v242, v248
    v_cndmask_b32 v243, 0, v238, s[76:77]
    s_waitcnt lgkmcnt(7)
    v_mfma_f32_32x32x16_bf16 v[160:175], v[120:123], v[192:195], v[160:175]
    ds_read_b64_tr_b16 v[188:189], v5 offset:14336
    ds_read_b64_tr_b16 v[190:191], v5 offset:14848
    v_cndmask_b32 v248, 0, v239, s[78:79]
    v_or_b32 v243, v243, v248
    v_cndmask_b32 v244, 0, v238, s[80:81]
    v_mfma_f32_32x32x16_bf16 v[160:175], v[124:127], v[196:199], v[160:175]
    s_waitcnt lgkmcnt(8)
    s_mov_b32 s11, 0
L_lp_32:
    v_readfirstlane_b32 s12, v15
    s_add_u32 s11, s11, 1
    s_nop 0
    s_cmp_ge_u32 s12, 4
    s_cbranch_scc1 L_lok_31
    s_sleep 1
    ds_read_b32 v15, v8 offset:17928
    s_waitcnt lgkmcnt(0)
    s_cmp_lt_u32 s11, 2097152
    s_cbranch_scc1 L_lp_32
L_lok_31:
    v_add_u32 v5, 65536, v2
    ds_read_b64_tr_b16 v[192:193], v5 offset:0
    ds_read_b64_tr_b16 v[194:195], v5 offset:512
    v_cndmask_b32 v248, 0, v239, s[82:83]
    v_or_b32 v244, v244, v248
    s_waitcnt lgkmcnt(6)
    v_mfma_f32_32x32x16_bf16 v[160:175], v[128:131], v[176:179], v[160:175]
    ds_read_b64_tr_b16 v[196:197], v5 offset:2048
    ds_read_b64_tr_b16 v[198:199], v5 offset:2560
    v_cndmask_b32 v245, 0, v238, s[84:85]
    v_cndmask_b32 v248, 0, v239, s[86:87]
    v_mfma_f32_32x32x16_bf16 v[160:175], v[132:135], v[180:183], v[160:175]
    ds_read_b64_tr_b16 v[176:177], v5 offset:4096
    ds_read_b64_tr_b16 v[178:179], v5 offset:4608
    v_or_b32 v245, v245, v248
    v_cndmask_b32 v246, 0, v238, s[88:89]
    s_waitcnt lgkmcnt(6)
    v_mfma_f32_32x32x16_bf16 v[160:175], v[136:139], v[184:187], v[160:175]
    ds_read_b64_tr_b16 v[180:181], v5 offset:6144
    ds_read_b64_tr_b16 v[182:183], v5 offset:6656
    v_cndmask_b32 v248, 0, v239, s[90:91]
    v_or_b32 v246, v246, v248
    v_cndmask_b32 v247, 0, v238, s[92:93]
    v_mfma_f32_32x32x16_bf16 v[160:175], v[140:143], v[188:191], v[160:175]
    ds_read_b64_tr_b16 v[184:185], v5 offset:8192
    ds_read_b64_tr_b16 v[186:187], v5 offset:8704
    v_cndmask_b32 v248, 0, v239, s[94:95]
    v_or_b32 v247, v247, v248
    s_waitcnt lgkmcnt(6)
    v_mfma_f32_32x32x16_bf16 v[144:159], v[192:195], v[16:19], 0
    ds_read_b64_tr_b16 v[188:189], v5 offset:10240
    ds_read_b64_tr_b16 v[190:191], v5 offset:10752
    v_mfma_f32_32x32x16_bf16 v[144:159], v[196:199], v[20:23], v[144:159]
    ds_read_b64_tr_b16 v[192:193], v5 offset:12288
    ds_read_b64_tr_b16 v[194:195], v5 offset:12800
    s_waitcnt lgkmcnt(6)
    v_mfma_f32_32x32x16_bf16 v[144:159], v[176:179], v[24:27], v[144:159]
    ds_read_b64_tr_b16 v[196:197], v5 offset:14336
    ds_read_b64_tr_b16 v[198:199], v5 offset:14848
    v_mfma_f32_32x32x16_bf16 v[144:159], v[180:183], v[28:31], v[144:159]
    v_add_u32 v5, 81920, v2
    ds_read_b64_tr_b16 v[176:177], v5 offset:0
    ds_read_b64_tr_b16 v[178:179], v5 offset:512
    ds_read_b128 v[200:203], v10 offset:0
    ds_read_b128 v[204:207], v10 offset:32
    ds_read_b128 v[208:211], v10 offset:64
    ds_read_b128 v[212:215], v10 offset:96
    s_waitcnt lgkmcnt(10)
    v_mfma_f32_32x32x16_bf16 v[144:159], v[184:187], v[32:35], v[144:159]
    ds_read_b64_tr_b16 v[180:181], v5 offset:2048
    ds_read_b64_tr_b16 v[182:183], v5 offset:2560
    s_waitcnt lgkmcnt(4)
    v_mul_f32 v200, v200, v160
    v_mul_f32 v201, v201, v161
    v_mul_f32 v202, v202, v162
    v_mfma_f32_32x32x16_bf16 v[144:159], v[188:191], v[36:39], v[144:159]
    ds_read_b64_tr_b16 v[184:185], v5 offset:4096
    ds_read_b64_tr_b16 v[186:187], v5 offset:4608
    v_mul_f32 v203, v203, v163
    v_mul_f32 v204, v204, v164
    v_mul_f32 v205, v205, v165
    v_mfma_f32_32x32x16_bf16 v[144:159], v[192:195], v[40:43], v[144:159]
    ds_read_b64_tr_b16 v[188:189], v5 offset:6144
    ds_read_b64_tr_b16 v[190:191], v5 offset:6656
    v_mul_f32 v206, v206, v166
    v_mul_f32 v207, v207, v167
    v_cvt_pk_bf16_f32 v224, v200, v201
    v_cvt_pk_bf16_f32 v225, v202, v203
    v_mfma_f32_32x32x16_bf16 v[144:159], v[196:199], v[44:47], v[144:159]
    ds_read_b32 v15, v8 offset:17932
    ds_read_b64_tr_b16 v[192:193], v5 offset:8192
    ds_read_b64_tr_b16 v[194:195], v5 offset:8704
    v_cvt_pk_bf16_f32 v226, v204, v205
    v_cvt_pk_bf16_f32 v227, v206, v207
    s_add_u32 s26, s18, 131072
    buffer_store_dwordx4 v[224:227], v1, s[32:35], s26 offen sc1
    s_waitcnt lgkmcnt(7)
    v_mfma_f32_32x32x16_bf16 v[144:159], v[176:179], v[48:51], v[144:159]
    ds_read_b64_tr_b16 v[196:197], v5 offset:10240
    ds_read_b64_tr_b16 v[198:199], v5 offset:10752
    v_mul_f32 v208, v208, v168
    v_mul_f32 v209, v209, v169
    v_mul_f32 v210, v210, v170
    v_mfma_f32_32x32x16_bf16 v[144:159], v[180:183], v[52:55], v[144:159]
    ds_read_b64_tr_b16 v[176:177], v5 offset:12288
    ds_read_b64_tr_b16 v[178:179], v5 offset:12800
    v_mul_f32 v211, v211, v171
    v_mul_f32 v212, v212, v172
    v_mul_f32 v213, v213, v173
    s_waitcnt lgkmcnt(7)
    v_mfma_f32_32x32x16_bf16 v[144:159], v[184:187], v[56:59], v[144:159]
    ds_read_b64_tr_b16 v[180:181], v5 offset:14336
    ds_read_b64_tr_b16 v[182:183], v5 offset:14848
    v_mul_f32 v214, v214, v174
    v_mul_f32 v215, v215, v175
    v_cvt_pk_bf16_f32 v228, v208, v209
    v_cvt_pk_bf16_f32 v229, v210, v211
    v_mfma_f32_32x32x16_bf16 v[144:159], v[188:191], v[60:63], v[144:159]
    s_waitcnt lgkmcnt(8)
    s_mov_b32 s11, 0
L_lp_34:
    v_readfirstlane_b32 s12, v15
    s_add_u32 s11, s11, 1
    s_nop 0
    s_cmp_ge_u32 s12, 4
    s_cbranch_scc1 L_lok_33
    s_sleep 1
    ds_read_b32 v15, v8 offset:17932
    s_waitcnt lgkmcnt(0)
    s_cmp_lt_u32 s11, 2097152
    s_cbranch_scc1 L_lp_34
L_lok_33:
    v_add_u32 v5, 98304, v2
    ds_read_b64_tr_b16 v[184:185], v5 offset:0
    ds_read_b64_tr_b16 v[186:187], v5 offset:512
    v_cvt_pk_bf16_f32 v230, v212, v213
    v_cvt_pk_bf16_f32 v231, v214, v215
    s_add_u32 s26, s18, 132096
    buffer_store_dwordx4 v[228:231], v1, s[32:35], s26 offen sc1
    s_waitcnt lgkmcnt(6)
    v_mfma_f32_32x32x16_bf16 v[144:159], v[192:195], v[64:67], v[144:159]
    ds_read_b64_tr_b16 v[188:189], v5 offset:2048
    ds_read_b64_tr_b16 v[190:191], v5 offset:2560
    s_mov_b64 exec, 1
    ds_add_u32 v8, v232 offset:17984
    s_mov_b64 exec, -1
    v_mfma_f32_32x32x16_bf16 v[144:159], v[196:199], v[68:71], v[144:159]
    ds_read_b64_tr_b16 v[192:193], v5 offset:4096
    ds_read_b64_tr_b16 v[194:195], v5 offset:4608
    s_waitcnt lgkmcnt(7)
    v_mfma_f32_32x32x16_bf16 v[144:159], v[176:179], v[72:75], v[144:159]
    ds_read_b64_tr_b16 v[196:197], v5 offset:6144
    ds_read_b64_tr_b16 v[198:199], v5 offset:6656
    v_mfma_f32_32x32x16_bf16 v[144:159], v[180:183], v[76:79], v[144:159]
    ds_read_b64_tr_b16 v[176:177], v5 offset:8192
    ds_read_b64_tr_b16 v[178:179], v5 offset:8704
    s_waitcnt lgkmcnt(7)
    v_mfma_f32_32x32x16_bf16 v[144:159], v[184:187], v[80:83], v[144:159]
    ds_read_b64_tr_b16 v[180:181], v5 offset:10240
    ds_read_b64_tr_b16 v[182:183], v5 offset:10752
    v_mfma_f32_32x32x16_bf16 v[144:159], v[188:191], v[84:87], v[144:159]
    ds_read_b64_tr_b16 v[184:185], v5 offset:12288
    ds_read_b64_tr_b16 v[186:187], v5 offset:12800
    s_waitcnt lgkmcnt(6)
    v_mfma_f32_32x32x16_bf16 v[144:159], v[192:195], v[88:91], v[144:159]
    ds_read_b64_tr_b16 v[188:189], v5 offset:14336
    ds_read_b64_tr_b16 v[190:191], v5 offset:14848
    v_mfma_f32_32x32x16_bf16 v[144:159], v[196:199], v[92:95], v[144:159]
    v_add_u32 v5, 114688, v2
    ds_read_b64_tr_b16 v[192:193], v5 offset:0
    ds_read_b64_tr_b16 v[194:195], v5 offset:512
    s_waitcnt lgkmcnt(6)
    v_mfma_f32_32x32x16_bf16 v[144:159], v[176:179], v[96:99], v[144:159]
    ds_read_b64_tr_b16 v[196:197], v5 offset:2048
    ds_read_b64_tr_b16 v[198:199], v5 offset:2560
    s_waitcnt vmcnt(4)
    v_readfirstlane_b32 s10, v14
    s_nop 1
    s_cmp_lg_u32 s10, 0
    s_cbranch_scc1 L_eok_35
    s_mov_b32 s11, 0
L_ep_36:
    buffer_load_dword v14, v12, s[36:39], 0 offen sc1
    s_waitcnt vmcnt(0)
    v_readfirstlane_b32 s10, v14
    s_add_u32 s11, s11, 1
    s_nop 0
    s_cmp_lg_u32 s10, 0
    s_cbranch_scc1 L_epd_37
    s_sleep 2
    s_cmp_lt_u32 s11, 131072
    s_cbranch_scc1 L_ep_36
L_epd_37:
L_eok_35:
    v_mov_b32 v11, s10
    v_mfma_f32_32x32x16_bf16 v[144:159], v[180:183], v[100:103], v[144:159]
    ds_read_b64_tr_b16 v[176:177], v5 offset:4096
    ds_read_b64_tr_b16 v[178:179], v5 offset:4608
    s_waitcnt lgkmcnt(6)
    v_mfma_f32_32x32x16_bf16 v[144:159], v[184:187], v[104:107], v[144:159]
    ds_read_b64_tr_b16 v[180:181], v5 offset:6144
    ds_read_b64_tr_b16 v[182:183], v5 offset:6656
    v_mfma_f32_32x32x16_bf16 v[144:159], v[188:191], v[108:111], v[144:159]
    ds_read_b64_tr_b16 v[184:185], v5 offset:8192
    ds_read_b64_tr_b16 v[186:187], v5 offset:8704
    s_waitcnt lgkmcnt(6)
    v_mfma_f32_32x32x16_bf16 v[144:159], v[192:195], v[112:115], v[144:159]
    ds_read_b64_tr_b16 v[188:189], v5 offset:10240
    ds_read_b64_tr_b16 v[190:191], v5 offset:10752
    v_mfma_f32_32x32x16_bf16 v[144:159], v[196:199], v[116:119], v[144:159]
    ds_read_b64_tr_b16 v[192:193], v5 offset:12288
    ds_read_b64_tr_b16 v[194:195], v5 offset:12800
    s_waitcnt lgkmcnt(6)
    v_mfma_f32_32x32x16_bf16 v[144:159], v[176:179], v[120:123], v[144:159]
    ds_read_b64_tr_b16 v[196:197], v5 offset:14336
    ds_read_b64_tr_b16 v[198:199], v5 offset:14848
    s_waitcnt vmcnt(0)
    buffer_store_dword v11, v12, s[32:35], s22 offen offset:0 sc1
    v_mfma_f32_32x32x16_bf16 v[144:159], v[180:183], v[124:127], v[144:159]
    v_add_u32 v5, 65536, v3
    ds_read_b64_tr_b16 v[176:177], v5 offset:0
    ds_read_b64_tr_b16 v[178:179], v5 offset:512
    s_waitcnt lgkmcnt(6)
    v_mfma_f32_32x32x16_bf16 v[144:159], v[184:187], v[128:131], v[144:159]
    ds_read_b64_tr_b16 v[180:181], v5 offset:2048
    ds_read_b64_tr_b16 v[182:183], v5 offset:2560
    v_mfma_f32_32x32x16_bf16 v[144:159], v[188:191], v[132:135], v[144:159]
    ds_read_b64_tr_b16 v[184:185], v5 offset:4096
    ds_read_b64_tr_b16 v[186:187], v5 offset:4608
    s_waitcnt lgkmcnt(6)
    v_mfma_f32_32x32x16_bf16 v[144:159], v[192:195], v[136:139], v[144:159]
    ds_read_b64_tr_b16 v[188:189], v5 offset:6144
    ds_read_b64_tr_b16 v[190:191], v5 offset:6656
    v_mfma_f32_32x32x16_bf16 v[144:159], v[196:199], v[140:143], v[144:159]
    ds_read_b64_tr_b16 v[192:193], v5 offset:8192
    ds_read_b64_tr_b16 v[194:195], v5 offset:8704
    s_waitcnt lgkmcnt(6)
    v_mfma_f32_32x32x16_bf16 v[160:175], v[176:179], v[16:19], 0
    ds_read_b64_tr_b16 v[196:197], v5 offset:10240
    ds_read_b64_tr_b16 v[198:199], v5 offset:10752
    v_mfma_f32_32x32x16_bf16 v[160:175], v[180:183], v[20:23], v[160:175]
    ds_read_b64_tr_b16 v[176:177], v5 offset:12288
    ds_read_b64_tr_b16 v[178:179], v5 offset:12800
    s_waitcnt lgkmcnt(6)
    v_mfma_f32_32x32x16_bf16 v[160:175], v[184:187], v[24:27], v[160:175]
    ds_read_b64_tr_b16 v[180:181], v5 offset:14336
    ds_read_b64_tr_b16 v[182:183], v5 offset:14848
    v_mfma_f32_32x32x16_bf16 v[160:175], v[188:191], v[28:31], v[160:175]
    v_add_u32 v5, 81920, v3
    ds_read_b64_tr_b16 v[184:185], v5 offset:0
    ds_read_b64_tr_b16 v[186:187], v5 offset:512
    ds_read_b128 v[200:203], v8 offset:16384
    ds_read_b128 v[204:207], v8 offset:16416
    ds_read_b128 v[208:211], v8 offset:16448
    ds_read_b128 v[212:215], v8 offset:16480
    s_waitcnt lgkmcnt(3)
    v_fma_f32 v200, v144, v6, v200
    v_mfma_f32_32x32x16_bf16 v[160:175], v[192:195], v[32:35], v[160:175]
    ds_read_b64_tr_b16 v[188:189], v5 offset:2048
    ds_read_b64_tr_b16 v[190:191], v5 offset:2560
    v_fma_f32 v201, v145, v6, v201
    v_fma_f32 v202, v146, v6, v202
    v_fma_f32 v203, v147, v6, v203
    v_mul_f32 v216, v200, v200
    v_mul_f32 v217, v201, v201
    v_mul_f32 v218, v202, v202
    v_mfma_f32_32x32x16_bf16 v[160:175], v[196:199], v[36:39], v[160:175]
    ds_read_b64_tr_b16 v[192:193], v5 offset:4096
    ds_read_b64_tr_b16 v[194:195], v5 offset:4608
    v_mul_f32 v219, v203, v203
    v_fmaak_f32 v216, v216, v9, 0xc0135761
    v_fmaak_f32 v217, v217, v9, 0xc0135761
    v_fmaak_f32 v218, v218, v9, 0xc0135761
    v_fmaak_f32 v219, v219, v9, 0xc0135761
    v_mul_f32 v216, v216, v200
    v_mul_f32 v217, v217, v201
    v_mfma_f32_32x32x16_bf16 v[160:175], v[176:179], v[40:43], v[160:175]
    ds_read_b64_tr_b16 v[196:197], v5 offset:6144
    ds_read_b64_tr_b16 v[198:199], v5 offset:6656
    v_mul_f32 v218, v218, v202
    v_mul_f32 v219, v219, v203
    v_exp_f32 v216, v216
    v_exp_f32 v217, v217
    v_mfma_f32_32x32x16_bf16 v[160:175], v[180:183], v[44:47], v[160:175]
    ds_read_b64_tr_b16 v[176:177], v5 offset:8192
    ds_read_b64_tr_b16 v[178:179], v5 offset:8704
    v_exp_f32 v218, v218
    v_exp_f32 v219, v219
    v_add_f32 v216, 1.0, v216
    v_add_f32 v217, 1.0, v217
    s_waitcnt lgkmcnt(6)
    v_mfma_f32_32x32x16_bf16 v[160:175], v[184:187], v[48:51], v[160:175]
    ds_read_b64_tr_b16 v[180:181], v5 offset:10240
    ds_read_b64_tr_b16 v[182:183], v5 offset:10752
    v_add_f32 v218, 1.0, v218
    v_add_f32 v219, 1.0, v219
    v_rcp_f32 v216, v216
    v_rcp_f32 v217, v217
    v_mfma_f32_32x32x16_bf16 v[160:175], v[188:191], v[52:55], v[160:175]
    ds_read_b64_tr_b16 v[184:185], v5 offset:12288
    ds_read_b64_tr_b16 v[186:187], v5 offset:12800
    v_rcp_f32 v218, v218
    v_rcp_f32 v219, v219
    v_mul_f32 v200, v200, v216
    v_mul_f32 v201, v201, v217
    s_waitcnt lgkmcnt(6)
    v_mfma_f32_32x32x16_bf16 v[160:175], v[192:195], v[56:59], v[160:175]
    ds_read_b64_tr_b16 v[188:189], v5 offset:14336
    ds_read_b64_tr_b16 v[190:191], v5 offset:14848
    v_mul_f32 v202, v202, v218
    v_mul_f32 v203, v203, v219
    v_cvt_pk_bf16_f32 v224, v200, v201
    v_cvt_pk_bf16_f32 v225, v202, v203
    v_fma_f32 v204, v148, v6, v204
    v_fma_f32 v205, v149, v6, v205
    v_mfma_f32_32x32x16_bf16 v[160:175], v[196:199], v[60:63], v[160:175]
    v_add_u32 v5, 98304, v3
    ds_read_b64_tr_b16 v[192:193], v5 offset:0
    ds_read_b64_tr_b16 v[194:195], v5 offset:512
    v_fma_f32 v206, v150, v6, v206
    v_fma_f32 v207, v151, v6, v207
    v_mul_f32 v220, v204, v204
    v_mul_f32 v221, v205, v205
    v_mul_f32 v222, v206, v206
    v_mul_f32 v223, v207, v207
    s_waitcnt lgkmcnt(6)
    v_mfma_f32_32x32x16_bf16 v[160:175], v[176:179], v[64:67], v[160:175]
    ds_read_b64_tr_b16 v[196:197], v5 offset:2048
    ds_read_b64_tr_b16 v[198:199], v5 offset:2560
    v_fmaak_f32 v220, v220, v9, 0xc0135761
    v_fmaak_f32 v221, v221, v9, 0xc0135761
    v_fmaak_f32 v222, v222, v9, 0xc0135761
    v_fmaak_f32 v223, v223, v9, 0xc0135761
    v_mul_f32 v220, v220, v204
    v_mul_f32 v221, v221, v205
    v_mfma_f32_32x32x16_bf16 v[160:175], v[180:183], v[68:71], v[160:175]
    ds_read_b64_tr_b16 v[176:177], v5 offset:4096
    ds_read_b64_tr_b16 v[178:179], v5 offset:4608
    v_mul_f32 v222, v222, v206
    v_mul_f32 v223, v223, v207
    v_exp_f32 v220, v220
    v_exp_f32 v221, v221
    s_waitcnt lgkmcnt(6)
    v_mfma_f32_32x32x16_bf16 v[160:175], v[184:187], v[72:75], v[160:175]
    ds_read_b64_tr_b16 v[180:181], v5 offset:6144
    ds_read_b64_tr_b16 v[182:183], v5 offset:6656
    v_exp_f32 v222, v222
    v_exp_f32 v223, v223
    v_add_f32 v220, 1.0, v220
    v_add_f32 v221, 1.0, v221
    v_mfma_f32_32x32x16_bf16 v[160:175], v[188:191], v[76:79], v[160:175]
    ds_read_b64_tr_b16 v[184:185], v5 offset:8192
    ds_read_b64_tr_b16 v[186:187], v5 offset:8704
    v_add_f32 v222, 1.0, v222
    v_add_f32 v223, 1.0, v223
    v_rcp_f32 v220, v220
    v_rcp_f32 v221, v221
    s_waitcnt lgkmcnt(6)
    v_mfma_f32_32x32x16_bf16 v[160:175], v[192:195], v[80:83], v[160:175]
    ds_read_b64_tr_b16 v[188:189], v5 offset:10240
    ds_read_b64_tr_b16 v[190:191], v5 offset:10752
    v_rcp_f32 v222, v222
    v_rcp_f32 v223, v223
    v_mul_f32 v204, v204, v220
    v_mul_f32 v205, v205, v221
    v_mul_f32 v206, v206, v222
    v_mfma_f32_32x32x16_bf16 v[160:175], v[196:199], v[84:87], v[160:175]
    ds_read_b64_tr_b16 v[192:193], v5 offset:12288
    ds_read_b64_tr_b16 v[194:195], v5 offset:12800
    v_mul_f32 v207, v207, v223
    v_cvt_pk_bf16_f32 v226, v204, v205
    v_cvt_pk_bf16_f32 v227, v206, v207
    s_add_u32 s26, s20, 0
    buffer_store_dwordx4 v[224:227], v1, s[32:35], s26 offen sc1
    s_waitcnt lgkmcnt(6)
    v_mfma_f32_32x32x16_bf16 v[160:175], v[176:179], v[88:91], v[160:175]
    ds_read_b64_tr_b16 v[196:197], v5 offset:14336
    ds_read_b64_tr_b16 v[198:199], v5 offset:14848
    v_fma_f32 v208, v152, v6, v208
    v_fma_f32 v209, v153, v6, v209
    v_fma_f32 v210, v154, v6, v210
    v_fma_f32 v211, v155, v6, v211
    v_mul_f32 v216, v208, v208
    v_mul_f32 v217, v209, v209
    v_mfma_f32_32x32x16_bf16 v[160:175], v[180:183], v[92:95], v[160:175]
    v_add_u32 v5, 114688, v3
    ds_read_b64_tr_b16 v[176:177], v5 offset:0
    ds_read_b64_tr_b16 v[178:179], v5 offset:512
    v_mul_f32 v218, v210, v210
    v_mul_f32 v219, v211, v211
    v_fmaak_f32 v216, v216, v9, 0xc0135761
    v_fmaak_f32 v217, v217, v9, 0xc0135761
    v_fmaak_f32 v218, v218, v9, 0xc0135761
    v_fmaak_f32 v219, v219, v9, 0xc0135761
    v_mul_f32 v216, v216, v208
    s_waitcnt lgkmcnt(6)
    v_mfma_f32_32x32x16_bf16 v[160:175], v[184:187], v[96:99], v[160:175]
    ds_read_b64_tr_b16 v[180:181], v5 offset:2048
    ds_read_b64_tr_b16 v[182:183], v5 offset:2560
    v_mul_f32 v217, v217, v209
    v_mul_f32 v218, v218, v210
    v_mul_f32 v219, v219, v211
    v_exp_f32 v216, v216
    v_mfma_f32_32x32x16_bf16 v[160:175], v[188:191], v[100:103], v[160:175]
    ds_read_b64_tr_b16 v[184:185], v5 offset:4096
    ds_read_b64_tr_b16 v[186:187], v5 offset:4608
    v_exp_f32 v217, v217
    v_exp_f32 v218, v218
    v_exp_f32 v219, v219
    v_add_f32 v216, 1.0, v216
    s_waitcnt lgkmcnt(6)
    v_mfma_f32_32x32x16_bf16 v[160:175], v[192:195], v[104:107], v[160:175]
    ds_read_b64_tr_b16 v[188:189], v5 offset:6144
    ds_read_b64_tr_b16 v[190:191], v5 offset:6656
    v_add_f32 v217, 1.0, v217
    v_add_f32 v218, 1.0, v218
    v_add_f32 v219, 1.0, v219
    v_rcp_f32 v216, v216
    v_mfma_f32_32x32x16_bf16 v[160:175], v[196:199], v[108:111], v[160:175]
    ds_read_b64_tr_b16 v[192:193], v5 offset:8192
    ds_read_b64_tr_b16 v[194:195], v5 offset:8704
    v_rcp_f32 v217, v217
    v_rcp_f32 v218, v218
    v_rcp_f32 v219, v219
    v_mul_f32 v208, v208, v216
    s_waitcnt lgkmcnt(6)
    v_mfma_f32_32x32x16_bf16 v[160:175], v[176:179], v[112:115], v[160:175]
    ds_read_b64_tr_b16 v[196:197], v5 offset:10240
    ds_read_b64_tr_b16 v[198:199], v5 offset:10752
    v_mul_f32 v209, v209, v217
    v_mul_f32 v210, v210, v218
    v_mul_f32 v211, v211, v219
    v_cvt_pk_bf16_f32 v228, v208, v209
    v_cvt_pk_bf16_f32 v229, v210, v211
    v_fma_f32 v212, v156, v6, v212
    v_mfma_f32_32x32x16_bf16 v[160:175], v[180:183], v[116:119], v[160:175]
    ds_read_b64_tr_b16 v[176:177], v5 offset:12288
    ds_read_b64_tr_b16 v[178:179], v5 offset:12800
    v_fma_f32 v213, v157, v6, v213
    v_fma_f32 v214, v158, v6, v214
    v_fma_f32 v215, v159, v6, v215
    v_mul_f32 v220, v212, v212
    v_mul_f32 v221, v213, v213
    v_mul_f32 v222, v214, v214
    s_waitcnt lgkmcnt(6)
    v_mfma_f32_32x32x16_bf16 v[160:175], v[184:187], v[120:123], v[160:175]
    ds_read_b64_tr_b16 v[180:181], v5 offset:14336
    ds_read_b64_tr_b16 v[182:183], v5 offset:14848
    v_mul_f32 v223, v215, v215
    v_fmaak_f32 v220, v220, v9, 0xc0135761
    v_fmaak_f32 v221, v221, v9, 0xc0135761
    v_fmaak_f32 v222, v222, v9, 0xc0135761
    v_fmaak_f32 v223, v223, v9, 0xc0135761
    v_mul_f32 v220, v220, v212
    v_mfma_f32_32x32x16_bf16 v[160:175], v[188:191], v[124:127], v[160:175]
    v_add_u32 v5, 131072, v2
    ds_read_b64_tr_b16 v[184:185], v5 offset:0
    ds_read_b64_tr_b16 v[186:187], v5 offset:512
    v_mul_f32 v221, v221, v213
    v_mul_f32 v222, v222, v214
    v_mul_f32 v223, v223, v215
    v_exp_f32 v220, v220
    s_waitcnt lgkmcnt(6)
    v_mfma_f32_32x32x16_bf16 v[160:175], v[192:195], v[128:131], v[160:175]
    ds_read_b64_tr_b16 v[188:189], v5 offset:2048
    ds_read_b64_tr_b16 v[190:191], v5 offset:2560
    v_exp_f32 v221, v221
    v_exp_f32 v222, v222
    v_exp_f32 v223, v223
    v_add_f32 v220, 1.0, v220
    v_mfma_f32_32x32x16_bf16 v[160:175], v[196:199], v[132:135], v[160:175]
    ds_read_b64_tr_b16 v[192:193], v5 offset:4096
    ds_read_b64_tr_b16 v[194:195], v5 offset:4608
    v_add_f32 v221, 1.0, v221
    v_add_f32 v222, 1.0, v222
    v_add_f32 v223, 1.0, v223
    v_rcp_f32 v220, v220
    v_rcp_f32 v221, v221
    s_waitcnt lgkmcnt(6)
    v_mfma_f32_32x32x16_bf16 v[160:175], v[176:179], v[136:139], v[160:175]
    ds_read_b64_tr_b16 v[196:197], v5 offset:6144
    ds_read_b64_tr_b16 v[198:199], v5 offset:6656
    v_rcp_f32 v222, v222
    v_rcp_f32 v223, v223
    v_mul_f32 v212, v212, v220
    v_mul_f32 v213, v213, v221
    v_mfma_f32_32x32x16_bf16 v[160:175], v[180:183], v[140:143], v[160:175]
    ds_read_b32 v15, v8 offset:17952
    ds_read_b64_tr_b16 v[176:177], v5 offset:8192
    ds_read_b64_tr_b16 v[178:179], v5 offset:8704
    v_mul_f32 v214, v214, v222
    v_mul_f32 v215, v215, v223
    v_cvt_pk_bf16_f32 v230, v212, v213
    v_cvt_pk_bf16_f32 v231, v214, v215
    s_add_u32 s26, s20, 1024
    buffer_store_dwordx4 v[228:231], v1, s[32:35], s26 offen sc1
    s_waitcnt lgkmcnt(7)
    v_mfma_f32_32x32x16_bf16 v[144:159], v[184:187], v[16:19], 0
    ds_read_b64_tr_b16 v[180:181], v5 offset:10240
    ds_read_b64_tr_b16 v[182:183], v5 offset:10752
    v_mfma_f32_32x32x16_bf16 v[144:159], v[188:191], v[20:23], v[144:159]
    ds_read_b64_tr_b16 v[184:185], v5 offset:12288
    ds_read_b64_tr_b16 v[186:187], v5 offset:12800
    s_waitcnt lgkmcnt(7)
    v_mfma_f32_32x32x16_bf16 v[144:159], v[192:195], v[24:27], v[144:159]
    ds_read_b64_tr_b16 v[188:189], v5 offset:14336
    ds_read_b64_tr_b16 v[190:191], v5 offset:14848
    v_mfma_f32_32x32x16_bf16 v[144:159], v[196:199], v[28:31], v[144:159]
    s_waitcnt lgkmcnt(8)
    s_mov_b32 s11, 0
L_lp_39:
    v_readfirstlane_b32 s12, v15
    s_add_u32 s11, s11, 1
    s_nop 0
    s_cmp_ge_u32 s12, 4
    s_cbranch_scc1 L_lok_38
    s_sleep 1
    ds_read_b32 v15, v8 offset:17952
    s_waitcnt lgkmcnt(0)
    s_cmp_lt_u32 s11, 2097152
    s_cbranch_scc1 L_lp_39
L_lok_38:
    v_add_u32 v5, 0, v2
    ds_read_b64_tr_b16 v[192:193], v5 offset:0
    ds_read_b64_tr_b16 v[194:195], v5 offset:512
    ds_read_b128 v[200:203], v8 offset:16512
    ds_read_b128 v[204:207], v8 offset:16544
    ds_read_b128 v[208:211], v8 offset:16576
    ds_read_b128 v[212:215], v8 offset:16608
    s_waitcnt lgkmcnt(3)
    v_fma_f32 v200, v160, v6, v200
    v_mfma_f32_32x32x16_bf16 v[144:159], v[176:179], v[32:35], v[144:159]
    ds_read_b64_tr_b16 v[196:197], v5 offset:2048
    ds_read_b64_tr_b16 v[198:199], v5 offset:2560
    v_fma_f32 v201, v161, v6, v201
    v_fma_f32 v202, v162, v6, v202
    v_fma_f32 v203, v163, v6, v203
    v_mul_f32 v216, v200, v200
    v_mul_f32 v217, v201, v201
    v_mul_f32 v218, v202, v202
    v_mfma_f32_32x32x16_bf16 v[144:159], v[180:183], v[36:39], v[144:159]
    ds_read_b64_tr_b16 v[176:177], v5 offset:4096
    ds_read_b64_tr_b16 v[178:179], v5 offset:4608
    v_mul_f32 v219, v203, v203
    v_fmaak_f32 v216, v216, v9, 0xc0135761
    v_fmaak_f32 v217, v217, v9, 0xc0135761
    v_fmaak_f32 v218, v218, v9, 0xc0135761
    v_fmaak_f32 v219, v219, v9, 0xc0135761
    v_mul_f32 v216, v216, v200
    v_mul_f32 v217, v217, v201
    v_mfma_f32_32x32x16_bf16 v[144:159], v[184:187], v[40:43], v[144:159]
    ds_read_b64_tr_b16 v[180:181], v5 offset:6144
    ds_read_b64_tr_b16 v[182:183], v5 offset:6656
    v_mul_f32 v218, v218, v202
    v_mul_f32 v219, v219, v203
    v_exp_f32 v216, v216
    v_exp_f32 v217, v217
    v_mfma_f32_32x32x16_bf16 v[144:159], v[188:191], v[44:47], v[144:159]
    ds_read_b64_tr_b16 v[184:185], v5 offset:8192
    ds_read_b64_tr_b16 v[186:187], v5 offset:8704
    v_exp_f32 v218, v218
    v_exp_f32 v219, v219
    v_add_f32 v216, 1.0, v216
    v_add_f32 v217, 1.0, v217
    s_waitcnt lgkmcnt(6)
    v_mfma_f32_32x32x16_bf16 v[144:159], v[192:195], v[48:51], v[144:159]
    ds_read_b64_tr_b16 v[188:189], v5 offset:10240
    ds_read_b64_tr_b16 v[190:191], v5 offset:10752
    v_add_f32 v218, 1.0, v218
    v_add_f32 v219, 1.0, v219
    v_rcp_f32 v216, v216
    v_rcp_f32 v217, v217
    v_mfma_f32_32x32x16_bf16 v[144:159], v[196:199], v[52:55], v[144:159]
    ds_read_b64_tr_b16 v[192:193], v5 offset:12288
    ds_read_b64_tr_b16 v[194:195], v5 offset:12800
    v_rcp_f32 v218, v218
    v_rcp_f32 v219, v219
    v_mul_f32 v200, v200, v216
    v_mul_f32 v201, v201, v217
    s_waitcnt lgkmcnt(6)
    v_mfma_f32_32x32x16_bf16 v[144:159], v[176:179], v[56:59], v[144:159]
    ds_read_b64_tr_b16 v[196:197], v5 offset:14336
    ds_read_b64_tr_b16 v[198:199], v5 offset:14848
    v_mul_f32 v202, v202, v218
    v_mul_f32 v203, v203, v219
    v_cvt_pk_bf16_f32 v224, v200, v201
    v_cvt_pk_bf16_f32 v225, v202, v203
    v_fma_f32 v204, v164, v6, v204
    v_fma_f32 v205, v165, v6, v205
    v_mfma_f32_32x32x16_bf16 v[144:159], v[180:183], v[60:63], v[144:159]
    v_add_u32 v5, 16384, v2
    ds_read_b64_tr_b16 v[176:177], v5 offset:0
    ds_read_b64_tr_b16 v[178:179], v5 offset:512
    v_fma_f32 v206, v166, v6, v206
    v_fma_f32 v207, v167, v6, v207
    v_mul_f32 v220, v204, v204
    v_mul_f32 v221, v205, v205
    v_mul_f32 v222, v206, v206
    v_mul_f32 v223, v207, v207
    s_waitcnt lgkmcnt(6)
    v_mfma_f32_32x32x16_bf16 v[144:159], v[184:187], v[64:67], v[144:159]
    ds_read_b64_tr_b16 v[180:181], v5 offset:2048
    ds_read_b64_tr_b16 v[182:183], v5 offset:2560
    s_waitcnt vmcnt(0)
    buffer_store_dword v11, v12, s[32:35], s23 offen offset:0 sc1
    s_mov_b64 exec, 1
    ds_add_u32 v8, v232 offset:18016
    s_mov_b64 exec, -1
    v_fmaak_f32 v220, v220, v9, 0xc0135761
    v_fmaak_f32 v221, v221, v9, 0xc0135761
    v_fmaak_f32 v222, v222, v9, 0xc0135761
    v_fmaak_f32 v223, v223, v9, 0xc0135761
    v_mul_f32 v220, v220, v204
    v_mul_f32 v221, v221, v205
    v_mfma_f32_32x32x16_bf16 v[144:159], v[188:191], v[68:71], v[144:159]
    ds_read_b64_tr_b16 v[184:185], v5 offset:4096
    ds_read_b64_tr_b16 v[186:187], v5 offset:4608
    v_mul_f32 v222, v222, v206
    v_mul_f32 v223, v223, v207
    v_exp_f32 v220, v220
    v_exp_f32 v221, v221
    s_waitcnt lgkmcnt(7)
    v_mfma_f32_32x32x16_bf16 v[144:159], v[192:195], v[72:75], v[144:159]
    ds_read_b64_tr_b16 v[188:189], v5 offset:6144
    ds_read_b64_tr_b16 v[190:191], v5 offset:6656
    v_exp_f32 v222, v222
    v_exp_f32 v223, v223
    v_add_f32 v220, 1.0, v220
    v_add_f32 v221, 1.0, v221
    v_mfma_f32_32x32x16_bf16 v[144:159], v[196:199], v[76:79], v[144:159]
    ds_read_b32 v15, v8 offset:17956
    ds_read_b64_tr_b16 v[192:193], v5 offset:8192
    ds_read_b64_tr_b16 v[194:195], v5 offset:8704
    v_add_f32 v222, 1.0, v222
    v_add_f32 v223, 1.0, v223
    v_rcp_f32 v220, v220
    v_rcp_f32 v221, v221
    s_waitcnt lgkmcnt(8)
    v_mfma_f32_32x32x16_bf16 v[144:159], v[176:179], v[80:83], v[144:159]
    ds_read_b64_tr_b16 v[196:197], v5 offset:10240
    ds_read_b64_tr_b16 v[198:199], v5 offset:10752
    v_rcp_f32 v222, v222
    v_rcp_f32 v223, v223
    v_mul_f32 v204, v204, v220
    v_mul_f32 v205, v205, v221
    v_mul_f32 v206, v206, v222
    v_mfma_f32_32x32x16_bf16 v[144:159], v[180:183], v[84:87], v[144:159]
    ds_read_b64_tr_b16 v[176:177], v5 offset:12288
    ds_read_b64_tr_b16 v[178:179], v5 offset:12800
    v_mul_f32 v207, v207, v223
    v_cvt_pk_bf16_f32 v226, v204, v205
    v_cvt_pk_bf16_f32 v227, v206, v207
    s_add_u32 s26, s20, 2048
    buffer_store_dwordx4 v[224:227], v1, s[32:35], s26 offen sc1
    s_waitcnt lgkmcnt(7)
    v_mfma_f32_32x32x16_bf16 v[144:159], v[184:187], v[88:91], v[144:159]
    ds_read_b64_tr_b16 v[180:181], v5 offset:14336
    ds_read_b64_tr_b16 v[182:183], v5 offset:14848
    v_fma_f32 v208, v168, v6, v208
    v_fma_f32 v209, v169, v6, v209
    v_fma_f32 v210, v170, v6, v210
    v_fma_f32 v211, v171, v6, v211
    v_mul_f32 v216, v208, v208
    v_mul_f32 v217, v209, v209
    v_mfma_f32_32x32x16_bf16 v[144:159], v[188:191], v[92:95], v[144:159]
    s_waitcnt lgkmcnt(8)
    s_mov_b32 s11, 0
L_lp_41:
    v_readfirstlane_b32 s12, v15
    s_add_u32 s11, s11, 1
    s_nop 0
    s_cmp_ge_u32 s12, 4
    s_cbranch_scc1 L_lok_40
    s_sleep 1
    ds_read_b32 v15, v8 offset:17956
    s_waitcnt lgkmcnt(0)
    s_cmp_lt_u32 s11, 2097152
    s_cbranch_scc1 L_lp_41
L_lok_40:
    v_add_u32 v5, 32768, v2
    ds_read_b64_tr_b16 v[184:185], v5 offset:0
    ds_read_b64_tr_b16 v[186:187], v5 offset:512
    v_mul_f32 v218, v210, v210
    v_mul_f32 v219, v211, v211
    v_fmaak_f32 v216, v216, v9, 0xc0135761
    v_fmaak_f32 v217, v217, v9, 0xc0135761
    v_fmaak_f32 v218, v218, v9, 0xc0135761
    v_fmaak_f32 v219, v219, v9, 0xc0135761
    v_mul_f32 v216, v216, v208
    s_waitcnt lgkmcnt(6)
    v_mfma_f32_32x32x16_bf16 v[144:159], v[192:195], v[96:99], v[144:159]
    ds_read_b64_tr_b16 v[188:189], v5 offset:2048
    ds_read_b64_tr_b16 v[190:191], v5 offset:2560
    v_mul_f32 v217, v217, v209
    v_mul_f32 v218, v218, v210
    v_mul_f32 v219, v219, v211
    v_exp_f32 v216, v216
    v_mfma_f32_32x32x16_bf16 v[144:159], v[196:199], v[100:103], v[144:159]
    ds_read_b64_tr_b16 v[192:193], v5 offset:4096
    ds_read_b64_tr_b16 v[194:195], v5 offset:4608
    v_exp_f32 v217, v217
    v_exp_f32 v218, v218
    v_exp_f32 v219, v219
    v_add_f32 v216, 1.0, v216
    s_waitcnt lgkmcnt(6)
    v_mfma_f32_32x32x16_bf16 v[144:159], v[176:179], v[104:107], v[144:159]
    ds_read_b64_tr_b16 v[196:197], v5 offset:6144
    ds_read_b64_tr_b16 v[198:199], v5 offset:6656
    v_add_f32 v217, 1.0, v217
    v_add_f32 v218, 1.0, v218
    v_add_f32 v219, 1.0, v219
    v_rcp_f32 v216, v216
    v_mfma_f32_32x32x16_bf16 v[144:159], v[180:183], v[108:111], v[144:159]
    ds_read_b64_tr_b16 v[176:177], v5 offset:8192
    ds_read_b64_tr_b16 v[178:179], v5 offset:8704
    v_rcp_f32 v217, v217
    v_rcp_f32 v218, v218
    v_rcp_f32 v219, v219
    v_mul_f32 v208, v208, v216
    s_waitcnt lgkmcnt(6)
    v_mfma_f32_32x32x16_bf16 v[144:159], v[184:187], v[112:115], v[144:159]
    ds_read_b64_tr_b16 v[180:181], v5 offset:10240
    ds_read_b64_tr_b16 v[182:183], v5 offset:10752
    v_mul_f32 v209, v209, v217
    v_mul_f32 v210, v210, v218
    v_mul_f32 v211, v211, v219
    v_cvt_pk_bf16_f32 v228, v208, v209
    v_cvt_pk_bf16_f32 v229, v210, v211
    v_fma_f32 v212, v172, v6, v212
    v_mfma_f32_32x32x16_bf16 v[144:159], v[188:191], v[116:119], v[144:159]
    ds_read_b64_tr_b16 v[184:185], v5 offset:12288
    ds_read_b64_tr_b16 v[186:187], v5 offset:12800
    v_fma_f32 v213, v173, v6, v213
    v_fma_f32 v214, v174, v6, v214
    v_fma_f32 v215, v175, v6, v215
    v_mul_f32 v220, v212, v212
    v_mul_f32 v221, v213, v213
    v_mul_f32 v222, v214, v214
    s_waitcnt lgkmcnt(6)
    v_mfma_f32_32x32x16_bf16 v[144:159], v[192:195], v[120:123], v[144:159]
    ds_read_b64_tr_b16 v[188:189], v5 offset:14336
    ds_read_b64_tr_b16 v[190:191], v5 offset:14848
    v_mul_f32 v223, v215, v215
    v_fmaak_f32 v220, v220, v9, 0xc0135761
    v_fmaak_f32 v221, v221, v9, 0xc0135761
    v_fmaak_f32 v222, v222, v9, 0xc0135761
    v_fmaak_f32 v223, v223, v9, 0xc0135761
    v_mul_f32 v220, v220, v212
    v_mfma_f32_32x32x16_bf16 v[144:159], v[196:199], v[124:127], v[144:159]
    v_add_u32 v5, 131072, v3
    ds_read_b64_tr_b16 v[192:193], v5 offset:0
    ds_read_b64_tr_b16 v[194:195], v5 offset:512
    v_mul_f32 v221, v221, v213
    v_mul_f32 v222, v222, v214
    v_mul_f32 v223, v223, v215
    v_exp_f32 v220, v220
    s_waitcnt lgkmcnt(6)
    v_mfma_f32_32x32x16_bf16 v[144:159], v[176:179], v[128:131], v[144:159]
    ds_read_b64_tr_b16 v[196:197], v5 offset:2048
    ds_read_b64_tr_b16 v[198:199], v5 offset:2560
    v_exp_f32 v221, v221
    v_exp_f32 v222, v222
    v_exp_f32 v223, v223
    v_add_f32 v220, 1.0, v220
    v_mfma_f32_32x32x16_bf16 v[144:159], v[180:183], v[132:135], v[144:159]
    ds_read_b64_tr_b16 v[176:177], v5 offset:4096
    ds_read_b64_tr_b16 v[178:179], v5 offset:4608
    v_add_f32 v221, 1.0, v221
    v_add_f32 v222, 1.0, v222
    v_add_f32 v223, 1.0, v223
    v_rcp_f32 v220, v220
    v_rcp_f32 v221, v221
    s_waitcnt lgkmcnt(6)
    v_mfma_f32_32x32x16_bf16 v[144:159], v[184:187], v[136:139], v[144:159]
    ds_read_b64_tr_b16 v[180:181], v5 offset:6144
    ds_read_b64_tr_b16 v[182:183], v5 offset:6656
    v_rcp_f32 v222, v222
    v_rcp_f32 v223, v223
    v_mul_f32 v212, v212, v220
    v_mul_f32 v213, v213, v221
    v_mfma_f32_32x32x16_bf16 v[144:159], v[188:191], v[140:143], v[144:159]
    ds_read_b64_tr_b16 v[184:185], v5 offset:8192
    ds_read_b64_tr_b16 v[186:187], v5 offset:8704
    v_mul_f32 v214, v214, v222
    v_mul_f32 v215, v215, v223
    v_cvt_pk_bf16_f32 v230, v212, v213
    v_cvt_pk_bf16_f32 v231, v214, v215
    s_add_u32 s26, s20, 3072
    buffer_store_dwordx4 v[228:231], v1, s[32:35], s26 offen sc1
    s_waitcnt lgkmcnt(6)
    v_mfma_f32_32x32x16_bf16 v[160:175], v[192:195], v[16:19], 0
    ds_read_b64_tr_b16 v[188:189], v5 offset:10240
    ds_read_b64_tr_b16 v[190:191], v5 offset:10752
    v_mfma_f32_32x32x16_bf16 v[160:175], v[196:199], v[20:23], v[160:175]
    ds_read_b64_tr_b16 v[192:193], v5 offset:12288
    ds_read_b64_tr_b16 v[194:195], v5 offset:12800
    s_waitcnt lgkmcnt(6)
    v_mfma_f32_32x32x16_bf16 v[160:175], v[176:179], v[24:27], v[160:175]
    ds_read_b64_tr_b16 v[196:197], v5 offset:14336
    ds_read_b64_tr_b16 v[198:199], v5 offset:14848
    v_mfma_f32_32x32x16_bf16 v[160:175], v[180:183], v[28:31], v[160:175]
    v_add_u32 v5, 0, v3
    ds_read_b64_tr_b16 v[176:177], v5 offset:0
    ds_read_b64_tr_b16 v[178:179], v5 offset:512
    ds_read_b128 v[200:203], v8 offset:16640
    ds_read_b128 v[204:207], v8 offset:16672
    ds_read_b128 v[208:211], v8 offset:16704
    ds_read_b128 v[212:215], v8 offset:16736
    s_waitcnt lgkmcnt(3)
    v_fma_f32 v200, v144, v6, v200
    v_mfma_f32_32x32x16_bf16 v[160:175], v[184:187], v[32:35], v[160:175]
    ds_read_b64_tr_b16 v[180:181], v5 offset:2048
    ds_read_b64_tr_b16 v[182:183], v5 offset:2560
    v_fma_f32 v201, v145, v6, v201
    v_fma_f32 v202, v146, v6, v202
    v_fma_f32 v203, v147, v6, v203
    v_mul_f32 v216, v200, v200
    v_mul_f32 v217, v201, v201
    v_mul_f32 v218, v202, v202
    v_mfma_f32_32x32x16_bf16 v[160:175], v[188:191], v[36:39], v[160:175]
    ds_read_b64_tr_b16 v[184:185], v5 offset:4096
    ds_read_b64_tr_b16 v[186:187], v5 offset:4608
    v_mul_f32 v219, v203, v203
    v_fmaak_f32 v216, v216, v9, 0xc0135761
    v_fmaak_f32 v217, v217, v9, 0xc0135761
    v_fmaak_f32 v218, v218, v9, 0xc0135761
    v_fmaak_f32 v219, v219, v9, 0xc0135761
    v_mul_f32 v216, v216, v200
    v_mul_f32 v217, v217, v201
    v_mfma_f32_32x32x16_bf16 v[160:175], v[192:195], v[40:43], v[160:175]
    ds_read_b64_tr_b16 v[188:189], v5 offset:6144
    ds_read_b64_tr_b16 v[190:191], v5 offset:6656
    v_mul_f32 v218, v218, v202
    v_mul_f32 v219, v219, v203
    v_exp_f32 v216, v216
    v_exp_f32 v217, v217
    v_mfma_f32_32x32x16_bf16 v[160:175], v[196:199], v[44:47], v[160:175]
    ds_read_b64_tr_b16 v[192:193], v5 offset:8192
    ds_read_b64_tr_b16 v[194:195], v5 offset:8704
    v_exp_f32 v218, v218
    v_exp_f32 v219, v219
    v_add_f32 v216, 1.0, v216
    v_add_f32 v217, 1.0, v217
    s_waitcnt lgkmcnt(6)
    v_mfma_f32_32x32x16_bf16 v[160:175], v[176:179], v[48:51], v[160:175]
    ds_read_b64_tr_b16 v[196:197], v5 offset:10240
    ds_read_b64_tr_b16 v[198:199], v5 offset:10752
    v_add_f32 v218, 1.0, v218
    v_add_f32 v219, 1.0, v219
    v_rcp_f32 v216, v216
    v_rcp_f32 v217, v217
    v_mfma_f32_32x32x16_bf16 v[160:175], v[180:183], v[52:55], v[160:175]
    ds_read_b64_tr_b16 v[176:177], v5 offset:12288
    ds_read_b64_tr_b16 v[178:179], v5 offset:12800
    v_rcp_f32 v218, v218
    v_rcp_f32 v219, v219
    v_mul_f32 v200, v200, v216
    v_mul_f32 v201, v201, v217
    s_waitcnt lgkmcnt(6)
    v_mfma_f32_32x32x16_bf16 v[160:175], v[184:187], v[56:59], v[160:175]
    ds_read_b64_tr_b16 v[180:181], v5 offset:14336
    ds_read_b64_tr_b16 v[182:183], v5 offset:14848
    v_mul_f32 v202, v202, v218
    v_mul_f32 v203, v203, v219
    v_cvt_pk_bf16_f32 v224, v200, v201
    v_cvt_pk_bf16_f32 v225, v202, v203
    v_fma_f32 v204, v148, v6, v204
    v_fma_f32 v205, v149, v6, v205
    v_mfma_f32_32x32x16_bf16 v[160:175], v[188:191], v[60:63], v[160:175]
    v_add_u32 v5, 16384, v3
    ds_read_b64_tr_b16 v[184:185], v5 offset:0
    ds_read_b64_tr_b16 v[186:187], v5 offset:512
    v_fma_f32 v206, v150, v6, v206
    v_fma_f32 v207, v151, v6, v207
    v_mul_f32 v220, v204, v204
    v_mul_f32 v221, v205, v205
    v_mul_f32 v222, v206, v206
    v_mul_f32 v223, v207, v207
    s_waitcnt lgkmcnt(6)
    v_mfma_f32_32x32x16_bf16 v[160:175], v[192:195], v[64:67], v[160:175]
    ds_read_b64_tr_b16 v[188:189], v5 offset:2048
    ds_read_b64_tr_b16 v[190:191], v5 offset:2560
    s_waitcnt vmcnt(0)
    buffer_store_dword v11, v12, s[32:35], s23 offen offset:4 sc1
    v_fmaak_f32 v220, v220, v9, 0xc0135761
    v_fmaak_f32 v221, v221, v9, 0xc0135761
    v_fmaak_f32 v222, v222, v9, 0xc0135761
    v_fmaak_f32 v223, v223, v9, 0xc0135761
    v_mul_f32 v220, v220, v204
    v_mul_f32 v221, v221, v205
    v_mfma_f32_32x32x16_bf16 v[160:175], v[196:199], v[68:71], v[160:175]
    ds_read_b64_tr_b16 v[192:193], v5 offset:4096
    ds_read_b64_tr_b16 v[194:195], v5 offset:4608
    v_mul_f32 v222, v222, v206
    v_mul_f32 v223, v223, v207
    v_exp_f32 v220, v220
    v_exp_f32 v221, v221
    s_waitcnt lgkmcnt(6)
    v_mfma_f32_32x32x16_bf16 v[160:175], v[176:179], v[72:75], v[160:175]
    ds_read_b64_tr_b16 v[196:197], v5 offset:6144
    ds_read_b64_tr_b16 v[198:199], v5 offset:6656
    v_exp_f32 v222, v222
    v_exp_f32 v223, v223
    v_add_f32 v220, 1.0, v220
    v_add_f32 v221, 1.0, v221
    v_mfma_f32_32x32x16_bf16 v[160:175], v[180:183], v[76:79], v[160:175]
    ds_read_b64_tr_b16 v[176:177], v5 offset:8192
    ds_read_b64_tr_b16 v[178:179], v5 offset:8704
    v_add_f32 v222, 1.0, v222
    v_add_f32 v223, 1.0, v223
    v_rcp_f32 v220, v220
    v_rcp_f32 v221, v221
    s_waitcnt lgkmcnt(6)
    v_mfma_f32_32x32x16_bf16 v[160:175], v[184:187], v[80:83], v[160:175]
    ds_read_b64_tr_b16 v[180:181], v5 offset:10240
    ds_read_b64_tr_b16 v[182:183], v5 offset:10752
    v_rcp_f32 v222, v222
    v_rcp_f32 v223, v223
    v_mul_f32 v204, v204, v220
    v_mul_f32 v205, v205, v221
    v_mul_f32 v206, v206, v222
    v_mfma_f32_32x32x16_bf16 v[160:175], v[188:191], v[84:87], v[160:175]
    ds_read_b64_tr_b16 v[184:185], v5 offset:12288
    ds_read_b64_tr_b16 v[186:187], v5 offset:12800
    v_mul_f32 v207, v207, v223
    v_cvt_pk_bf16_f32 v226, v204, v205
    v_cvt_pk_bf16_f32 v227, v206, v207
    s_add_u32 s26, s21, 0
    buffer_store_dwordx4 v[224:227], v1, s[32:35], s26 offen sc1
    s_waitcnt lgkmcnt(6)
    v_mfma_f32_32x32x16_bf16 v[160:175], v[192:195], v[88:91], v[160:175]
    ds_read_b64_tr_b16 v[188:189], v5 offset:14336
    ds_read_b64_tr_b16 v[190:191], v5 offset:14848
    v_fma_f32 v208, v152, v6, v208
    v_fma_f32 v209, v153, v6, v209
    v_fma_f32 v210, v154, v6, v210
    v_fma_f32 v211, v155, v6, v211
    v_mul_f32 v216, v208, v208
    v_mul_f32 v217, v209, v209
    v_mfma_f32_32x32x16_bf16 v[160:175], v[196:199], v[92:95], v[160:175]
    v_add_u32 v5, 32768, v3
    ds_read_b64_tr_b16 v[192:193], v5 offset:0
    ds_read_b64_tr_b16 v[194:195], v5 offset:512
    v_mul_f32 v218, v210, v210
    v_mul_f32 v219, v211, v211
    v_fmaak_f32 v216, v216, v9, 0xc0135761
    v_fmaak_f32 v217, v217, v9, 0xc0135761
    v_fmaak_f32 v218, v218, v9, 0xc0135761
    v_fmaak_f32 v219, v219, v9, 0xc0135761
    v_mul_f32 v216, v216, v208
    s_waitcnt lgkmcnt(6)
    v_mfma_f32_32x32x16_bf16 v[160:175], v[176:179], v[96:99], v[160:175]
    ds_read_b64_tr_b16 v[196:197], v5 offset:2048
    ds_read_b64_tr_b16 v[198:199], v5 offset:2560
    v_mul_f32 v217, v217, v209
    v_mul_f32 v218, v218, v210
    v_mul_f32 v219, v219, v211
    v_exp_f32 v216, v216
    v_mfma_f32_32x32x16_bf16 v[160:175], v[180:183], v[100:103], v[160:175]
    ds_read_b64_tr_b16 v[176:177], v5 offset:4096
    ds_read_b64_tr_b16 v[178:179], v5 offset:4608
    v_exp_f32 v217, v217
    v_exp_f32 v218, v218
    v_exp_f32 v219, v219
    v_add_f32 v216, 1.0, v216
    s_waitcnt lgkmcnt(6)
    v_mfma_f32_32x32x16_bf16 v[160:175], v[184:187], v[104:107], v[160:175]
    ds_read_b64_tr_b16 v[180:181], v5 offset:6144
    ds_read_b64_tr_b16 v[182:183], v5 offset:6656
    buffer_load_dword v14, v13, s[32:35], 0 offen sc1
    v_add_f32 v217, 1.0, v217
    v_add_f32 v218, 1.0, v218
    v_add_f32 v219, 1.0, v219
    v_rcp_f32 v216, v216
    v_mfma_f32_32x32x16_bf16 v[160:175], v[188:191], v[108:111], v[160:175]
    ds_read_b64_tr_b16 v[184:185], v5 offset:8192
    ds_read_b64_tr_b16 v[186:187], v5 offset:8704
    v_rcp_f32 v217, v217
    v_rcp_f32 v218, v218
    v_rcp_f32 v219, v219
    v_mul_f32 v208, v208, v216
    s_waitcnt lgkmcnt(6)
    v_mfma_f32_32x32x16_bf16 v[160:175], v[192:195], v[112:115], v[160:175]
    ds_read_b64_tr_b16 v[188:189], v5 offset:10240
    ds_read_b64_tr_b16 v[190:191], v5 offset:10752
    v_mul_f32 v209, v209, v217
    v_mul_f32 v210, v210, v218
    v_mul_f32 v211, v211, v219
    v_cvt_pk_bf16_f32 v228, v208, v209
    v_cvt_pk_bf16_f32 v229, v210, v211
    v_fma_f32 v212, v156, v6, v212
    v_mfma_f32_32x32x16_bf16 v[160:175], v[196:199], v[116:119], v[160:175]
    ds_read_b64_tr_b16 v[192:193], v5 offset:12288
    ds_read_b64_tr_b16 v[194:195], v5 offset:12800
    v_fma_f32 v213, v157, v6, v213
    v_fma_f32 v214, v158, v6, v214
    v_fma_f32 v215, v159, v6, v215
    v_mul_f32 v220, v212, v212
    v_mul_f32 v221, v213, v213
    v_mul_f32 v222, v214, v214
    s_waitcnt lgkmcnt(6)
    v_mfma_f32_32x32x16_bf16 v[160:175], v[176:179], v[120:123], v[160:175]
    ds_read_b64_tr_b16 v[196:197], v5 offset:14336
    ds_read_b64_tr_b16 v[198:199], v5 offset:14848
    v_mul_f32 v223, v215, v215
    v_fmaak_f32 v220, v220, v9, 0xc0135761
    v_fmaak_f32 v221, v221, v9, 0xc0135761
    v_fmaak_f32 v222, v222, v9, 0xc0135761
    v_fmaak_f32 v223, v223, v9, 0xc0135761
    v_mul_f32 v220, v220, v212
    v_mfma_f32_32x32x16_bf16 v[160:175], v[180:183], v[124:127], v[160:175]
    v_mul_f32 v221, v221, v213
    v_mul_f32 v222, v222, v214
    v_mul_f32 v223, v223, v215
    v_exp_f32 v220, v220
    s_waitcnt lgkmcnt(4)
    v_mfma_f32_32x32x16_bf16 v[160:175], v[184:187], v[128:131], v[160:175]
    v_exp_f32 v221, v221
    v_exp_f32 v222, v222
    v_exp_f32 v223, v223
    v_add_f32 v220, 1.0, v220
    v_mfma_f32_32x32x16_bf16 v[160:175], v[188:191], v[132:135], v[160:175]
    v_add_f32 v221, 1.0, v221
    v_add_f32 v222, 1.0, v222
    v_add_f32 v223, 1.0, v223
    v_rcp_f32 v220, v220
    v_rcp_f32 v221, v221
    s_waitcnt lgkmcnt(0)
    v_mfma_f32_32x32x16_bf16 v[160:175], v[192:195], v[136:139], v[160:175]
    v_rcp_f32 v222, v222
    v_rcp_f32 v223, v223
    v_mul_f32 v212, v212, v220
    v_mul_f32 v213, v213, v221
    v_mfma_f32_32x32x16_bf16 v[160:175], v[196:199], v[140:143], v[160:175]
    v_mul_f32 v214, v214, v222
    v_mul_f32 v215, v215, v223
    v_cvt_pk_bf16_f32 v230, v212, v213
    v_cvt_pk_bf16_f32 v231, v214, v215
    s_add_u32 s26, s21, 1024
    buffer_store_dwordx4 v[228:231], v1, s[32:35], s26 offen sc1
    s_waitcnt vmcnt(1)
    v_cmp_ne_u32 vcc, s10, v14
    s_nop 1
    s_cmp_eq_u64 vcc, 0
    s_cbranch_scc1 L_ok_42
    s_mov_b32 s11, 0
L_pl_43:
    buffer_load_dword v14, v13, s[32:35], 0 offen sc1
    s_waitcnt vmcnt(0)
    v_cmp_ne_u32 vcc, s10, v14
    s_add_u32 s11, s11, 1
    s_nop 0
    s_cmp_eq_u64 vcc, 0
    s_cbranch_scc1 L_pld_44
    s_sleep 4
    s_cmp_lt_u32 s11, 131072
    s_cbranch_scc1 L_pl_43
L_pld_44:
L_ok_42:
    buffer_load_dwordx4 v[248:251], v1, s[32:35], s43 offen sc1
    buffer_load_dwordx4 v[252:255], v1, s[32:35], s43 offen offset:1024 sc1
    v_add_u32 v236, 0, v233
    v_max_i32 v236, v236, v234
    buffer_load_dwordx4 v[16:19], v236, s[32:35], s42 offen sc1
    ds_read_b128 v[200:203], v8 offset:16768
    ds_read_b128 v[204:207], v8 offset:16800
    ds_read_b128 v[208:211], v8 offset:16832
    ds_read_b128 v[212:215], v8 offset:16864
    s_waitcnt lgkmcnt(3)
    v_fma_f32 v200, v160, v6, v200
    v_fma_f32 v201, v161, v6, v201
    v_add_u32 v236, 8192, v233
    v_max_i32 v236, v236, v234
    buffer_load_dwordx4 v[48:51], v236, s[32:35], s42 offen sc1
    v_fma_f32 v202, v162, v6, v202
    v_fma_f32 v203, v163, v6, v203
    v_mul_f32 v216, v200, v200
    v_mul_f32 v217, v201, v201
    v_mul_f32 v218, v202, v202
    v_mul_f32 v219, v203, v203
    v_fmaak_f32 v216, v216, v9, 0xc0135761
    v_add_u32 v237, 1024, v233
    v_max_i32 v237, v237, v234
    buffer_load_dwordx4 v[20:23], v237, s[32:35], s42 offen sc1
    v_fmaak_f32 v217, v217, v9, 0xc0135761
    v_fmaak_f32 v218, v218, v9, 0xc0135761
    v_fmaak_f32 v219, v219, v9, 0xc0135761
    v_mul_f32 v216, v216, v200
    v_mul_f32 v217, v217, v201
    v_mul_f32 v218, v218, v202
    v_mul_f32 v219, v219, v203
    v_add_u32 v238, 2048, v233
    v_max_i32 v238, v238, v234
    buffer_load_dwordx4 v[24:27], v238, s[32:35], s42 offen sc1
    v_exp_f32 v216, v216
    v_exp_f32 v217, v217
    v_exp_f32 v218, v218
    v_exp_f32 v219, v219
    v_add_f32 v216, 1.0, v216
    v_add_f32 v217, 1.0, v217
    v_add_f32 v218, 1.0, v218
    v_add_u32 v239, 3072, v233
    v_max_i32 v239, v239, v234
    buffer_load_dwordx4 v[28:31], v239, s[32:35], s42 offen sc1
    v_add_f32 v219, 1.0, v219
    v_rcp_f32 v216, v216
    v_rcp_f32 v217, v217
    v_rcp_f32 v218, v218
    v_rcp_f32 v219, v219
    v_mul_f32 v200, v200, v216
    v_mul_f32 v201, v201, v217
    v_add_u32 v236, 4096, v233
    v_max_i32 v236, v236, v234
    buffer_load_dwordx4 v[32:35], v236, s[32:35], s42 offen sc1
    v_mul_f32 v202, v202, v218
    v_mul_f32 v203, v203, v219
    v_cvt_pk_bf16_f32 v224, v200, v201
    v_cvt_pk_bf16_f32 v225, v202, v203
    s_waitcnt lgkmcnt(2)
    v_fma_f32 v204, v164, v6, v204
    v_fma_f32 v205, v165, v6, v205
    v_add_u32 v237, 5120, v233
    v_max_i32 v237, v237, v234
    buffer_load_dwordx4 v[36:39], v237, s[32:35], s42 offen sc1
    v_fma_f32 v206, v166, v6, v206
    v_fma_f32 v207, v167, v6, v207
    v_mul_f32 v220, v204, v204
    v_mul_f32 v221, v205, v205
    v_mul_f32 v222, v206, v206
    v_mul_f32 v223, v207, v207
    v_fmaak_f32 v220, v220, v9, 0xc0135761
    v_add_u32 v238, 6144, v233
    v_max_i32 v238, v238, v234
    buffer_load_dwordx4 v[40:43], v238, s[32:35], s42 offen sc1
    v_fmaak_f32 v221, v221, v9, 0xc0135761
    v_fmaak_f32 v222, v222, v9, 0xc0135761
    v_fmaak_f32 v223, v223, v9, 0xc0135761
    v_mul_f32 v220, v220, v204
    v_mul_f32 v221, v221, v205
    v_mul_f32 v222, v222, v206
    v_mul_f32 v223, v223, v207
    v_add_u32 v239, 7168, v233
    v_max_i32 v239, v239, v234
    buffer_load_dwordx4 v[44:47], v239, s[32:35], s42 offen sc1
    v_exp_f32 v220, v220
    v_exp_f32 v221, v221
    v_exp_f32 v222, v222
    v_exp_f32 v223, v223
    v_add_f32 v220, 1.0, v220
    v_add_f32 v221, 1.0, v221
    v_add_f32 v222, 1.0, v222
    v_add_u32 v237, 9216, v233
    v_max_i32 v237, v237, v234
    buffer_load_dwordx4 v[52:55], v237, s[32:35], s42 offen sc1
    v_add_f32 v223, 1.0, v223
    v_rcp_f32 v220, v220
    v_rcp_f32 v221, v221
    v_rcp_f32 v222, v222
    v_rcp_f32 v223, v223
    v_mul_f32 v204, v204, v220
    v_mul_f32 v205, v205, v221
    s_waitcnt vmcnt(12)
    buffer_store_dword v11, v12, s[32:35], s23 offen offset:8 sc1
    v_mul_f32 v206, v206, v222
    v_mul_f32 v207, v207, v223
    v_cvt_pk_bf16_f32 v226, v204, v205
    v_cvt_pk_bf16_f32 v227, v206, v207
    s_add_u32 s26, s21, 2048
    buffer_store_dwordx4 v[224:227], v1, s[32:35], s26 offen sc1
    s_waitcnt lgkmcnt(1)
    v_fma_f32 v208, v168, v6, v208
    v_fma_f32 v209, v169, v6, v209
    v_fma_f32 v210, v170, v6, v210
    v_fma_f32 v211, v171, v6, v211
    v_mul_f32 v216, v208, v208
    v_mul_f32 v217, v209, v209
    v_mul_f32 v218, v210, v210
    v_mul_f32 v219, v211, v211
    v_fmaak_f32 v216, v216, v9, 0xc0135761
    v_fmaak_f32 v217, v217, v9, 0xc0135761
    v_fmaak_f32 v218, v218, v9, 0xc0135761
    v_fmaak_f32 v219, v219, v9, 0xc0135761
    v_mul_f32 v216, v216, v208
    v_mul_f32 v217, v217, v209
    v_mul_f32 v218, v218, v210
    v_mul_f32 v219, v219, v211
    v_exp_f32 v216, v216
    v_exp_f32 v217, v217
    v_exp_f32 v218, v218
    v_exp_f32 v219, v219
    v_add_f32 v216, 1.0, v216
    v_add_f32 v217, 1.0, v217
    v_add_f32 v218, 1.0, v218
    v_add_f32 v219, 1.0, v219
    v_rcp_f32 v216, v216
    v_rcp_f32 v217, v217
    v_rcp_f32 v218, v218
    v_rcp_f32 v219, v219
    v_mul_f32 v208, v208, v216
    v_mul_f32 v209, v209, v217
    v_mul_f32 v210, v210, v218
    v_mul_f32 v211, v211, v219
    v_cvt_pk_bf16_f32 v228, v208, v209
    v_cvt_pk_bf16_f32 v229, v210, v211
    s_waitcnt lgkmcnt(0)
    v_fma_f32 v212, v172, v6, v212
    v_fma_f32 v213, v173, v6, v213
    v_fma_f32 v214, v174, v6, v214
    v_fma_f32 v215, v175, v6, v215
    v_mul_f32 v220, v212, v212
    v_mul_f32 v221, v213, v213
    v_mul_f32 v222, v214, v214
    v_mul_f32 v223, v215, v215
    v_fmaak_f32 v220, v220, v9, 0xc0135761
    v_fmaak_f32 v221, v221, v9, 0xc0135761
    v_fmaak_f32 v222, v222, v9, 0xc0135761
    v_fmaak_f32 v223, v223, v9, 0xc0135761
    v_mul_f32 v220, v220, v212
    v_mul_f32 v221, v221, v213
    v_mul_f32 v222, v222, v214
    v_mul_f32 v223, v223, v215
    v_exp_f32 v220, v220
    v_exp_f32 v221, v221
    v_exp_f32 v222, v222
    v_exp_f32 v223, v223
    v_add_f32 v220, 1.0, v220
    v_add_f32 v221, 1.0, v221
    v_add_f32 v222, 1.0, v222
    v_add_f32 v223, 1.0, v223
    v_rcp_f32 v220, v220
    v_rcp_f32 v221, v221
    v_rcp_f32 v222, v222
    v_rcp_f32 v223, v223
    v_mul_f32 v212, v212, v220
    v_mul_f32 v213, v213, v221
    v_mul_f32 v214, v214, v222
    v_mul_f32 v215, v215, v223
    v_cvt_pk_bf16_f32 v230, v212, v213
    v_cvt_pk_bf16_f32 v231, v214, v215
    s_add_u32 s26, s21, 3072
    buffer_store_dwordx4 v[228:231], v1, s[32:35], s26 offen sc1
    s_add_u32 s23, s23, 12
L_attn:
    s_waitcnt lgkmcnt(0)
    s_waitcnt vmcnt(12)
    v_mfma_f32_32x32x16_bf16 v[144:159], v[16:19], v[248:251], 0
    s_waitcnt vmcnt(11)
    v_mfma_f32_32x32x16_bf16 v[160:175], v[48:51], v[248:251], 0
    s_waitcnt vmcnt(10)
    v_mfma_f32_32x32x16_bf16 v[176:191], v[20:23], v[248:251], 0
    s_waitcnt vmcnt(9)
    v_mfma_f32_32x32x16_bf16 v[192:207], v[24:27], v[248:251], 0
    s_nop 7
    v_cndmask_b32 v144, v144, v160, s[64:65]
    v_cndmask_b32 v145, v145, v161, s[66:67]
    v_cndmask_b32 v146, v146, v162, s[68:69]
    v_cndmask_b32 v147, v147, v163, s[70:71]
    v_cndmask_b32 v148, v148, v164, s[72:73]
    v_cndmask_b32 v149, v149, v165, s[74:75]
    v_cndmask_b32 v150, v150, v166, s[76:77]
    v_cndmask_b32 v151, v151, v167, s[78:79]
    s_waitcnt vmcnt(8)
    v_mfma_f32_32x32x16_bf16 v[208:223], v[28:31], v[248:251], 0
    v_cndmask_b32 v152, v152, v168, s[80:81]
    v_cndmask_b32 v153, v153, v169, s[82:83]
    v_cndmask_b32 v154, v154, v170, s[84:85]
    v_cndmask_b32 v155, v155, v171, s[86:87]
    v_cndmask_b32 v156, v156, v172, s[88:89]
    v_cndmask_b32 v157, v157, v173, s[90:91]
    v_cndmask_b32 v158, v158, v174, s[92:93]
    v_cndmask_b32 v159, v159, v175, s[94:95]
    v_max3_f32 v2, v144, v145, v146
    v_max3_f32 v3, v147, v148, v149
    v_max3_f32 v2, v2, v150, v151
    v_max3_f32 v3, v3, v152, v153
    v_max3_f32 v2, v2, v154, v155
    v_max3_f32 v3, v3, v156, v157
    v_max3_f32 v2, v2, v158, v159
    s_waitcnt vmcnt(7)
    v_mfma_f32_32x32x16_bf16 v[144:159], v[32:35], v[248:251], 0
    s_cmp_ge_i32 s41, -1
    s_cselect_b32 s47, 0x3f803f80, 0
    v_mov_b32 v64, s47
    v_mov_b32 v65, s47
    v_mov_b32 v66, s47
    v_mov_b32 v67, s47
    v_mov_b32 v68, s47
    v_mov_b32 v69, s47
    v_mov_b32 v70, s47
    v_mov_b32 v71, s47
    v_add_u32 v237, 2048, v235
    s_mov_b32 exec_lo, 0xffff
    s_mov_b32 exec_hi, 0xffff
    buffer_load_dwordx4 v[64:67], v237, s[32:35], s44 offen sc1
    buffer_load_dwordx4 v[68:71], v237, s[32:35], s44 offen offset:1024 sc1
    s_mov_b64 exec, -1
    v_max3_f32 v2, v2, v176, v177
    v_max3_f32 v3, v3, v178, v179
    v_max3_f32 v2, v2, v180, v181
    v_max3_f32 v3, v3, v182, v183
    v_max3_f32 v2, v2, v184, v185
    v_max3_f32 v3, v3, v186, v187
    v_max3_f32 v2, v2, v188, v189
    v_max3_f32 v3, v3, v190, v191
    s_waitcnt vmcnt(8)
    v_mfma_f32_32x32x16_bf16 v[160:175], v[36:39], v[248:251], 0
    s_cmp_ge_i32 s41, -2
    s_cselect_b32 s47, 0x3f803f80, 0
    v_mov_b32 v72, s47
    v_mov_b32 v73, s47
    v_mov_b32 v74, s47
    v_mov_b32 v75, s47
    v_mov_b32 v76, s47
    v_mov_b32 v77, s47
    v_mov_b32 v78, s47
    v_mov_b32 v79, s47
    v_add_u32 v238, 4096, v235
    s_mov_b32 exec_lo, 0xffff
    s_mov_b32 exec_hi, 0xffff
    buffer_load_dwordx4 v[72:75], v238, s[32:35], s44 offen sc1
    buffer_load_dwordx4 v[76:79], v238, s[32:35], s44 offen offset:1024 sc1
    s_mov_b64 exec, -1
    v_max3_f32 v2, v2, v192, v193
    v_max3_f32 v3, v3, v194, v195
    v_max3_f32 v2, v2, v196, v197
    v_max3_f32 v3, v3, v198, v199
    v_max3_f32 v2, v2, v200, v201
    v_max3_f32 v3, v3, v202, v203
    v_max3_f32 v2, v2, v204, v205
    v_max3_f32 v3, v3, v206, v207
    s_waitcnt vmcnt(9)
    v_mfma_f32_32x32x16_bf16 v[176:191], v[40:43], v[248:251], 0
    s_cmp_ge_i32 s41, -3
    s_cselect_b32 s47, 0x3f803f80, 0
    v_mov_b32 v80, s47
    v_mov_b32 v81, s47
    v_mov_b32 v82, s47
    v_mov_b32 v83, s47
    v_mov_b32 v84, s47
    v_mov_b32 v85, s47
    v_mov_b32 v86, s47
    v_mov_b32 v87, s47
    v_add_u32 v239, 6144, v235
    s_mov_b32 exec_lo, 0xffff
    s_mov_b32 exec_hi, 0xffff
    buffer_load_dwordx4 v[80:83], v239, s[32:35], s44 offen sc1
    buffer_load_dwordx4 v[84:87], v239, s[32:35], s44 offen offset:1024 sc1
    s_mov_b64 exec, -1
    v_max3_f32 v2, v2, v208, v209
    v_max3_f32 v3, v3, v210, v211
    v_max3_f32 v2, v2, v212, v213
    v_max3_f32 v3, v3, v214, v215
    v_max3_f32 v2, v2, v216, v217
    v_max3_f32 v3, v3, v218, v219
    v_max3_f32 v2, v2, v220, v221
    v_max3_f32 v3, v3, v222, v223
    s_waitcnt vmcnt(10)
    v_mfma_f32_32x32x16_bf16 v[192:207], v[44:47], v[248:251], 0
    s_cmp_ge_i32 s41, -4
    s_cselect_b32 s47, 0x3f803f80, 0
    v_mov_b32 v88, s47
    v_mov_b32 v89, s47
    v_mov_b32 v90, s47
    v_mov_b32 v91, s47
    v_mov_b32 v92, s47
    v_mov_b32 v93, s47
    v_mov_b32 v94, s47
    v_mov_b32 v95, s47
    v_add_u32 v236, 8192, v235
    s_mov_b32 exec_lo, 0xffff
    s_mov_b32 exec_hi, 0xffff
    buffer_load_dwordx4 v[88:91], v236, s[32:35], s44 offen sc1
    buffer_load_dwordx4 v[92:95], v236, s[32:35], s44 offen offset:1024 sc1
    s_mov_b64 exec, -1
    v_max3_f32 v2, v2, v144, v145
    v_max3_f32 v3, v3, v146, v147
    v_max3_f32 v2, v2, v148, v149
    v_max3_f32 v3, v3, v150, v151
    v_max3_f32 v2, v2, v152, v153
    v_max3_f32 v3, v3, v154, v155
    v_max3_f32 v2, v2, v156, v157
    v_max3_f32 v3, v3, v158, v159
    v_mfma_f32_32x32x16_bf16 v[208:223], v[20:23], v[252:255], 0
    s_waitcnt vmcnt(8)
    buffer_store_dword v11, v12, s[32:35], s23 offen offset:0 sc1
    s_cmp_ge_i32 s41, -5
    s_cselect_b32 s47, 0x3f803f80, 0
    v_mov_b32 v96, s47
    v_mov_b32 v97, s47
    v_mov_b32 v98, s47
    v_mov_b32 v99, s47
    v_mov_b32 v100, s47
    v_mov_b32 v101, s47
    v_mov_b32 v102, s47
    v_mov_b32 v103, s47
    v_add_u32 v237, 10240, v235
    s_mov_b32 exec_lo, 0xffff
    s_mov_b32 exec_hi, 0xffff
    buffer_load_dwordx4 v[96:99], v237, s[32:35], s44 offen sc1
    buffer_load_dwordx4 v[100:103], v237, s[32:35], s44 offen offset:1024 sc1
    s_mov_b64 exec, -1
    v_max3_f32 v2, v2, v160, v161
    v_max3_f32 v3, v3, v162, v163
    v_max3_f32 v2, v2, v164, v165
    v_max3_f32 v3, v3, v166, v167
    v_max3_f32 v2, v2, v168, v169
    v_max3_f32 v3, v3, v170, v171
    v_max3_f32 v2, v2, v172, v173
    v_max3_f32 v3, v3, v174, v175
    v_mfma_f32_32x32x16_bf16 v[144:159], v[52:55], v[252:255], 0
    s_cmp_ge_i32 s41, -6
    s_cselect_b32 s47, 0x3f803f80, 0
    v_mov_b32 v104, s47
    v_mov_b32 v105, s47
    v_mov_b32 v106, s47
    v_mov_b32 v107, s47
    v_mov_b32 v108, s47
    v_mov_b32 v109, s47
    v_mov_b32 v110, s47
    v_mov_b32 v111, s47
    v_add_u32 v238, 12288, v235
    s_mov_b32 exec_lo, 0xffff
    s_mov_b32 exec_hi, 0xffff
    buffer_load_dwordx4 v[104:107], v238, s[32:35], s44 offen sc1
    buffer_load_dwordx4 v[108:111], v238, s[32:35], s44 offen offset:1024 sc1
    s_mov_b64 exec, -1
    v_max3_f32 v2, v2, v176, v177
    v_max3_f32 v3, v3, v178, v179
    v_max3_f32 v2, v2, v180, v181
    v_max3_f32 v3, v3, v182, v183
    v_max3_f32 v2, v2, v184, v185
    v_max3_f32 v3, v3, v186, v187
    v_max3_f32 v2, v2, v188, v189
    v_max3_f32 v3, v3, v190, v191
    v_mfma_f32_32x32x16_bf16 v[160:175], v[24:27], v[252:255], 0
    s_cmp_ge_i32 s41, -7
    s_cselect_b32 s47, 0x3f803f80, 0
    v_mov_b32 v112, s47
    v_mov_b32 v113, s47
    v_mov_b32 v114, s47
    v_mov_b32 v115, s47
    v_mov_b32 v116, s47
    v_mov_b32 v117, s47
    v_mov_b32 v118, s47
    v_mov_b32 v119, s47
    v_add_u32 v239, 14336, v235
    s_mov_b32 exec_lo, 0xffff
    s_mov_b32 exec_hi, 0xffff
    buffer_load_dwordx4 v[112:115], v239, s[32:35], s44 offen sc1
    buffer_load_dwordx4 v[116:119], v239, s[32:35], s44 offen offset:1024 sc1
    s_mov_b64 exec, -1
    v_max3_f32 v2, v2, v192, v193
    v_max3_f32 v3, v3, v194, v195
    v_max3_f32 v2, v2, v196, v197
    v_max3_f32 v3, v3, v198, v199
    v_max3_f32 v2, v2, v200, v201
    v_max3_f32 v3, v3, v202, v203
    v_max3_f32 v2, v2, v204, v205
    v_max3_f32 v3, v3, v206, v207
    v_mfma_f32_32x32x16_bf16 v[176:191], v[28:31], v[252:255], 0
    s_cmp_ge_i32 s41, 0
    s_cselect_b32 s47, 0x3f803f80, 0
    v_mov_b32 v56, s47
    v_mov_b32 v57, s47
    v_mov_b32 v58, s47
    v_mov_b32 v59, s47
    v_mov_b32 v60, s47
    v_mov_b32 v61, s47
    v_mov_b32 v62, s47
    v_mov_b32 v63, s47
    v_add_u32 v236, 0, v235
    s_mov_b32 exec_lo, 0xffff
    s_mov_b32 exec_hi, 0xffff
    buffer_load_dwordx4 v[56:59], v236, s[32:35], s44 offen sc1
    buffer_load_dwordx4 v[60:63], v236, s[32:35], s44 offen offset:1024 sc1
    s_mov_b64 exec, -1
    v_max_f32 v2, v2, v3
    v_mov_b32 v3, v2
    s_nop 1
    v_permlane32_swap_b32 v2, v3
    v_max_f32 v5, v2, v3
    v_cndmask_b32 v208, v208, v144, s[64:65]
    v_cndmask_b32 v209, v209, v145, s[66:67]
    v_cndmask_b32 v210, v210, v146, s[68:69]
    v_cndmask_b32 v211, v211, v147, s[70:71]
    v_cndmask_b32 v212, v212, v148, s[72:73]
    v_cndmask_b32 v213, v213, v149, s[74:75]
    v_cndmask_b32 v214, v214, v150, s[76:77]
    v_cndmask_b32 v215, v215, v151, s[78:79]
    v_mfma_f32_32x32x16_bf16 v[192:207], v[32:35], v[252:255], 0
    v_cndmask_b32 v216, v216, v152, s[80:81]
    v_cndmask_b32 v217, v217, v153, s[82:83]
    v_cndmask_b32 v218, v218, v154, s[84:85]
    v_cndmask_b32 v219, v219, v155, s[86:87]
    v_cndmask_b32 v220, v220, v156, s[88:89]
    v_cndmask_b32 v221, v221, v157, s[90:91]
    v_cndmask_b32 v222, v222, v158, s[92:93]
    v_cndmask_b32 v223, v223, v159, s[94:95]
    v_max3_f32 v2, v208, v209, v210
    v_max3_f32 v3, v211, v212, v213
    v_max3_f32 v2, v2, v214, v215
    v_max3_f32 v3, v3, v216, v217
    v_max3_f32 v2, v2, v218, v219
    v_max3_f32 v3, v3, v220, v221
    v_max3_f32 v2, v2, v222, v223
    v_mfma_f32_32x32x16_bf16 v[208:223], v[36:39], v[252:255], 0
    s_cmp_ge_i32 s41, -8
    s_cselect_b32 s47, 0x3f803f80, 0
    v_mov_b32 v120, s47
    v_mov_b32 v121, s47
    v_mov_b32 v122, s47
    v_mov_b32 v123, s47
    v_mov_b32 v124, s47
    v_mov_b32 v125, s47
    v_mov_b32 v126, s47
    v_mov_b32 v127, s47
    v_add_u32 v236, 16384, v235
    s_mov_b32 exec_lo, 0xffff
    s_mov_b32 exec_hi, 0xffff
    buffer_load_dwordx4 v[120:123], v236, s[32:35], s44 offen sc1
    buffer_load_dwordx4 v[124:127], v236, s[32:35], s44 offen offset:1024 sc1
    s_mov_b64 exec, -1
    v_max3_f32 v2, v2, v160, v161
    v_max3_f32 v3, v3, v162, v163
    v_max3_f32 v2, v2, v164, v165
    v_max3_f32 v3, v3, v166, v167
    v_max3_f32 v2, v2, v168, v169
    v_max3_f32 v3, v3, v170, v171
    v_max3_f32 v2, v2, v172, v173
    v_max3_f32 v3, v3, v174, v175
    v_mfma_f32_32x32x16_bf16 v[144:159], v[40:43], v[252:255], 0
    s_cmp_ge_i32 s41, -9
    s_cselect_b32 s47, 0x3f803f80, 0
    v_mov_b32 v128, s47
    v_mov_b32 v129, s47
    v_mov_b32 v130, s47
    v_mov_b32 v131, s47
    v_mov_b32 v132, s47
    v_mov_b32 v133, s47
    v_mov_b32 v134, s47
    v_mov_b32 v135, s47
    v_add_u32 v237, 18432, v235
    s_mov_b32 exec_lo, 0xffff
    s_mov_b32 exec_hi, 0xffff
    buffer_load_dwordx4 v[128:131], v237, s[32:35], s44 offen sc1
    buffer_load_dwordx4 v[132:135], v237, s[32:35], s44 offen offset:1024 sc1
    s_mov_b64 exec, -1
    s_mov_b64 exec, 1
    ds_add_u32 v8, v232 offset:18048
    s_mov_b64 exec, -1
    v_max3_f32 v2, v2, v176, v177
    v_max3_f32 v3, v3, v178, v179
    v_max3_f32 v2, v2, v180, v181
    v_max3_f32 v3, v3, v182, v183
    v_max3_f32 v2, v2, v184, v185
    v_max3_f32 v3, v3, v186, v187
    v_max3_f32 v2, v2, v188, v189
    v_max3_f32 v3, v3, v190, v191
    v_mfma_f32_32x32x16_bf16 v[160:175], v[44:47], v[252:255], 0
    v_max3_f32 v2, v2, v192, v193
    v_max3_f32 v3, v3, v194, v195
    v_max3_f32 v2, v2, v196, v197
    v_max3_f32 v3, v3, v198, v199
    v_max3_f32 v2, v2, v200, v201
    v_max3_f32 v3, v3, v202, v203
    v_max3_f32 v2, v2, v204, v205
    v_max3_f32 v3, v3, v206, v207
    v_mfma_f32_32x32x16_bf16 v[176:191], v[48:51], v[252:255], 0
    v_max3_f32 v2, v2, v208, v209
    v_max3_f32 v3, v3, v210, v211
    v_max3_f32 v2, v2, v212, v213
    v_max3_f32 v3, v3, v214, v215
    v_max3_f32 v2, v2, v216, v217
    v_max3_f32 v3, v3, v218, v219
    v_max3_f32 v2, v2, v220, v221
    v_max3_f32 v3, v3, v222, v223
    v_max3_f32 v2, v2, v144, v145
    v_max3_f32 v3, v3, v146, v147
    v_max3_f32 v2, v2, v148, v149
    v_max3_f32 v3, v3, v150, v151
    v_max3_f32 v2, v2, v152, v153
    v_max3_f32 v3, v3, v154, v155
    v_max3_f32 v2, v2, v156, v157
    v_max3_f32 v3, v3, v158, v159
    v_max3_f32 v2, v2, v160, v161
    v_max3_f32 v3, v3, v162, v163
    v_max3_f32 v2, v2, v164, v165
    v_max3_f32 v3, v3, v166, v167
    v_max3_f32 v2, v2, v168, v169
    v_max3_f32 v3, v3, v170, v171
    v_max3_f32 v2, v2, v172, v173
    v_max3_f32 v3, v3, v174, v175
    v_max3_f32 v2, v2, v176, v177
    v_max3_f32 v3, v3, v178, v179
    v_max3_f32 v2, v2, v180, v181
    v_max3_f32 v3, v3, v182, v183
    v_max3_f32 v2, v2, v184, v185
    v_max3_f32 v3, v3, v186, v187
    v_max3_f32 v2, v2, v188, v189
    v_max3_f32 v3, v3, v190, v191
    v_max_f32 v2, v2, v3
    v_mov_b32 v3, v2
    s_nop 1
    v_permlane32_swap_b32 v2, v3
    v_max_f32 v6, v2, v3
    v_sub_f32 v192, 0, v5
    v_sub_f32 v193, 0, v5
    v_sub_f32 v194, 0, v5
    v_sub_f32 v195, 0, v5
    v_sub_f32 v196, 0, v5
    v_sub_f32 v197, 0, v5
    v_sub_f32 v198, 0, v5
    v_sub_f32 v199, 0, v5
    v_sub_f32 v200, 0, v5
    v_sub_f32 v201, 0, v5
    v_sub_f32 v202, 0, v5
    v_sub_f32 v203, 0, v5
    v_sub_f32 v204, 0, v5
    v_sub_f32 v205, 0, v5
    v_sub_f32 v206, 0, v5
    v_sub_f32 v207, 0, v5
    s_nop 1
    v_mfma_f32_32x32x16_bf16 v[176:191], v[20:23], v[248:251], v[192:207]
    v_mfma_f32_32x32x16_bf16 v[144:159], v[24:27], v[248:251], v[192:207]
    v_mfma_f32_32x32x16_bf16 v[160:175], v[28:31], v[248:251], v[192:207]
    s_nop 9
    v_exp_f32 v176, v176
    v_exp_f32 v177, v177
    v_exp_f32 v178, v178
    v_exp_f32 v179, v179
    v_exp_f32 v180, v180
    v_exp_f32 v181, v181
    v_exp_f32 v182, v182
    v_exp_f32 v183, v183
    v_cvt_pk_bf16_f32 v224, v176, v177
    v_cvt_pk_bf16_f32 v225, v178, v179
    v_cvt_pk_bf16_f32 v226, v180, v181
    v_cvt_pk_bf16_f32 v227, v182, v183
    v_exp_f32 v184, v184
    v_exp_f32 v185, v185
    s_waitcnt vmcnt(19)
    v_mfma_f32_32x32x16_bf16 v[208:223], v[64:67], v[224:227], 0
    v_exp_f32 v186, v186
    v_exp_f32 v187, v187
    v_exp_f32 v188, v188
    v_exp_f32 v189, v189
    v_exp_f32 v190, v190
    v_exp_f32 v191, v191
    v_cvt_pk_bf16_f32 v228, v184, v185
    v_cvt_pk_bf16_f32 v229, v186, v187
    v_cvt_pk_bf16_f32 v230, v188, v189
    v_cvt_pk_bf16_f32 v231, v190, v191
    v_mfma_f32_32x32x16_bf16 v[176:191], v[32:35], v[248:251], v[192:207]
    v_exp_f32 v144, v144
    v_exp_f32 v145, v145
    v_exp_f32 v146, v146
    v_exp_f32 v147, v147
    v_mfma_f32_32x32x16_bf16 v[208:223], v[68:71], v[228:231], v[208:223]
    v_exp_f32 v148, v148
    v_exp_f32 v149, v149
    v_exp_f32 v150, v150
    v_exp_f32 v151, v151
    v_cvt_pk_bf16_f32 v232, v144, v145
    v_cvt_pk_bf16_f32 v233, v146, v147
    v_cvt_pk_bf16_f32 v234, v148, v149
    v_cvt_pk_bf16_f32 v235, v150, v151
    v_exp_f32 v152, v152
    v_exp_f32 v153, v153
    s_waitcnt vmcnt(17)
    v_mfma_f32_32x32x16_bf16 v[208:223], v[72:75], v[232:235], v[208:223]
    v_exp_f32 v154, v154
    v_exp_f32 v155, v155
    v_exp_f32 v156, v156
    v_exp_f32 v157, v157
    v_exp_f32 v158, v158
    v_exp_f32 v159, v159
    v_cvt_pk_bf16_f32 v236, v152, v153
    v_cvt_pk_bf16_f32 v237, v154, v155
    v_cvt_pk_bf16_f32 v238, v156, v157
    v_cvt_pk_bf16_f32 v239, v158, v159
    v_mfma_f32_32x32x16_bf16 v[144:159], v[36:39], v[248:251], v[192:207]
    v_exp_f32 v160, v160
    v_exp_f32 v161, v161
    v_exp_f32 v162, v162
    v_exp_f32 v163, v163
    v_mfma_f32_32x32x16_bf16 v[208:223], v[76:79], v[236:239], v[208:223]
    v_exp_f32 v164, v164
    v_exp_f32 v165, v165
    v_exp_f32 v166, v166
    v_exp_f32 v167, v167
    v_cvt_pk_bf16_f32 v224, v160, v161
    v_cvt_pk_bf16_f32 v225, v162, v163
    v_cvt_pk_bf16_f32 v226, v164, v165
    v_cvt_pk_bf16_f32 v227, v166, v167
    v_exp_f32 v168, v168
    v_exp_f32 v169, v169
    s_waitcnt vmcnt(15)
    v_mfma_f32_32x32x16_bf16 v[208:223], v[80:83], v[224:227], v[208:223]
    v_exp_f32 v170, v170
    v_exp_f32 v171, v171
    v_exp_f32 v172, v172
    v_exp_f32 v173, v173
    v_exp_f32 v174, v174
    v_exp_f32 v175, v175
    v_cvt_pk_bf16_f32 v228, v168, v169
    v_cvt_pk_bf16_f32 v229, v170, v171
    v_cvt_pk_bf16_f32 v230, v172, v173
    v_cvt_pk_bf16_f32 v231, v174, v175
    v_mfma_f32_32x32x16_bf16 v[160:175], v[40:43], v[248:251], v[192:207]
    v_exp_f32 v176, v176
    v_exp_f32 v177, v177
    v_exp_f32 v178, v178
    v_exp_f32 v179, v179
    v_mfma_f32_32x32x16_bf16 v[208:223], v[84:87], v[228:231], v[208:223]
    v_exp_f32 v180, v180
    v_exp_f32 v181, v181
    v_exp_f32 v182, v182
    v_exp_f32 v183, v183
    v_cvt_pk_bf16_f32 v232, v176, v177
    v_cvt_pk_bf16_f32 v233, v178, v179
    v_cvt_pk_bf16_f32 v234, v180, v181
    v_cvt_pk_bf16_f32 v235, v182, v183
    v_exp_f32 v184, v184
    v_exp_f32 v185, v185
    s_waitcnt vmcnt(13)
    v_mfma_f32_32x32x16_bf16 v[208:223], v[88:91], v[232:235], v[208:223]
    v_exp_f32 v186, v186
    v_exp_f32 v187, v187
    v_exp_f32 v188, v188
    v_exp_f32 v189, v189
    v_exp_f32 v190, v190
    v_exp_f32 v191, v191
    v_cvt_pk_bf16_f32 v236, v184, v185
    v_cvt_pk_bf16_f32 v237, v186, v187
    v_cvt_pk_bf16_f32 v238, v188, v189
    v_cvt_pk_bf16_f32 v239, v190, v191
    v_mfma_f32_32x32x16_bf16 v[176:191], v[44:47], v[248:251], v[192:207]
    v_exp_f32 v144, v144
    v_exp_f32 v145, v145
    v_exp_f32 v146, v146
    v_exp_f32 v147, v147
    v_mfma_f32_32x32x16_bf16 v[208:223], v[92:95], v[236:239], v[208:223]
    v_exp_f32 v148, v148
    v_exp_f32 v149, v149
    v_exp_f32 v150, v150
    v_exp_f32 v151, v151
    v_cvt_pk_bf16_f32 v224, v144, v145
    v_cvt_pk_bf16_f32 v225, v146, v147
    v_cvt_pk_bf16_f32 v226, v148, v149
    v_cvt_pk_bf16_f32 v227, v150, v151
    v_exp_f32 v152, v152
    v_exp_f32 v153, v153
    s_waitcnt vmcnt(10)
    v_mfma_f32_32x32x16_bf16 v[208:223], v[96:99], v[224:227], v[208:223]
    v_exp_f32 v154, v154
    v_exp_f32 v155, v155
    v_exp_f32 v156, v156
    v_exp_f32 v157, v157
    v_exp_f32 v158, v158
    v_exp_f32 v159, v159
    v_cvt_pk_bf16_f32 v228, v152, v153
    v_cvt_pk_bf16_f32 v229, v154, v155
    v_cvt_pk_bf16_f32 v230, v156, v157
    v_cvt_pk_bf16_f32 v231, v158, v159
    v_mfma_f32_32x32x16_bf16 v[144:159], v[16:19], v[248:251], v[192:207]
    v_exp_f32 v160, v160
    v_exp_f32 v161, v161
    v_exp_f32 v162, v162
    v_exp_f32 v163, v163
    v_mfma_f32_32x32x16_bf16 v[208:223], v[100:103], v[228:231], v[208:223]
    v_exp_f32 v164, v164
    v_exp_f32 v165, v165
    v_exp_f32 v166, v166
    v_exp_f32 v167, v167
    v_cvt_pk_bf16_f32 v232, v160, v161
    v_cvt_pk_bf16_f32 v233, v162, v163
    v_cvt_pk_bf16_f32 v234, v164, v165
    v_cvt_pk_bf16_f32 v235, v166, v167
    v_exp_f32 v168, v168
    v_exp_f32 v169, v169
    s_waitcnt vmcnt(8)
    v_mfma_f32_32x32x16_bf16 v[208:223], v[104:107], v[232:235], v[208:223]
    v_exp_f32 v170, v170
    v_exp_f32 v171, v171
    v_exp_f32 v172, v172
    v_exp_f32 v173, v173
    v_exp_f32 v174, v174
    v_exp_f32 v175, v175
    v_cvt_pk_bf16_f32 v236, v168, v169
    v_cvt_pk_bf16_f32 v237, v170, v171
    v_cvt_pk_bf16_f32 v238, v172, v173
    v_cvt_pk_bf16_f32 v239, v174, v175
    v_mfma_f32_32x32x16_bf16 v[160:175], v[48:51], v[248:251], v[192:207]
    v_exp_f32 v176, v176
    v_exp_f32 v177, v177
    v_exp_f32 v178, v178
    v_exp_f32 v179, v179
    v_mfma_f32_32x32x16_bf16 v[208:223], v[108:111], v[236:239], v[208:223]
    v_exp_f32 v180, v180
    v_exp_f32 v181, v181
    v_exp_f32 v182, v182
    v_exp_f32 v183, v183
    v_cvt_pk_bf16_f32 v224, v176, v177
    v_cvt_pk_bf16_f32 v225, v178, v179
    v_cvt_pk_bf16_f32 v226, v180, v181
    v_cvt_pk_bf16_f32 v227, v182, v183
    v_exp_f32 v184, v184
    v_exp_f32 v185, v185
    s_waitcnt vmcnt(6)
    v_mfma_f32_32x32x16_bf16 v[208:223], v[112:115], v[224:227], v[208:223]
    v_exp_f32 v186, v186
    v_exp_f32 v187, v187
    v_exp_f32 v188, v188
    v_exp_f32 v189, v189
    v_exp_f32 v190, v190
    v_exp_f32 v191, v191
    v_cvt_pk_bf16_f32 v228, v184, v185
    v_cvt_pk_bf16_f32 v229, v186, v187
    v_cvt_pk_bf16_f32 v230, v188, v189
    v_cvt_pk_bf16_f32 v231, v190, v191
    v_cndmask_b32 v144, v144, v160, s[64:65]
    v_cndmask_b32 v145, v145, v161, s[66:67]
    v_cndmask_b32 v146, v146, v162, s[68:69]
    v_cndmask_b32 v147, v147, v163, s[70:71]
    v_cndmask_b32 v148, v148, v164, s[72:73]
    v_cndmask_b32 v149, v149, v165, s[74:75]
    v_mfma_f32_32x32x16_bf16 v[208:223], v[116:119], v[228:231], v[208:223]
    v_cndmask_b32 v150, v150, v166, s[76:77]
    v_cndmask_b32 v151, v151, v167, s[78:79]
    v_cndmask_b32 v152, v152, v168, s[80:81]
    v_cndmask_b32 v153, v153, v169, s[82:83]
    v_cndmask_b32 v154, v154, v170, s[84:85]
    v_cndmask_b32 v155, v155, v171, s[86:87]
    v_cndmask_b32 v156, v156, v172, s[88:89]
    v_cndmask_b32 v157, v157, v173, s[90:91]
    v_cndmask_b32 v158, v158, v174, s[92:93]
    v_cndmask_b32 v159, v159, v175, s[94:95]
    s_waitcnt vmcnt(4)
    s_waitcnt vmcnt(2)
    v_exp_f32 v144, v144
    v_exp_f32 v145, v145
    v_exp_f32 v146, v146
    v_exp_f32 v147, v147
    v_exp_f32 v148, v148
    v_exp_f32 v149, v149
    v_exp_f32 v150, v150
    v_exp_f32 v151, v151
    v_cvt_pk_bf16_f32 v232, v144, v145
    v_cvt_pk_bf16_f32 v233, v146, v147
    v_cvt_pk_bf16_f32 v234, v148, v149
    v_cvt_pk_bf16_f32 v235, v150, v151
    v_and_b32 v224, v240, v232
    v_and_b32 v225, v241, v233
    v_and_b32 v226, v242, v234
    v_and_b32 v227, v243, v235
    v_bfi_b32 v232, v240, 0, v232
    v_bfi_b32 v233, v241, 0, v233
    v_bfi_b32 v234, v242, 0, v234
    v_bfi_b32 v235, v243, 0, v235
    v_mfma_f32_32x32x16_bf16 v[208:223], v[120:123], v[224:227], v[208:223]
    v_exp_f32 v152, v152
    v_exp_f32 v153, v153
    v_exp_f32 v154, v154
    v_exp_f32 v155, v155
    v_mfma_f32_32x32x16_bf16 v[208:223], v[56:59], v[232:235], v[208:223]
    v_exp_f32 v156, v156
    v_exp_f32 v157, v157
    v_exp_f32 v158, v158
    v_exp_f32 v159, v159
    v_cvt_pk_bf16_f32 v236, v152, v153
    v_cvt_pk_bf16_f32 v237, v154, v155
    v_cvt_pk_bf16_f32 v238, v156, v157
    v_cvt_pk_bf16_f32 v239, v158, v159
    v_and_b32 v228, v244, v236
    v_and_b32 v229, v245, v237
    v_and_b32 v230, v246, v238
    v_and_b32 v231, v247, v239
    v_bfi_b32 v236, v244, 0, v236
    v_bfi_b32 v237, v245, 0, v237
    v_bfi_b32 v238, v246, 0, v238
    v_bfi_b32 v239, v247, 0, v239
    v_mfma_f32_32x32x16_bf16 v[208:223], v[124:127], v[228:231], v[208:223]
    s_nop 0
    v_mfma_f32_32x32x16_bf16 v[208:223], v[60:63], v[236:239], v[208:223]
    s_nop 11
    v_rcp_f32 v2, v216
    s_nop 0
    v_mul_f32 v160, v2, v208
    v_mul_f32 v161, v2, v209
    v_mul_f32 v162, v2, v210
    v_mul_f32 v163, v2, v211
    v_mul_f32 v164, v2, v212
    v_mul_f32 v165, v2, v213
    v_mul_f32 v166, v2, v214
    v_mul_f32 v167, v2, v215
    v_cvt_pk_bf16_f32 v136, v160, v161
    v_cvt_pk_bf16_f32 v137, v162, v163
    v_cvt_pk_bf16_f32 v138, v164, v165
    v_cvt_pk_bf16_f32 v139, v166, v167
    buffer_store_dwordx4 v[136:139], v1, s[32:35], s45 offen sc1
    v_sub_f32 v192, 0, v6
    v_sub_f32 v193, 0, v6
    v_sub_f32 v194, 0, v6
    v_sub_f32 v195, 0, v6
    v_sub_f32 v196, 0, v6
    v_sub_f32 v197, 0, v6
    v_sub_f32 v198, 0, v6
    v_sub_f32 v199, 0, v6
    v_sub_f32 v200, 0, v6
    v_sub_f32 v201, 0, v6
    v_sub_f32 v202, 0, v6
    v_sub_f32 v203, 0, v6
    v_sub_f32 v204, 0, v6
    v_sub_f32 v205, 0, v6
    v_sub_f32 v206, 0, v6
    v_sub_f32 v207, 0, v6
    s_nop 1
    v_mfma_f32_32x32x16_bf16 v[176:191], v[24:27], v[252:255], v[192:207]
    v_mfma_f32_32x32x16_bf16 v[144:159], v[28:31], v[252:255], v[192:207]
    v_mfma_f32_32x32x16_bf16 v[160:175], v[32:35], v[252:255], v[192:207]
    s_nop 9
    v_exp_f32 v176, v176
    v_exp_f32 v177, v177
    v_exp_f32 v178, v178
    v_exp_f32 v179, v179
    v_exp_f32 v180, v180
    v_exp_f32 v181, v181
    v_exp_f32 v182, v182
    v_exp_f32 v183, v183
    v_cvt_pk_bf16_f32 v224, v176, v177
    v_cvt_pk_bf16_f32 v225, v178, v179
    v_cvt_pk_bf16_f32 v226, v180, v181
    v_cvt_pk_bf16_f32 v227, v182, v183
    v_exp_f32 v184, v184
    v_exp_f32 v185, v185
    v_mfma_f32_32x32x16_bf16 v[208:223], v[72:75], v[224:227], 0
    v_exp_f32 v186, v186
    v_exp_f32 v187, v187
    v_exp_f32 v188, v188
    v_exp_f32 v189, v189
    v_exp_f32 v190, v190
    v_exp_f32 v191, v191
    v_cvt_pk_bf16_f32 v228, v184, v185
    v_cvt_pk_bf16_f32 v229, v186, v187
    v_cvt_pk_bf16_f32 v230, v188, v189
    v_cvt_pk_bf16_f32 v231, v190, v191
    v_mfma_f32_32x32x16_bf16 v[176:191], v[36:39], v[252:255], v[192:207]
    v_exp_f32 v144, v144
    v_exp_f32 v145, v145
    v_exp_f32 v146, v146
    v_exp_f32 v147, v147
    v_mfma_f32_32x32x16_bf16 v[208:223], v[76:79], v[228:231], v[208:223]
    v_exp_f32 v148, v148
    v_exp_f32 v149, v149
    v_exp_f32 v150, v150
    v_exp_f32 v151, v151
    v_cvt_pk_bf16_f32 v232, v144, v145
    v_cvt_pk_bf16_f32 v233, v146, v147
    v_cvt_pk_bf16_f32 v234, v148, v149
    v_cvt_pk_bf16_f32 v235, v150, v151
    v_exp_f32 v152, v152
    v_exp_f32 v153, v153
    v_mfma_f32_32x32x16_bf16 v[208:223], v[80:83], v[232:235], v[208:223]
    v_exp_f32 v154, v154
    v_exp_f32 v155, v155
    v_exp_f32 v156, v156
    v_exp_f32 v157, v157
    v_exp_f32 v158, v158
    v_exp_f32 v159, v159
    v_cvt_pk_bf16_f32 v236, v152, v153
    v_cvt_pk_bf16_f32 v237, v154, v155
    v_cvt_pk_bf16_f32 v238, v156, v157
    v_cvt_pk_bf16_f32 v239, v158, v159
    v_mfma_f32_32x32x16_bf16 v[144:159], v[40:43], v[252:255], v[192:207]
    v_exp_f32 v160, v160
    v_exp_f32 v161, v161
    v_exp_f32 v162, v162
    v_exp_f32 v163, v163
    v_mfma_f32_32x32x16_bf16 v[208:223], v[84:87], v[236:239], v[208:223]
    v_exp_f32 v164, v164
    v_exp_f32 v165, v165
    v_exp_f32 v166, v166
    v_exp_f32 v167, v167
    v_cvt_pk_bf16_f32 v224, v160, v161
    v_cvt_pk_bf16_f32 v225, v162, v163
    v_cvt_pk_bf16_f32 v226, v164, v165
    v_cvt_pk_bf16_f32 v227, v166, v167
    v_exp_f32 v168, v168
    v_exp_f32 v169, v169
    v_mfma_f32_32x32x16_bf16 v[208:223], v[88:91], v[224:227], v[208:223]
    v_exp_f32 v170, v170
    v_exp_f32 v171, v171
    v_exp_f32 v172, v172
    v_exp_f32 v173, v173
    v_exp_f32 v174, v174
    v_exp_f32 v175, v175
    v_cvt_pk_bf16_f32 v228, v168, v169
    v_cvt_pk_bf16_f32 v229, v170, v171
    v_cvt_pk_bf16_f32 v230, v172, v173
    v_cvt_pk_bf16_f32 v231, v174, v175
    v_mfma_f32_32x32x16_bf16 v[160:175], v[44:47], v[252:255], v[192:207]
    v_exp_f32 v176, v176
    v_exp_f32 v177, v177
    v_exp_f32 v178, v178
    v_exp_f32 v179, v179
    v_mfma_f32_32x32x16_bf16 v[208:223], v[92:95], v[228:231], v[208:223]
    v_exp_f32 v180, v180
    v_exp_f32 v181, v181
    v_exp_f32 v182, v182
    v_exp_f32 v183, v183
    v_cvt_pk_bf16_f32 v232, v176, v177
    v_cvt_pk_bf16_f32 v233, v178, v179
    v_cvt_pk_bf16_f32 v234, v180, v181
    v_cvt_pk_bf16_f32 v235, v182, v183
    v_exp_f32 v184, v184
    v_exp_f32 v185, v185
    v_mfma_f32_32x32x16_bf16 v[208:223], v[96:99], v[232:235], v[208:223]
    v_exp_f32 v186, v186
    v_exp_f32 v187, v187
    v_exp_f32 v188, v188
    v_exp_f32 v189, v189
    v_exp_f32 v190, v190
    v_exp_f32 v191, v191
    v_cvt_pk_bf16_f32 v236, v184, v185
    v_cvt_pk_bf16_f32 v237, v186, v187
    v_cvt_pk_bf16_f32 v238, v188, v189
    v_cvt_pk_bf16_f32 v239, v190, v191
    v_mfma_f32_32x32x16_bf16 v[176:191], v[48:51], v[252:255], v[192:207]
    v_exp_f32 v144, v144
    v_exp_f32 v145, v145
    v_exp_f32 v146, v146
    v_exp_f32 v147, v147
    v_mfma_f32_32x32x16_bf16 v[208:223], v[100:103], v[236:239], v[208:223]
    v_exp_f32 v148, v148
    v_exp_f32 v149, v149
    v_exp_f32 v150, v150
    v_exp_f32 v151, v151
    v_cvt_pk_bf16_f32 v224, v144, v145
    v_cvt_pk_bf16_f32 v225, v146, v147
    v_cvt_pk_bf16_f32 v226, v148, v149
    v_cvt_pk_bf16_f32 v227, v150, v151
    v_exp_f32 v152, v152
    v_exp_f32 v153, v153
    v_mfma_f32_32x32x16_bf16 v[208:223], v[104:107], v[224:227], v[208:223]
    v_exp_f32 v154, v154
    v_exp_f32 v155, v155
    v_exp_f32 v156, v156
    v_exp_f32 v157, v157
    v_exp_f32 v158, v158
    v_exp_f32 v159, v159
    v_cvt_pk_bf16_f32 v228, v152, v153
    v_cvt_pk_bf16_f32 v229, v154, v155
    v_cvt_pk_bf16_f32 v230, v156, v157
    v_cvt_pk_bf16_f32 v231, v158, v159
    v_mfma_f32_32x32x16_bf16 v[144:159], v[20:23], v[252:255], v[192:207]
    v_exp_f32 v160, v160
    v_exp_f32 v161, v161
    v_exp_f32 v162, v162
    v_exp_f32 v163, v163
    v_mfma_f32_32x32x16_bf16 v[208:223], v[108:111], v[228:231], v[208:223]
    v_exp_f32 v164, v164
    v_exp_f32 v165, v165
    v_exp_f32 v166, v166
    v_exp_f32 v167, v167
    v_cvt_pk_bf16_f32 v232, v160, v161
    v_cvt_pk_bf16_f32 v233, v162, v163
    v_cvt_pk_bf16_f32 v234, v164, v165
    v_cvt_pk_bf16_f32 v235, v166, v167
    v_exp_f32 v168, v168
    v_exp_f32 v169, v169
    v_mfma_f32_32x32x16_bf16 v[208:223], v[112:115], v[232:235], v[208:223]
    v_exp_f32 v170, v170
    v_exp_f32 v171, v171
    v_exp_f32 v172, v172
    v_exp_f32 v173, v173
    v_exp_f32 v174, v174
    v_exp_f32 v175, v175
    v_cvt_pk_bf16_f32 v236, v168, v169
    v_cvt_pk_bf16_f32 v237, v170, v171
    v_cvt_pk_bf16_f32 v238, v172, v173
    v_cvt_pk_bf16_f32 v239, v174, v175
    v_mfma_f32_32x32x16_bf16 v[160:175], v[52:55], v[252:255], v[192:207]
    v_exp_f32 v176, v176
    v_exp_f32 v177, v177
    v_exp_f32 v178, v178
    v_exp_f32 v179, v179
    v_mfma_f32_32x32x16_bf16 v[208:223], v[116:119], v[236:239], v[208:223]
    v_exp_f32 v180, v180
    v_exp_f32 v181, v181
    v_exp_f32 v182, v182
    v_exp_f32 v183, v183
    v_cvt_pk_bf16_f32 v224, v176, v177
    v_cvt_pk_bf16_f32 v225, v178, v179
    v_cvt_pk_bf16_f32 v226, v180, v181
    v_cvt_pk_bf16_f32 v227, v182, v183
    v_exp_f32 v184, v184
    v_exp_f32 v185, v185
    v_mfma_f32_32x32x16_bf16 v[208:223], v[120:123], v[224:227], v[208:223]
    v_exp_f32 v186, v186
    v_exp_f32 v187, v187
    v_exp_f32 v188, v188
    v_exp_f32 v189, v189
    v_exp_f32 v190, v190
    v_exp_f32 v191, v191
    v_cvt_pk_bf16_f32 v228, v184, v185
    v_cvt_pk_bf16_f32 v229, v186, v187
    v_cvt_pk_bf16_f32 v230, v188, v189
    v_cvt_pk_bf16_f32 v231, v190, v191
    v_cndmask_b32 v144, v144, v160, s[64:65]
    v_cndmask_b32 v145, v145, v161, s[66:67]
    v_cndmask_b32 v146, v146, v162, s[68:69]
    v_cndmask_b32 v147, v147, v163, s[70:71]
    v_cndmask_b32 v148, v148, v164, s[72:73]
    v_cndmask_b32 v149, v149, v165, s[74:75]
    v_mfma_f32_32x32x16_bf16 v[208:223], v[124:127], v[228:231], v[208:223]
    v_cndmask_b32 v150, v150, v166, s[76:77]
    v_cndmask_b32 v151, v151, v167, s[78:79]
    v_cndmask_b32 v152, v152, v168, s[80:81]
    v_cndmask_b32 v153, v153, v169, s[82:83]
    v_cndmask_b32 v154, v154, v170, s[84:85]
    v_cndmask_b32 v155, v155, v171, s[86:87]
    v_cndmask_b32 v156, v156, v172, s[88:89]
    v_cndmask_b32 v157, v157, v173, s[90:91]
    v_cndmask_b32 v158, v158, v174, s[92:93]
    v_cndmask_b32 v159, v159, v175, s[94:95]
    s_waitcnt vmcnt(1)
    v_exp_f32 v144, v144
    v_exp_f32 v145, v145
    v_exp_f32 v146, v146
    v_exp_f32 v147, v147
    v_exp_f32 v148, v148
    v_exp_f32 v149, v149
    v_exp_f32 v150, v150
    v_exp_f32 v151, v151
    v_cvt_pk_bf16_f32 v232, v144, v145
    v_cvt_pk_bf16_f32 v233, v146, v147
    v_cvt_pk_bf16_f32 v234, v148, v149
    v_cvt_pk_bf16_f32 v235, v150, v151
    v_and_b32 v224, v240, v232
    v_and_b32 v225, v241, v233
    v_and_b32 v226, v242, v234
    v_and_b32 v227, v243, v235
    v_bfi_b32 v232, v240, 0, v232
    v_bfi_b32 v233, v241, 0, v233
    v_bfi_b32 v234, v242, 0, v234
    v_bfi_b32 v235, v243, 0, v235
    v_mfma_f32_32x32x16_bf16 v[208:223], v[128:131], v[224:227], v[208:223]
    v_exp_f32 v152, v152
    v_exp_f32 v153, v153
    v_exp_f32 v154, v154
    v_exp_f32 v155, v155
    v_mfma_f32_32x32x16_bf16 v[208:223], v[64:67], v[232:235], v[208:223]
    v_exp_f32 v156, v156
    v_exp_f32 v157, v157
    v_exp_f32 v158, v158
    v_exp_f32 v159, v159
    v_cvt_pk_bf16_f32 v236, v152, v153
    v_cvt_pk_bf16_f32 v237, v154, v155
    v_cvt_pk_bf16_f32 v238, v156, v157
    v_cvt_pk_bf16_f32 v239, v158, v159
    v_and_b32 v228, v244, v236
    v_and_b32 v229, v245, v237
    v_and_b32 v230, v246, v238
    v_and_b32 v231, v247, v239
    v_bfi_b32 v236, v244, 0, v236
    v_bfi_b32 v237, v245, 0, v237
    v_bfi_b32 v238, v246, 0, v238
    v_bfi_b32 v239, v247, 0, v239
    v_mfma_f32_32x32x16_bf16 v[208:223], v[132:135], v[228:231], v[208:223]
    s_nop 0
    v_mfma_f32_32x32x16_bf16 v[208:223], v[68:71], v[236:239], v[208:223]
    s_nop 11
    v_rcp_f32 v2, v216
    s_nop 0
    v_mul_f32 v160, v2, v208
    v_mul_f32 v161, v2, v209
    v_mul_f32 v162, v2, v210
    v_mul_f32 v163, v2, v211
    v_mul_f32 v164, v2, v212
    v_mul_f32 v165, v2, v213
    v_mul_f32 v166, v2, v214
    v_mul_f32 v167, v2, v215
    v_cvt_pk_bf16_f32 v140, v160, v161
    v_cvt_pk_bf16_f32 v141, v162, v163
    v_cvt_pk_bf16_f32 v142, v164, v165
    v_cvt_pk_bf16_f32 v143, v166, v167
    s_add_u32 s45, s45, 147456
    buffer_store_dwordx4 v[140:143], v1, s[32:35], s45 offen sc1
    s_waitcnt vmcnt(0)
    buffer_store_dword v11, v12, s[32:35], s46 offen offset:0 sc1
    v_mov_b32 v232, 1
    s_mov_b64 exec, 1
    ds_add_u32 v8, v232 offset:18096
    s_mov_b64 exec, -1
    s_endpgm
L_loader:
    s_mov_b32 s40, s70
    s_and_b32 s41, s71, 0xffff
    s_mov_b32 s42, 1572864
    s_mov_b32 s43, 0x20000
    s_mov_b32 s44, s76
    s_and_b32 s45, s77, 0xffff
    s_mov_b32 s46, 1835008
    s_mov_b32 s47, 0x20000
    s_mov_b32 s48, s78
    s_and_b32 s49, s79, 0xffff
    s_mov_b32 s50, 3584
    s_mov_b32 s51, 0x20000
    s_sub_u32 s15, s7, 4
    v_lshrrev_b32 v5, 3, v0
    v_and_b32 v6, 7, v0
    v_bfe_u32 v7, v0, 4, 1
    v_lshlrev_b32 v7, 2, v7
    v_xor_b32 v6, v6, v7
    v_lshlrev_b32 v6, 4, v6
    v_mul_u32_u24 v2, 3072, v5
    v_add_u32 v2, v2, v6
    v_mul_u32_u24 v3, 3584, v5
    v_add_u32 v3, v3, v6
    v_lshl_add_u32 v9, v5, 10, v6
    v_lshrrev_b32 v5, 2, v0
    v_and_b32 v6, 3, v0
    v_lshlrev_b32 v6, 4, v6
    v_mul_u32_u24 v4, 3584, v5
    v_add_u32 v4, v4, v6
    v_mov_b32 v12, 0
    s_cmp_eq_u32 s6, 1
    s_cbranch_scc1 L_lB
    s_mul_i32 s16, s15, 98304
    s_mul_i32 s17, s15, 114688
    s_lshl_b32 s18, s15, 12
    s_lshl_b32 s19, s15, 11
    s_lshl_b32 s24, s5, 7
    s_add_u32 s20, s16, s24
    s_add_u32 s21, s20, 1024
    s_add_u32 s22, s17, s24
    s_lshl_b32 s25, s5, 6
    s_add_u32 s25, s25, 3072
    s_add_u32 s23, s17, s25
    v_mov_b32 v11, 148992
    v_mov_b32 v13, 1
    s_add_u32 m0, s18, 0
    s_add_u32 s11, s20, 0
    buffer_load_dwordx4 v2, s[40:43], s11 offen lds
    s_add_u32 m0, s18, 1024
    s_add_u32 s11, s20, 24576
    buffer_load_dwordx4 v2, s[40:43], s11 offen lds
    s_add_u32 m0, s18, 2048
    s_add_u32 s11, s20, 49152
    buffer_load_dwordx4 v2, s[40:43], s11 offen lds
    s_add_u32 m0, s18, 3072
    s_add_u32 s11, s20, 73728
    buffer_load_dwordx4 v2, s[40:43], s11 offen lds
    v_lshlrev_b32 v5, 1, v0
    buffer_load_ushort v6, v5, s[48:51], s24 offen
    buffer_load_ushort v7, v5, s[48:51], s25 offen
    s_and_b32 s12, s4, 7
    s_lshl_b32 s12, s12, 6
    s_lshl_b32 s13, s15, 4
    s_sub_u32 s12, s12, s13
    v_and_b32 v14, 15, v0
    v_add_u32 v14, s12, v14
    v_mul_i32_i24 v15, 3072, v14
    v_mul_i32_i24 v121, 3584, v14
    v_add_u32 v8, s20, v15
    buffer_load_dword v120, v8, s[40:43], 0 offen
    v_add_u32 v8, s21, v15
    buffer_load_dword v120, v8, s[40:43], 0 offen
    v_add_u32 v8, s22, v121
    buffer_load_dword v120, v8, s[44:47], 0 offen
    v_add_u32 v8, s23, v121
    buffer_load_dword v120, v8, s[44:47], 0 offen
    s_mov_b32 s52, s80
    s_and_b32 s53, s81, 0xffff
    s_mov_b32 s54, 1835008
    s_mov_b32 s55, 0x20000
    s_mov_b32 s56, s72
    s_and_b32 s57, s73, 0xffff
    s_mov_b32 s58, 524288
    s_mov_b32 s59, 0x20000
    s_lshl_b32 s12, s2, 2
    s_add_u32 s12, s12, s15
    s_mul_i32 s11, s12, 1792
    v_min_u32 v14, 13, v0
    v_lshlrev_b32 v14, 7, v14
    buffer_load_dword v120, v14, s[52:55], s11 offen
    s_lshl_b32 s11, s12, 9
    v_min_u32 v14, 3, v0
    v_lshlrev_b32 v14, 7, v14
    buffer_load_dword v120, v14, s[56:59], s11 offen
    v_lshlrev_b32 v5, 2, v0
    v_add_u32 v5, 147456, v5
    s_waitcnt vmcnt(6)
    v_lshlrev_b32 v6, 16, v6
    v_lshlrev_b32 v7, 16, v7
    ds_write_b32 v5, v6
    ds_write_b32 v5, v7 offset:256
    s_mov_b64 exec, 1
    ds_add_u32 v11, v13 offset:44
    s_mov_b64 exec, -1
    s_mov_b32 s11, 0
L_lw2_46:
    ds_read_b32 v10, v11 offset:160
    s_waitcnt lgkmcnt(0)
    v_readfirstlane_b32 s12, v10
    s_add_u32 s11, s11, 1
    s_nop 0
    s_cmp_ge_u32 s12, 4
    s_cbranch_scc1 L_lg_45
    s_sleep 1
    s_cmp_lt_u32 s11, 2097152
    s_cbranch_scc1 L_lw2_46
L_lg_45:
    s_add_u32 m0, s18, 16384
    s_add_u32 s11, s20, 393216
    buffer_load_dwordx4 v2, s[40:43], s11 offen lds
    s_add_u32 m0, s18, 17408
    s_add_u32 s11, s20, 417792
    buffer_load_dwordx4 v2, s[40:43], s11 offen lds
    s_add_u32 m0, s18, 18432
    s_add_u32 s11, s20, 442368
    buffer_load_dwordx4 v2, s[40:43], s11 offen lds
    s_add_u32 m0, s18, 19456
    s_add_u32 s11, s20, 466944
    buffer_load_dwordx4 v2, s[40:43], s11 offen lds
    s_add_u32 m0, s18, 32768
    s_add_u32 s11, s20, 786432
    buffer_load_dwordx4 v2, s[40:43], s11 offen lds
    s_add_u32 m0, s18, 33792
    s_add_u32 s11, s20, 811008
    buffer_load_dwordx4 v2, s[40:43], s11 offen lds
    s_add_u32 m0, s18, 34816
    s_add_u32 s11, s20, 835584
    buffer_load_dwordx4 v2, s[40:43], s11 offen lds
    s_add_u32 m0, s18, 35840
    s_add_u32 s11, s20, 860160
    buffer_load_dwordx4 v2, s[40:43], s11 offen lds
    s_mov_b32 s11, 0
L_lw2_48:
    ds_read_b32 v10, v11 offset:164
    s_waitcnt lgkmcnt(0)
    v_readfirstlane_b32 s12, v10
    s_add_u32 s11, s11, 1
    s_nop 0
    s_cmp_ge_u32 s12, 4
    s_cbranch_scc1 L_lg_47
    s_sleep 1
    s_cmp_lt_u32 s11, 2097152
    s_cbranch_scc1 L_lw2_48
L_lg_47:
    s_add_u32 m0, s18, 49152
    s_add_u32 s11, s20, 1179648
    buffer_load_dwordx4 v2, s[40:43], s11 offen lds
    s_add_u32 m0, s18, 50176
    s_add_u32 s11, s20, 1204224
    buffer_load_dwordx4 v2, s[40:43], s11 offen lds
    s_add_u32 m0, s18, 51200
    s_add_u32 s11, s20, 1228800
    buffer_load_dwordx4 v2, s[40:43], s11 offen lds
    s_add_u32 m0, s18, 52224
    s_add_u32 s11, s20, 1253376
    buffer_load_dwordx4 v2, s[40:43], s11 offen lds
    s_add_u32 m0, s18, 65536
    s_add_u32 s11, s21, 0
    buffer_load_dwordx4 v2, s[40:43], s11 offen lds
    s_add_u32 m0, s18, 66560
    s_add_u32 s11, s21, 24576
    buffer_load_dwordx4 v2, s[40:43], s11 offen lds
    s_add_u32 m0, s18, 67584
    s_add_u32 s11, s21, 49152
    buffer_load_dwordx4 v2, s[40:43], s11 offen lds
    s_add_u32 m0, s18, 68608
    s_add_u32 s11, s21, 73728
    buffer_load_dwordx4 v2, s[40:43], s11 offen lds
    s_mov_b32 s52, s80
    s_and_b32 s53, s81, 0xffff
    s_mov_b32 s54, 1835008
    s_mov_b32 s55, 0x20000
    s_mov_b32 s56, s72
    s_and_b32 s57, s73, 0xffff
    s_mov_b32 s58, 524288
    s_mov_b32 s59, 0x20000
    s_mov_b32 s60, s82
    s_and_b32 s61, s83, 0xffff
    s_mov_b32 s62, 1024
    s_mov_b32 s63, 0x20000
    s_mov_b32 s64, s84
    s_and_b32 s65, s85, 0xffff
    s_mov_b32 s66, 2097152
    s_mov_b32 s67, 0x20000
    s_and_b32 s11, s2, 7
    s_lshr_b32 s12, s2, 3
    s_lshl_b32 s13, s11, 2
    s_and_b32 s14, s12, 3
    s_add_u32 s8, s13, s14
    s_lshr_b32 s9, s12, 2
    s_lshl_b32 s11, s9, 7
    s_mul_i32 s12, s8, 294912
    s_add_u32 s12, s12, 6291456
    s_mul_i32 s13, s15, 262144
    s_add_u32 s68, s13, s11
    s_add_u32 s68, s68, 524288
    s_mul_i32 s13, s15, 16384
    s_add_u32 s72, s13, s12
    s_add_u32 s72, s72, 32768
    s_mul_i32 s13, s15, 131072
    s_add_u32 s69, s13, s11
    s_add_u32 s69, s69, 0
    s_mul_i32 s13, s15, 8192
    s_add_u32 s73, s13, s12
    s_add_u32 s73, s73, 0
    s_mul_i32 s13, s15, 65536
    s_add_u32 s70, s13, s11
    s_add_u32 s70, s70, 1572864
    s_mul_i32 s13, s15, 4096
    s_add_u32 s74, s13, s12
    s_add_u32 s74, s74, 98304
    s_mul_i32 s13, s15, 131072
    s_add_u32 s71, s13, s11
    s_add_u32 s71, s71, 0
    s_mul_i32 s13, s15, 8192
    s_add_u32 s75, s13, s12
    s_add_u32 s75, s75, 114688
    s_lshl_b32 s76, s15, 11
    v_mov_b32 v5, v9
    s_waitcnt vmcnt(12)
    s_mov_b64 exec, 1
    ds_add_u32 v11, v13 offset:0
    s_mov_b64 exec, -1
    s_mov_b32 s11, 0
L_lw2_50:
    ds_read_b32 v10, v11 offset:168
    s_waitcnt lgkmcnt(0)
    v_readfirstlane_b32 s12, v10
    s_add_u32 s11, s11, 1
    s_nop 0
    s_cmp_ge_u32 s12, 4
    s_cbranch_scc1 L_lg_49
    s_sleep 1
    s_cmp_lt_u32 s11, 2097152
    s_cbranch_scc1 L_lw2_50
L_lg_49:
    s_add_u32 m0, s18, 81920
    s_add_u32 s11, s21, 393216
    buffer_load_dwordx4 v2, s[40:43], s11 offen lds
    s_add_u32 m0, s18, 82944
    s_add_u32 s11, s21, 417792
    buffer_load_dwordx4 v2, s[40:43], s11 offen lds
    s_add_u32 m0, s18, 83968
    s_add_u32 s11, s21, 442368
    buffer_load_dwordx4 v2, s[40:43], s11 offen lds
    s_add_u32 m0, s18, 84992
    s_add_u32 s11, s21, 466944
    buffer_load_dwordx4 v2, s[40:43], s11 offen lds
    s_waitcnt vmcnt(8)
    s_mov_b64 exec, 1
    ds_add_u32 v11, v13 offset:4
    s_mov_b64 exec, -1
    s_add_u32 m0, s18, 98304
    s_add_u32 s11, s21, 786432
    buffer_load_dwordx4 v2, s[40:43], s11 offen lds
    s_add_u32 m0, s18, 99328
    s_add_u32 s11, s21, 811008
    buffer_load_dwordx4 v2, s[40:43], s11 offen lds
    s_add_u32 m0, s18, 100352
    s_add_u32 s11, s21, 835584
    buffer_load_dwordx4 v2, s[40:43], s11 offen lds
    s_add_u32 m0, s18, 101376
    s_add_u32 s11, s21, 860160
    buffer_load_dwordx4 v2, s[40:43], s11 offen lds
    s_mov_b32 s11, 0
L_lw2_52:
    ds_read_b32 v10, v11 offset:172
    s_waitcnt lgkmcnt(0)
    v_readfirstlane_b32 s12, v10
    s_add_u32 s11, s11, 1
    s_nop 0
    s_cmp_ge_u32 s12, 4
    s_cbranch_scc1 L_lg_51
    s_sleep 1
    s_cmp_lt_u32 s11, 2097152
    s_cbranch_scc1 L_lw2_52
L_lg_51:
    s_add_u32 m0, s18, 114688
    s_add_u32 s11, s21, 1179648
    buffer_load_dwordx4 v2, s[40:43], s11 offen lds
    s_add_u32 m0, s18, 115712
    s_add_u32 s11, s21, 1204224
    buffer_load_dwordx4 v2, s[40:43], s11 offen lds
    s_add_u32 m0, s18, 116736
    s_add_u32 s11, s21, 1228800
    buffer_load_dwordx4 v2, s[40:43], s11 offen lds
    s_add_u32 m0, s18, 117760
    s_add_u32 s11, s21, 1253376
    buffer_load_dwordx4 v2, s[40:43], s11 offen lds
    s_add_u32 m0, s18, 131072
    s_add_u32 s11, s22, 0
    buffer_load_dwordx4 v3, s[44:47], s11 offen lds
    s_add_u32 m0, s18, 132096
    s_add_u32 s11, s22, 28672
    buffer_load_dwordx4 v3, s[44:47], s11 offen lds
    s_add_u32 m0, s18, 133120
    s_add_u32 s11, s22, 57344
    buffer_load_dwordx4 v3, s[44:47], s11 offen lds
    s_add_u32 m0, s18, 134144
    s_add_u32 s11, s22, 86016
    buffer_load_dwordx4 v3, s[44:47], s11 offen lds
    s_waitcnt vmcnt(12)
    s_mov_b64 exec, 1
    ds_add_u32 v11, v13 offset:8
    s_mov_b64 exec, -1
    s_add_u32 s13, s68, 180224
    buffer_load_dwordx4 v[136:139], v5, s[52:55], s13 offen
    s_add_u32 s13, s68, 188416
    buffer_load_dwordx4 v[140:143], v5, s[52:55], s13 offen
    s_add_u32 s13, s68, 65536
    buffer_load_dwordx4 v[144:147], v5, s[52:55], s13 offen
    s_add_u32 s13, s68, 73728
    buffer_load_dwordx4 v[148:151], v5, s[52:55], s13 offen
    s_add_u32 s13, s68, 81920
    buffer_load_dwordx4 v[152:155], v5, s[52:55], s13 offen
    s_add_u32 s13, s68, 90112
    buffer_load_dwordx4 v[156:159], v5, s[52:55], s13 offen
    s_waitcnt vmcnt(6)
    s_mov_b64 exec, 1
    ds_add_u32 v11, v13 offset:12
    s_mov_b64 exec, -1
    s_add_u32 s13, s68, 196608
    buffer_load_dwordx4 v[160:163], v5, s[52:55], s13 offen
    s_add_u32 s13, s68, 204800
    buffer_load_dwordx4 v[164:167], v5, s[52:55], s13 offen
    s_add_u32 s13, s68, 212992
    buffer_load_dwordx4 v[168:171], v5, s[52:55], s13 offen
    s_add_u32 s13, s68, 221184
    buffer_load_dwordx4 v[172:175], v5, s[52:55], s13 offen
    s_add_u32 s13, s69, 0
    buffer_load_dwordx4 v[176:179], v5, s[52:55], s13 offen
    s_add_u32 s13, s69, 8192
    buffer_load_dwordx4 v[180:183], v5, s[52:55], s13 offen
    s_add_u32 s13, s69, 16384
    buffer_load_dwordx4 v[184:187], v5, s[52:55], s13 offen
    s_add_u32 s13, s69, 24576
    buffer_load_dwordx4 v[188:191], v5, s[52:55], s13 offen
    s_add_u32 s13, s69, 65536
    buffer_load_dwordx4 v[192:195], v5, s[52:55], s13 offen
    s_add_u32 s13, s69, 73728
    buffer_load_dwordx4 v[196:199], v5, s[52:55], s13 offen
    s_mov_b32 s11, 0
L_lw2_54:
    ds_read_b32 v10, v11 offset:64
    s_waitcnt lgkmcnt(0)
    v_readfirstlane_b32 s12, v10
    s_add_u32 s11, s11, 1
    s_nop 0
    s_cmp_ge_u32 s12, 4
    s_cbranch_scc1 L_lg_53
    s_sleep 1
    s_cmp_lt_u32 s11, 2097152
    s_cbranch_scc1 L_lw2_54
L_lg_53:
    s_add_u32 m0, s18, 0
    s_add_u32 s11, s22, 458752
    buffer_load_dwordx4 v3, s[44:47], s11 offen lds
    s_add_u32 m0, s18, 1024
    s_add_u32 s11, s22, 487424
    buffer_load_dwordx4 v3, s[44:47], s11 offen lds
    s_add_u32 m0, s18, 2048
    s_add_u32 s11, s22, 516096
    buffer_load_dwordx4 v3, s[44:47], s11 offen lds
    s_add_u32 m0, s18, 3072
    s_add_u32 s11, s22, 544768
    buffer_load_dwordx4 v3, s[44:47], s11 offen lds
    s_add_u32 m0, s18, 16384
    s_add_u32 s11, s22, 917504
    buffer_load_dwordx4 v3, s[44:47], s11 offen lds
    s_add_u32 m0, s18, 17408
    s_add_u32 s11, s22, 946176
    buffer_load_dwordx4 v3, s[44:47], s11 offen lds
    s_add_u32 m0, s18, 18432
    s_add_u32 s11, s22, 974848
    buffer_load_dwordx4 v3, s[44:47], s11 offen lds
    s_add_u32 m0, s18, 19456
    s_add_u32 s11, s22, 1003520
    buffer_load_dwordx4 v3, s[44:47], s11 offen lds
    s_add_u32 m0, s18, 32768
    s_add_u32 s11, s22, 1376256
    buffer_load_dwordx4 v3, s[44:47], s11 offen lds
    s_add_u32 m0, s18, 33792
    s_add_u32 s11, s22, 1404928
    buffer_load_dwordx4 v3, s[44:47], s11 offen lds
    s_add_u32 m0, s18, 34816
    s_add_u32 s11, s22, 1433600
    buffer_load_dwordx4 v3, s[44:47], s11 offen lds
    s_add_u32 m0, s18, 35840
    s_add_u32 s11, s22, 1462272
    buffer_load_dwordx4 v3, s[44:47], s11 offen lds
    s_add_u32 m0, s19, 49152
    s_add_u32 s11, s23, 0
    buffer_load_dwordx4 v4, s[44:47], s11 offen lds
    s_add_u32 m0, s19, 50176
    s_add_u32 s11, s23, 57344
    buffer_load_dwordx4 v4, s[44:47], s11 offen lds
    s_add_u32 m0, s19, 57344
    s_add_u32 s11, s23, 458752
    buffer_load_dwordx4 v4, s[44:47], s11 offen lds
    s_add_u32 m0, s19, 58368
    s_add_u32 s11, s23, 516096
    buffer_load_dwordx4 v4, s[44:47], s11 offen lds
    s_waitcnt vmcnt(8)
    s_mov_b64 exec, 1
    ds_add_u32 v11, v13 offset:32
    s_mov_b64 exec, -1
    s_add_u32 s13, s69, 81920
    buffer_load_dwordx4 v[200:203], v5, s[52:55], s13 offen
    s_add_u32 s13, s69, 90112
    buffer_load_dwordx4 v[204:207], v5, s[52:55], s13 offen
    s_add_u32 s13, s68, 98304
    buffer_load_dwordx4 v[208:211], v5, s[52:55], s13 offen
    s_add_u32 s13, s68, 106496
    buffer_load_dwordx4 v[212:215], v5, s[52:55], s13 offen
    s_waitcnt vmcnt(4)
    s_mov_b64 exec, 1
    ds_add_u32 v11, v13 offset:36
    s_mov_b64 exec, -1
    s_add_u32 s13, s68, 114688
    buffer_load_dwordx4 v[216:219], v5, s[52:55], s13 offen
    s_add_u32 s13, s68, 122880
    buffer_load_dwordx4 v[220:223], v5, s[52:55], s13 offen
    s_add_u32 s13, s68, 229376
    buffer_load_dwordx4 v[224:227], v5, s[52:55], s13 offen
    s_add_u32 s13, s68, 237568
    buffer_load_dwordx4 v[228:231], v5, s[52:55], s13 offen
    s_mov_b32 s11, 0
L_lw2_56:
    ds_read_b32 v10, v11 offset:96
    s_waitcnt lgkmcnt(0)
    v_readfirstlane_b32 s12, v10
    s_add_u32 s11, s11, 1
    s_nop 0
    s_cmp_ge_u32 s12, 4
    s_cbranch_scc1 L_lg_55
    s_sleep 1
    s_cmp_lt_u32 s11, 2097152
    s_cbranch_scc1 L_lw2_56
L_lg_55:
    s_add_u32 m0, s19, 65536
    s_add_u32 s11, s23, 917504
    buffer_load_dwordx4 v4, s[44:47], s11 offen lds
    s_add_u32 m0, s19, 66560
    s_add_u32 s11, s23, 974848
    buffer_load_dwordx4 v4, s[44:47], s11 offen lds
    s_add_u32 m0, s19, 73728
    s_add_u32 s11, s23, 1376256
    buffer_load_dwordx4 v4, s[44:47], s11 offen lds
    s_add_u32 m0, s19, 74752
    s_add_u32 s11, s23, 1433600
    buffer_load_dwordx4 v4, s[44:47], s11 offen lds
    s_add_u32 m0, s76, 81920
    s_add_u32 s13, s68, 0
    buffer_load_dwordx4 v5, s[52:55], s13 offen lds
    s_add_u32 m0, s76, 82944
    s_add_u32 s13, s68, 8192
    buffer_load_dwordx4 v5, s[52:55], s13 offen lds
    s_add_u32 m0, s76, 90112
    s_add_u32 s13, s68, 16384
    buffer_load_dwordx4 v5, s[52:55], s13 offen lds
    s_add_u32 m0, s76, 91136
    s_add_u32 s13, s68, 24576
    buffer_load_dwordx4 v5, s[52:55], s13 offen lds
    s_add_u32 m0, s76, 98304
    s_add_u32 s13, s68, 131072
    buffer_load_dwordx4 v5, s[52:55], s13 offen lds
    s_add_u32 m0, s76, 99328
    s_add_u32 s13, s68, 139264
    buffer_load_dwordx4 v5, s[52:55], s13 offen lds
    s_waitcnt vmcnt(6)
    s_mov_b64 exec, 1
    ds_add_u32 v11, v13 offset:40
    s_mov_b64 exec, -1
    s_add_u32 m0, s76, 106496
    s_add_u32 s13, s68, 147456
    buffer_load_dwordx4 v5, s[52:55], s13 offen lds
    s_add_u32 m0, s76, 107520
    s_add_u32 s13, s68, 155648
    buffer_load_dwordx4 v5, s[52:55], s13 offen lds
    s_add_u32 m0, s76, 149504
    s_add_u32 s13, s68, 32768
    buffer_load_dwordx4 v5, s[52:55], s13 offen lds
    s_add_u32 m0, s76, 150528
    s_add_u32 s13, s68, 40960
    buffer_load_dwordx4 v5, s[52:55], s13 offen lds
    s_add_u32 m0, s76, 114688
    s_add_u32 s13, s68, 49152
    buffer_load_dwordx4 v5, s[52:55], s13 offen lds
    s_add_u32 m0, s76, 115712
    s_add_u32 s13, s68, 57344
    buffer_load_dwordx4 v5, s[52:55], s13 offen lds
    s_add_u32 m0, s76, 122880
    s_add_u32 s13, s68, 163840
    buffer_load_dwordx4 v5, s[52:55], s13 offen lds
    s_add_u32 m0, s76, 123904
    s_add_u32 s13, s68, 172032
    buffer_load_dwordx4 v5, s[52:55], s13 offen lds
    s_branch L_g2
L_lB:
    s_mul_i32 s16, s15, 98304
    s_mul_i32 s17, s15, 114688
    s_lshl_b32 s18, s15, 12
    s_lshl_b32 s19, s15, 11
    s_lshl_b32 s11, s5, 7
    s_add_u32 s20, s16, s11
    s_add_u32 s20, s20, 2048
    s_lshl_b32 s24, s5, 8
    s_add_u32 s24, s24, 1024
    s_add_u32 s25, s24, 128
    s_add_u32 s21, s17, s24
    s_add_u32 s22, s21, 128
    v_mov_b32 v11, 148992
    v_mov_b32 v13, 1
    s_xor_b32 s11, s2, 128
    s_or_b32 s27, s11, s15
    s_cmp_lg_u32 s27, 0
    s_cbranch_scc1 L_scan_skip_57
    s_mov_b32 s12, 15728640
    buffer_load_dwordx4 v[16:19], v1, s[32:35], s12 offen sc1
    s_add_u32 s12, s12, 1024
    buffer_load_dwordx4 v[20:23], v1, s[32:35], s12 offen sc1
    s_add_u32 s12, s12, 1024
    buffer_load_dwordx4 v[24:27], v1, s[32:35], s12 offen sc1
    s_add_u32 s12, s12, 1024
    buffer_load_dwordx4 v[28:31], v1, s[32:35], s12 offen sc1
    s_add_u32 s12, s12, 1024
    buffer_load_dwordx4 v[32:35], v1, s[32:35], s12 offen sc1
    s_add_u32 s12, s12, 1024
    buffer_load_dwordx4 v[36:39], v1, s[32:35], s12 offen sc1
    s_add_u32 s12, s12, 1024
    buffer_load_dwordx4 v[40:43], v1, s[32:35], s12 offen sc1
    s_add_u32 s12, s12, 1024
    buffer_load_dwordx4 v[44:47], v1, s[32:35], s12 offen sc1
    s_add_u32 s12, s12, 1024
    buffer_load_dwordx4 v[48:51], v1, s[32:35], s12 offen sc1
    s_add_u32 s12, s12, 1024
    buffer_load_dwordx4 v[52:55], v1, s[32:35], s12 offen sc1
    s_add_u32 s12, s12, 1024
    buffer_load_dwordx4 v[56:59], v1, s[32:35], s12 offen sc1
    s_add_u32 s12, s12, 1024
    buffer_load_dwordx4 v[60:63], v1, s[32:35], s12 offen sc1
    s_add_u32 s12, s12, 1024
    buffer_load_dwordx4 v[64:67], v1, s[32:35], s12 offen sc1
    s_add_u32 s12, s12, 1024
    buffer_load_dwordx4 v[68:71], v1, s[32:35], s12 offen sc1
    s_add_u32 s12, s12, 1024
    buffer_load_dwordx4 v[72:75], v1, s[32:35], s12 offen sc1
    s_add_u32 s12, s12, 1024
    buffer_load_dwordx4 v[76:79], v1, s[32:35], s12 offen sc1
    s_add_u32 s12, s12, 1024
    buffer_load_dwordx4 v[80:83], v1, s[32:35], s12 offen sc1
    s_add_u32 s12, s12, 1024
    buffer_load_dwordx4 v[84:87], v1, s[32:35], s12 offen sc1
    s_add_u32 s12, s12, 1024
    buffer_load_dwordx4 v[88:91], v1, s[32:35], s12 offen sc1
    s_add_u32 s12, s12, 1024
    buffer_load_dwordx4 v[92:95], v1, s[32:35], s12 offen sc1
    s_add_u32 s12, s12, 1024
    buffer_load_dwordx4 v[96:99], v1, s[32:35], s12 offen sc1
    s_add_u32 s12, s12, 1024
    buffer_load_dwordx4 v[100:103], v1, s[32:35], s12 offen sc1
    s_add_u32 s12, s12, 1024
    buffer_load_dwordx4 v[104:107], v1, s[32:35], s12 offen sc1
    s_add_u32 s12, s12, 1024
    buffer_load_dwordx4 v[108:111], v1, s[32:35], s12 offen sc1
    s_add_u32 s12, s12, 1024
L_scan_skip_57:
    s_add_u32 m0, s18, 0
    s_add_u32 s11, s20, 0
    buffer_load_dwordx4 v2, s[40:43], s11 offen lds
    s_add_u32 m0, s18, 1024
    s_add_u32 s11, s20, 24576
    buffer_load_dwordx4 v2, s[40:43], s11 offen lds
    s_add_u32 m0, s18, 2048
    s_add_u32 s11, s20, 49152
    buffer_load_dwordx4 v2, s[40:43], s11 offen lds
    s_add_u32 m0, s18, 3072
    s_add_u32 s11, s20, 73728
    buffer_load_dwordx4 v2, s[40:43], s11 offen lds
    v_lshlrev_b32 v5, 1, v0
    buffer_load_ushort v6, v5, s[48:51], s24 offen
    buffer_load_ushort v7, v5, s[48:51], s25 offen
    s_and_b32 s12, s4, 7
    s_lshl_b32 s12, s12, 6
    s_lshl_b32 s13, s15, 4
    s_sub_u32 s12, s12, s13
    v_and_b32 v14, 15, v0
    v_add_u32 v14, s12, v14
    v_mul_i32_i24 v15, 3072, v14
    v_mul_i32_i24 v121, 3584, v14
    v_add_u32 v8, s20, v15
    buffer_load_dword v120, v8, s[40:43], 0 offen
    v_add_u32 v8, s21, v121
    buffer_load_dword v120, v8, s[44:47], 0 offen
    v_add_u32 v8, s22, v121
    buffer_load_dword v120, v8, s[44:47], 0 offen
    s_mov_b32 s52, s80
    s_and_b32 s53, s81, 0xffff
    s_mov_b32 s54, 1835008
    s_mov_b32 s55, 0x20000
    s_mov_b32 s56, s72
    s_and_b32 s57, s73, 0xffff
    s_mov_b32 s58, 524288
    s_mov_b32 s59, 0x20000
    s_lshl_b32 s12, s2, 2
    s_add_u32 s12, s12, s15
    s_mul_i32 s11, s12, 1792
    v_min_u32 v14, 13, v0
    v_lshlrev_b32 v14, 7, v14
    buffer_load_dword v120, v14, s[52:55], s11 offen
    s_lshl_b32 s11, s12, 9
    v_min_u32 v14, 3, v0
    v_lshlrev_b32 v14, 7, v14
    buffer_load_dword v120, v14, s[56:59], s11 offen
    v_lshlrev_b32 v5, 2, v0
    v_add_u32 v5, 147456, v5
    s_waitcnt vmcnt(5)
    v_lshlrev_b32 v6, 16, v6
    v_lshlrev_b32 v7, 16, v7
    ds_write_b32 v5, v6
    ds_write_b32 v5, v7 offset:256
    s_mov_b64 exec, 1
    ds_add_u32 v11, v13 offset:44
    s_mov_b64 exec, -1
    s_cmp_lg_u32 s27, 0
    s_cbranch_scc1 L_scan_skip_58
    v_readfirstlane_b32 s13, v16
L_scan_59:
    s_nop 1
    s_add_u32 s13, s13, 1
    s_cmp_eq_u32 s13, 0
    s_cbranch_scc1 L_scan_59
    v_mov_b32 v148, -1
    v_mov_b32 v149, -1
    v_xor_b32 v144, s13, v16
    v_xor_b32 v145, s13, v17
    v_xor_b32 v146, s13, v18
    v_xor_b32 v147, s13, v19
    v_min3_u32 v148, v148, v144, v145
    v_min3_u32 v149, v149, v146, v147
    v_xor_b32 v144, s13, v20
    v_xor_b32 v145, s13, v21
    v_xor_b32 v146, s13, v22
    v_xor_b32 v147, s13, v23
    v_min3_u32 v148, v148, v144, v145
    v_min3_u32 v149, v149, v146, v147
    v_xor_b32 v144, s13, v24
    v_xor_b32 v145, s13, v25
    v_xor_b32 v146, s13, v26
    v_xor_b32 v147, s13, v27
    v_min3_u32 v148, v148, v144, v145
    v_min3_u32 v149, v149, v146, v147
    v_xor_b32 v144, s13, v28
    v_xor_b32 v145, s13, v29
    v_xor_b32 v146, s13, v30
    v_xor_b32 v147, s13, v31
    v_min3_u32 v148, v148, v144, v145
    v_min3_u32 v149, v149, v146, v147
    v_xor_b32 v144, s13, v32
    v_xor_b32 v145, s13, v33
    v_xor_b32 v146, s13, v34
    v_xor_b32 v147, s13, v35
    v_min3_u32 v148, v148, v144, v145
    v_min3_u32 v149, v149, v146, v147
    v_xor_b32 v144, s13, v36
    v_xor_b32 v145, s13, v37
    v_xor_b32 v146, s13, v38
    v_xor_b32 v147, s13, v39
    v_min3_u32 v148, v148, v144, v145
    v_min3_u32 v149, v149, v146, v147
    v_xor_b32 v144, s13, v40
    v_xor_b32 v145, s13, v41
    v_xor_b32 v146, s13, v42
    v_xor_b32 v147, s13, v43
    v_min3_u32 v148, v148, v144, v145
    v_min3_u32 v149, v149, v146, v147
    v_xor_b32 v144, s13, v44
    v_xor_b32 v145, s13, v45
    v_xor_b32 v146, s13, v46
    v_xor_b32 v147, s13, v47
    v_min3_u32 v148, v148, v144, v145
    v_min3_u32 v149, v149, v146, v147
    v_xor_b32 v144, s13, v48
    v_xor_b32 v145, s13, v49
    v_xor_b32 v146, s13, v50
    v_xor_b32 v147, s13, v51
    v_min3_u32 v148, v148, v144, v145
    v_min3_u32 v149, v149, v146, v147
    v_xor_b32 v144, s13, v52
    v_xor_b32 v145, s13, v53
    v_xor_b32 v146, s13, v54
    v_xor_b32 v147, s13, v55
    v_min3_u32 v148, v148, v144, v145
    v_min3_u32 v149, v149, v146, v147
    v_xor_b32 v144, s13, v56
    v_xor_b32 v145, s13, v57
    v_xor_b32 v146, s13, v58
    v_xor_b32 v147, s13, v59
    v_min3_u32 v148, v148, v144, v145
    v_min3_u32 v149, v149, v146, v147
    v_xor_b32 v144, s13, v60
    v_xor_b32 v145, s13, v61
    v_xor_b32 v146, s13, v62
    v_xor_b32 v147, s13, v63
    v_min3_u32 v148, v148, v144, v145
    v_min3_u32 v149, v149, v146, v147
    v_xor_b32 v144, s13, v64
    v_xor_b32 v145, s13, v65
    v_xor_b32 v146, s13, v66
    v_xor_b32 v147, s13, v67
    v_min3_u32 v148, v148, v144, v145
    v_min3_u32 v149, v149, v146, v147
    v_xor_b32 v144, s13, v68
    v_xor_b32 v145, s13, v69
    v_xor_b32 v146, s13, v70
    v_xor_b32 v147, s13, v71
    v_min3_u32 v148, v148, v144, v145
    v_min3_u32 v149, v149, v146, v147
    v_xor_b32 v144, s13, v72
    v_xor_b32 v145, s13, v73
    v_xor_b32 v146, s13, v74
    v_xor_b32 v147, s13, v75
    v_min3_u32 v148, v148, v144, v145
    v_min3_u32 v149, v149, v146, v147
    v_xor_b32 v144, s13, v76
    v_xor_b32 v145, s13, v77
    v_xor_b32 v146, s13, v78
    v_xor_b32 v147, s13, v79
    v_min3_u32 v148, v148, v144, v145
    v_min3_u32 v149, v149, v146, v147
    v_xor_b32 v144, s13, v80
    v_xor_b32 v145, s13, v81
    v_xor_b32 v146, s13, v82
    v_xor_b32 v147, s13, v83
    v_min3_u32 v148, v148, v144, v145
    v_min3_u32 v149, v149, v146, v147
    v_xor_b32 v144, s13, v84
    v_xor_b32 v145, s13, v85
    v_xor_b32 v146, s13, v86
    v_xor_b32 v147, s13, v87
    v_min3_u32 v148, v148, v144, v145
    v_min3_u32 v149, v149, v146, v147
    v_xor_b32 v144, s13, v88
    v_xor_b32 v145, s13, v89
    v_xor_b32 v146, s13, v90
    v_xor_b32 v147, s13, v91
    v_min3_u32 v148, v148, v144, v145
    v_min3_u32 v149, v149, v146, v147
    v_xor_b32 v144, s13, v92
    v_xor_b32 v145, s13, v93
    v_xor_b32 v146, s13, v94
    v_xor_b32 v147, s13, v95
    v_min3_u32 v148, v148, v144, v145
    v_min3_u32 v149, v149, v146, v147
    v_xor_b32 v144, s13, v96
    v_xor_b32 v145, s13, v97
    v_xor_b32 v146, s13, v98
    v_xor_b32 v147, s13, v99
    v_min3_u32 v148, v148, v144, v145
    v_min3_u32 v149, v149, v146, v147
    v_xor_b32 v144, s13, v100
    v_xor_b32 v145, s13, v101
    v_xor_b32 v146, s13, v102
    v_xor_b32 v147, s13, v103
    v_min3_u32 v148, v148, v144, v145
    v_min3_u32 v149, v149, v146, v147
    v_xor_b32 v144, s13, v104
    v_xor_b32 v145, s13, v105
    v_xor_b32 v146, s13, v106
    v_xor_b32 v147, s13, v107
    v_min3_u32 v148, v148, v144, v145
    v_min3_u32 v149, v149, v146, v147
    v_xor_b32 v144, s13, v108
    v_xor_b32 v145, s13, v109
    v_xor_b32 v146, s13, v110
    v_xor_b32 v147, s13, v111
    v_min3_u32 v148, v148, v144, v145
    v_min3_u32 v149, v149, v146, v147
    v_min_u32 v148, v148, v149
    v_cmp_eq_u32 vcc, 0, v148
    s_nop 1
    s_cmp_lg_u64 vcc, 0
    s_cbranch_scc1 L_scan_59
    v_mov_b32 v16, s13
    v_mov_b32 v17, 0
    buffer_store_dword v16, v17, s[36:39], 0 offen sc1
L_scan_skip_58:
    s_mov_b32 s11, 0
L_lw2_61:
    ds_read_b32 v10, v11 offset:160
    s_waitcnt lgkmcnt(0)
    v_readfirstlane_b32 s12, v10
    s_add_u32 s11, s11, 1
    s_nop 0
    s_cmp_ge_u32 s12, 4
    s_cbranch_scc1 L_lg_60
    s_sleep 1
    s_cmp_lt_u32 s11, 2097152
    s_cbranch_scc1 L_lw2_61
L_lg_60:
    s_add_u32 m0, s18, 16384
    s_add_u32 s11, s20, 393216
    buffer_load_dwordx4 v2, s[40:43], s11 offen lds
    s_add_u32 m0, s18, 17408
    s_add_u32 s11, s20, 417792
    buffer_load_dwordx4 v2, s[40:43], s11 offen lds
    s_add_u32 m0, s18, 18432
    s_add_u32 s11, s20, 442368
    buffer_load_dwordx4 v2, s[40:43], s11 offen lds
    s_add_u32 m0, s18, 19456
    s_add_u32 s11, s20, 466944
    buffer_load_dwordx4 v2, s[40:43], s11 offen lds
    s_add_u32 m0, s18, 32768
    s_add_u32 s11, s20, 786432
    buffer_load_dwordx4 v2, s[40:43], s11 offen lds
    s_add_u32 m0, s18, 33792
    s_add_u32 s11, s20, 811008
    buffer_load_dwordx4 v2, s[40:43], s11 offen lds
    s_add_u32 m0, s18, 34816
    s_add_u32 s11, s20, 835584
    buffer_load_dwordx4 v2, s[40:43], s11 offen lds
    s_add_u32 m0, s18, 35840
    s_add_u32 s11, s20, 860160
    buffer_load_dwordx4 v2, s[40:43], s11 offen lds
    s_mov_b32 s11, 0
L_lw2_63:
    ds_read_b32 v10, v11 offset:164
    s_waitcnt lgkmcnt(0)
    v_readfirstlane_b32 s12, v10
    s_add_u32 s11, s11, 1
    s_nop 0
    s_cmp_ge_u32 s12, 4
    s_cbranch_scc1 L_lg_62
    s_sleep 1
    s_cmp_lt_u32 s11, 2097152
    s_cbranch_scc1 L_lw2_63
L_lg_62:
    s_add_u32 m0, s18, 49152
    s_add_u32 s11, s20, 1179648
    buffer_load_dwordx4 v2, s[40:43], s11 offen lds
    s_add_u32 m0, s18, 50176
    s_add_u32 s11, s20, 1204224
    buffer_load_dwordx4 v2, s[40:43], s11 offen lds
    s_add_u32 m0, s18, 51200
    s_add_u32 s11, s20, 1228800
    buffer_load_dwordx4 v2, s[40:43], s11 offen lds
    s_add_u32 m0, s18, 52224
    s_add_u32 s11, s20, 1253376
    buffer_load_dwordx4 v2, s[40:43], s11 offen lds
    s_add_u32 m0, s18, 65536
    s_add_u32 s11, s21, 0
    buffer_load_dwordx4 v3, s[44:47], s11 offen lds
    s_add_u32 m0, s18, 66560
    s_add_u32 s11, s21, 28672
    buffer_load_dwordx4 v3, s[44:47], s11 offen lds
    s_add_u32 m0, s18, 67584
    s_add_u32 s11, s21, 57344
    buffer_load_dwordx4 v3, s[44:47], s11 offen lds
    s_add_u32 m0, s18, 68608
    s_add_u32 s11, s21, 86016
    buffer_load_dwordx4 v3, s[44:47], s11 offen lds
    s_mov_b32 s52, s80
    s_and_b32 s53, s81, 0xffff
    s_mov_b32 s54, 1835008
    s_mov_b32 s55, 0x20000
    s_mov_b32 s56, s72
    s_and_b32 s57, s73, 0xffff
    s_mov_b32 s58, 524288
    s_mov_b32 s59, 0x20000
    s_mov_b32 s60, s82
    s_and_b32 s61, s83, 0xffff
    s_mov_b32 s62, 1024
    s_mov_b32 s63, 0x20000
    s_mov_b32 s64, s84
    s_and_b32 s65, s85, 0xffff
    s_mov_b32 s66, 2097152
    s_mov_b32 s67, 0x20000
    s_and_b32 s11, s2, 7
    s_lshr_b32 s12, s2, 3
    s_lshl_b32 s13, s11, 2
    s_and_b32 s14, s12, 3
    s_add_u32 s8, s13, s14
    s_lshr_b32 s9, s12, 2
    s_lshl_b32 s11, s9, 7
    s_mul_i32 s12, s8, 294912
    s_add_u32 s12, s12, 6291456
    s_mul_i32 s13, s15, 262144
    s_add_u32 s68, s13, s11
    s_add_u32 s68, s68, 524288
    s_mul_i32 s13, s15, 16384
    s_add_u32 s72, s13, s12
    s_add_u32 s72, s72, 32768
    s_mul_i32 s13, s15, 131072
    s_add_u32 s69, s13, s11
    s_add_u32 s69, s69, 0
    s_mul_i32 s13, s15, 8192
    s_add_u32 s73, s13, s12
    s_add_u32 s73, s73, 0
    s_mul_i32 s13, s15, 65536
    s_add_u32 s70, s13, s11
    s_add_u32 s70, s70, 1572864
    s_mul_i32 s13, s15, 4096
    s_add_u32 s74, s13, s12
    s_add_u32 s74, s74, 98304
    s_mul_i32 s13, s15, 131072
    s_add_u32 s71, s13, s11
    s_add_u32 s71, s71, 0
    s_mul_i32 s13, s15, 8192
    s_add_u32 s75, s13, s12
    s_add_u32 s75, s75, 114688
    s_lshl_b32 s76, s15, 11
    v_mov_b32 v5, v9
    s_waitcnt vmcnt(12)
    s_mov_b64 exec, 1
    ds_add_u32 v11, v13 offset:0
    s_mov_b64 exec, -1
    s_mov_b32 s11, 0
L_lw2_65:
    ds_read_b32 v10, v11 offset:168
    s_waitcnt lgkmcnt(0)
    v_readfirstlane_b32 s12, v10
    s_add_u32 s11, s11, 1
    s_nop 0
    s_cmp_ge_u32 s12, 4
    s_cbranch_scc1 L_lg_64
    s_sleep 1
    s_cmp_lt_u32 s11, 2097152
    s_cbranch_scc1 L_lw2_65
L_lg_64:
    s_add_u32 m0, s18, 81920
    s_add_u32 s11, s21, 458752
    buffer_load_dwordx4 v3, s[44:47], s11 offen lds
    s_add_u32 m0, s18, 82944
    s_add_u32 s11, s21, 487424
    buffer_load_dwordx4 v3, s[44:47], s11 offen lds
    s_add_u32 m0, s18, 83968
    s_add_u32 s11, s21, 516096
    buffer_load_dwordx4 v3, s[44:47], s11 offen lds
    s_add_u32 m0, s18, 84992
    s_add_u32 s11, s21, 544768
    buffer_load_dwordx4 v3, s[44:47], s11 offen lds
    s_waitcnt vmcnt(8)
    s_mov_b64 exec, 1
    ds_add_u32 v11, v13 offset:4
    s_mov_b64 exec, -1
    s_add_u32 m0, s18, 98304
    s_add_u32 s11, s21, 917504
    buffer_load_dwordx4 v3, s[44:47], s11 offen lds
    s_add_u32 m0, s18, 99328
    s_add_u32 s11, s21, 946176
    buffer_load_dwordx4 v3, s[44:47], s11 offen lds
    s_add_u32 m0, s18, 100352
    s_add_u32 s11, s21, 974848
    buffer_load_dwordx4 v3, s[44:47], s11 offen lds
    s_add_u32 m0, s18, 101376
    s_add_u32 s11, s21, 1003520
    buffer_load_dwordx4 v3, s[44:47], s11 offen lds
    s_mov_b32 s11, 0
L_lw2_67:
    ds_read_b32 v10, v11 offset:172
    s_waitcnt lgkmcnt(0)
    v_readfirstlane_b32 s12, v10
    s_add_u32 s11, s11, 1
    s_nop 0
    s_cmp_ge_u32 s12, 4
    s_cbranch_scc1 L_lg_66
    s_sleep 1
    s_cmp_lt_u32 s11, 2097152
    s_cbranch_scc1 L_lw2_67
L_lg_66:
    s_add_u32 m0, s18, 114688
    s_add_u32 s11, s21, 1376256
    buffer_load_dwordx4 v3, s[44:47], s11 offen lds
    s_add_u32 m0, s18, 115712
    s_add_u32 s11, s21, 1404928
    buffer_load_dwordx4 v3, s[44:47], s11 offen lds
    s_add_u32 m0, s18, 116736
    s_add_u32 s11, s21, 1433600
    buffer_load_dwordx4 v3, s[44:47], s11 offen lds
    s_add_u32 m0, s18, 117760
    s_add_u32 s11, s21, 1462272
    buffer_load_dwordx4 v3, s[44:47], s11 offen lds
    s_add_u32 m0, s18, 131072
    s_add_u32 s11, s22, 0
    buffer_load_dwordx4 v3, s[44:47], s11 offen lds
    s_add_u32 m0, s18, 132096
    s_add_u32 s11, s22, 28672
    buffer_load_dwordx4 v3, s[44:47], s11 offen lds
    s_add_u32 m0, s18, 133120
    s_add_u32 s11, s22, 57344
    buffer_load_dwordx4 v3, s[44:47], s11 offen lds
    s_add_u32 m0, s18, 134144
    s_add_u32 s11, s22, 86016
    buffer_load_dwordx4 v3, s[44:47], s11 offen lds
    s_waitcnt vmcnt(12)
    s_mov_b64 exec, 1
    ds_add_u32 v11, v13 offset:8
    s_mov_b64 exec, -1
    s_add_u32 s13, s68, 180224
    buffer_load_dwordx4 v[136:139], v5, s[52:55], s13 offen
    s_add_u32 s13, s68, 188416
    buffer_load_dwordx4 v[140:143], v5, s[52:55], s13 offen
    s_add_u32 s13, s68, 65536
    buffer_load_dwordx4 v[144:147], v5, s[52:55], s13 offen
    s_add_u32 s13, s68, 73728
    buffer_load_dwordx4 v[148:151], v5, s[52:55], s13 offen
    s_add_u32 s13, s68, 81920
    buffer_load_dwordx4 v[152:155], v5, s[52:55], s13 offen
    s_add_u32 s13, s68, 90112
    buffer_load_dwordx4 v[156:159], v5, s[52:55], s13 offen
    s_waitcnt vmcnt(6)
    s_mov_b64 exec, 1
    ds_add_u32 v11, v13 offset:12
    s_mov_b64 exec, -1
    s_add_u32 s13, s68, 196608
    buffer_load_dwordx4 v[160:163], v5, s[52:55], s13 offen
    s_add_u32 s13, s68, 204800
    buffer_load_dwordx4 v[164:167], v5, s[52:55], s13 offen
    s_add_u32 s13, s68, 212992
    buffer_load_dwordx4 v[168:171], v5, s[52:55], s13 offen
    s_add_u32 s13, s68, 221184
    buffer_load_dwordx4 v[172:175], v5, s[52:55], s13 offen
    s_add_u32 s13, s69, 0
    buffer_load_dwordx4 v[176:179], v5, s[52:55], s13 offen
    s_add_u32 s13, s69, 8192
    buffer_load_dwordx4 v[180:183], v5, s[52:55], s13 offen
    s_add_u32 s13, s69, 16384
    buffer_load_dwordx4 v[184:187], v5, s[52:55], s13 offen
    s_add_u32 s13, s69, 24576
    buffer_load_dwordx4 v[188:191], v5, s[52:55], s13 offen
    s_add_u32 s13, s69, 65536
    buffer_load_dwordx4 v[192:195], v5, s[52:55], s13 offen
    s_add_u32 s13, s69, 73728
    buffer_load_dwordx4 v[196:199], v5, s[52:55], s13 offen
    s_mov_b32 s11, 0
L_lw2_69:
    ds_read_b32 v10, v11 offset:64
    s_waitcnt lgkmcnt(0)
    v_readfirstlane_b32 s12, v10
    s_add_u32 s11, s11, 1
    s_nop 0
    s_cmp_ge_u32 s12, 4
    s_cbranch_scc1 L_lg_68
    s_sleep 1
    s_cmp_lt_u32 s11, 2097152
    s_cbranch_scc1 L_lw2_69
L_lg_68:
    s_add_u32 m0, s18, 0
    s_add_u32 s11, s22, 458752
    buffer_load_dwordx4 v3, s[44:47], s11 offen lds
    s_add_u32 m0, s18, 1024
    s_add_u32 s11, s22, 487424
    buffer_load_dwordx4 v3, s[44:47], s11 offen lds
    s_add_u32 m0, s18, 2048
    s_add_u32 s11, s22, 516096
    buffer_load_dwordx4 v3, s[44:47], s11 offen lds
    s_add_u32 m0, s18, 3072
    s_add_u32 s11, s22, 544768
    buffer_load_dwordx4 v3, s[44:47], s11 offen lds
    s_add_u32 m0, s18, 16384
    s_add_u32 s11, s22, 917504
    buffer_load_dwordx4 v3, s[44:47], s11 offen lds
    s_add_u32 m0, s18, 17408
    s_add_u32 s11, s22, 946176
    buffer_load_dwordx4 v3, s[44:47], s11 offen lds
    s_add_u32 m0, s18, 18432
    s_add_u32 s11, s22, 974848
    buffer_load_dwordx4 v3, s[44:47], s11 offen lds
    s_add_u32 m0, s18, 19456
    s_add_u32 s11, s22, 1003520
    buffer_load_dwordx4 v3, s[44:47], s11 offen lds
    s_add_u32 m0, s18, 32768
    s_add_u32 s11, s22, 1376256
    buffer_load_dwordx4 v3, s[44:47], s11 offen lds
    s_add_u32 m0, s18, 33792
    s_add_u32 s11, s22, 1404928
    buffer_load_dwordx4 v3, s[44:47], s11 offen lds
    s_add_u32 m0, s18, 34816
    s_add_u32 s11, s22, 1433600
    buffer_load_dwordx4 v3, s[44:47], s11 offen lds
    s_add_u32 m0, s18, 35840
    s_add_u32 s11, s22, 1462272
    buffer_load_dwordx4 v3, s[44:47], s11 offen lds
    s_waitcnt vmcnt(4)
    s_mov_b64 exec, 1
    ds_add_u32 v11, v13 offset:32
    s_mov_b64 exec, -1
    s_add_u32 s13, s69, 81920
    buffer_load_dwordx4 v[200:203], v5, s[52:55], s13 offen
    s_add_u32 s13, s69, 90112
    buffer_load_dwordx4 v[204:207], v5, s[52:55], s13 offen
    s_add_u32 s13, s68, 98304
    buffer_load_dwordx4 v[208:211], v5, s[52:55], s13 offen
    s_add_u32 s13, s68, 106496
    buffer_load_dwordx4 v[212:215], v5, s[52:55], s13 offen
    s_waitcnt vmcnt(4)
    s_mov_b64 exec, 1
    ds_add_u32 v11, v13 offset:36
    s_mov_b64 exec, -1
    s_add_u32 s13, s68, 114688
    buffer_load_dwordx4 v[216:219], v5, s[52:55], s13 offen
    s_add_u32 s13, s68, 122880
    buffer_load_dwordx4 v[220:223], v5, s[52:55], s13 offen
    s_add_u32 s13, s68, 229376
    buffer_load_dwordx4 v[224:227], v5, s[52:55], s13 offen
    s_add_u32 s13, s68, 237568
    buffer_load_dwordx4 v[228:231], v5, s[52:55], s13 offen
    s_mov_b32 s11, 0
L_lw2_71:
    ds_read_b32 v10, v11 offset:96
    s_waitcnt lgkmcnt(0)
    v_readfirstlane_b32 s12, v10
    s_add_u32 s11, s11, 1
    s_nop 0
    s_cmp_ge_u32 s12, 4
    s_cbranch_scc1 L_lg_70
    s_sleep 1
    s_cmp_lt_u32 s11, 2097152
    s_cbranch_scc1 L_lw2_71
L_lg_70:
    s_add_u32 m0, s76, 81920
    s_add_u32 s13, s68, 0
    buffer_load_dwordx4 v5, s[52:55], s13 offen lds
    s_add_u32 m0, s76, 82944
    s_add_u32 s13, s68, 8192
    buffer_load_dwordx4 v5, s[52:55], s13 offen lds
    s_add_u32 m0, s76, 90112
    s_add_u32 s13, s68, 16384
    buffer_load_dwordx4 v5, s[52:55], s13 offen lds
    s_add_u32 m0, s76, 91136
    s_add_u32 s13, s68, 24576
    buffer_load_dwordx4 v5, s[52:55], s13 offen lds
    s_add_u32 m0, s76, 98304
    s_add_u32 s13, s68, 131072
    buffer_load_dwordx4 v5, s[52:55], s13 offen lds
    s_add_u32 m0, s76, 99328
    s_add_u32 s13, s68, 139264
    buffer_load_dwordx4 v5, s[52:55], s13 offen lds
    s_add_u32 m0, s76, 106496
    s_add_u32 s13, s68, 147456
    buffer_load_dwordx4 v5, s[52:55], s13 offen lds
    s_add_u32 m0, s76, 107520
    s_add_u32 s13, s68, 155648
    buffer_load_dwordx4 v5, s[52:55], s13 offen lds
    s_add_u32 m0, s76, 149504
    s_add_u32 s13, s68, 32768
    buffer_load_dwordx4 v5, s[52:55], s13 offen lds
    s_add_u32 m0, s76, 150528
    s_add_u32 s13, s68, 40960
    buffer_load_dwordx4 v5, s[52:55], s13 offen lds
    s_add_u32 m0, s76, 114688
    s_add_u32 s13, s68, 49152
    buffer_load_dwordx4 v5, s[52:55], s13 offen lds
    s_add_u32 m0, s76, 115712
    s_add_u32 s13, s68, 57344
    buffer_load_dwordx4 v5, s[52:55], s13 offen lds
    s_add_u32 m0, s76, 122880
    s_add_u32 s13, s68, 163840
    buffer_load_dwordx4 v5, s[52:55], s13 offen lds
    s_add_u32 m0, s76, 123904
    s_add_u32 s13, s68, 172032
    buffer_load_dwordx4 v5, s[52:55], s13 offen lds
L_g2:
    s_nop 4
    s_lshl_b32 s13, s15, 3
    v_lshrrev_b32 v112, 3, v0
    v_add_u32 v112, s13, v112
    v_and_b32 v113, 7, v0
    v_lshlrev_b32 v114, 4, v113
    v_lshl_add_u32 v248, v112, 10, v114
    s_lshl_b32 s16, s8, 16
    s_lshl_b32 s17, s9, 7
    s_add_u32 s16, s16, s17
    buffer_load_dwordx4 v[116:119], v114, s[60:63], s17 offen
    s_add_u32 s13, s16, 0
    buffer_load_dwordx4 v[120:123], v248, s[28:31], s13 offen
    s_add_u32 s13, s16, 32768
    buffer_load_dwordx4 v[124:127], v248, s[28:31], s13 offen
    v_lshlrev_b32 v249, 4, v112
    v_lshrrev_b32 v115, 2, v113
    v_mul_u32_u24 v115, 4352, v115
    v_add_u32 v249, v249, v115
    v_and_b32 v115, 3, v113
    v_mul_u32_u24 v115, 1088, v115
    v_add_u32 v249, v249, v115
    s_mul_i32 s13, s15, 17408
    v_add_u32 v250, s13, v1
    v_and_b32 v251, 15, v0
    v_lshrrev_b32 v251, 2, v251
    v_and_b32 v252, 3, v0
    v_lshlrev_b32 v252, 3, v252
    v_bfe_u32 v253, v0, 4, 1
    v_lshl_add_u32 v252, v253, 5, v252
    v_lshrrev_b32 v253, 5, v0
    v_lshl_add_u32 v252, v253, 9, v252
    v_lshl_add_u32 v252, v251, 7, v252
    v_bfe_u32 v253, v0, 3, 1
    v_lshl_add_u32 v252, v253, 6, v252
    v_add_u32 v252, s76, v252
    v_add_u32 v14, 0, v252
    v_xor_b32 v15, 64, v14
    v_add_u32 v2, 65536, v252
    v_xor_b32 v3, 64, v2
    v_add_u32 v4, 131072, v252
    v_xor_b32 v9, 64, v4
    v_add_u32 v6, s76, v1
    v_add_u32 v6, 81920, v6
    v_and_b32 v251, 31, v0
    s_lshl_b32 s11, s8, 2
    s_add_u32 s11, s11, s15
    s_lshl_b32 s11, s11, 7
    s_add_u32 s11, s11, 15736832
    v_lshlrev_b32 v251, 2, v251
    v_add_u32 v7, s11, v251
    v_and_b32 v251, 7, v0
    s_lshl_b32 s11, s8, 5
    s_lshl_b32 s12, s15, 3
    s_add_u32 s11, s11, s12
    v_add_u32 v251, s11, v251
    v_lshlrev_b32 v251, 2, v251
    v_add_u32 v8, 15732736, v251
    s_mov_b32 s11, 0
L_ep_72:
    buffer_load_dword v10, v12, s[36:39], 0 offen sc1
    s_waitcnt vmcnt(0)
    v_readfirstlane_b32 s10, v10
    s_add_u32 s11, s11, 1
    s_nop 0
    s_cmp_lg_u32 s10, 0
    s_cbranch_scc1 L_epd_73
    s_sleep 2
    s_cmp_lt_u32 s11, 131072
    s_cbranch_scc1 L_ep_72
L_epd_73:
    v_lshlrev_b32 v128, 16, v116
    v_and_b32 v129, 0xffff0000, v116
    v_lshlrev_b32 v130, 16, v117
    v_and_b32 v131, 0xffff0000, v117
    v_lshlrev_b32 v132, 16, v118
    v_and_b32 v133, 0xffff0000, v118
    v_lshlrev_b32 v134, 16, v119
    v_and_b32 v135, 0xffff0000, v119
    v_lshlrev_b32 v232, 16, v120
    v_and_b32 v233, 0xffff0000, v120
    v_lshlrev_b32 v234, 16, v121
    v_and_b32 v235, 0xffff0000, v121
    v_lshlrev_b32 v236, 16, v122
    v_and_b32 v237, 0xffff0000, v122
    v_lshlrev_b32 v238, 16, v123
    v_and_b32 v239, 0xffff0000, v123
    v_add_f32 v232, v232, v128
    v_add_f32 v233, v233, v129
    v_add_f32 v234, v234, v130
    v_add_f32 v235, v235, v131
    v_add_f32 v236, v236, v132
    v_add_f32 v237, v237, v133
    v_add_f32 v238, v238, v134
    v_add_f32 v239, v239, v135
    v_lshlrev_b32 v240, 16, v124
    v_and_b32 v241, 0xffff0000, v124
    v_lshlrev_b32 v242, 16, v125
    v_and_b32 v243, 0xffff0000, v125
    v_lshlrev_b32 v244, 16, v126
    v_and_b32 v245, 0xffff0000, v126
    v_lshlrev_b32 v246, 16, v127
    v_and_b32 v247, 0xffff0000, v127
    v_add_f32 v240, v240, v128
    v_add_f32 v241, v241, v129
    v_add_f32 v242, v242, v130
    v_add_f32 v243, v243, v131
    v_add_f32 v244, v244, v132
    v_add_f32 v245, v245, v133
    v_add_f32 v246, v246, v134
    v_add_f32 v247, v247, v135
    s_mov_b32 s11, 0
L_lw2_75:
    ds_read_b32 v10, v11 offset:128
    s_waitcnt lgkmcnt(0)
    v_readfirstlane_b32 s12, v10
    s_add_u32 s11, s11, 1
    s_nop 0
    s_cmp_ge_u32 s12, 4
    s_cbranch_scc1 L_lg_74
    s_sleep 1
    s_cmp_lt_u32 s11, 2097152
    s_cbranch_scc1 L_lw2_75
L_lg_74:
    buffer_load_dword v10, v7, s[32:35], 0 offen sc1
    v_subrev_u32 v251, 81920, v6
    v_add_u32 v252, 65536, v251
    v_add_u32 v253, 131072, v251
    s_waitcnt vmcnt(0)
    v_cmp_ne_u32 vcc, s10, v10
    s_nop 1
    s_and_b32 s12, vcc_lo, 0x11001100
    s_cmp_eq_u32 s12, 0
    s_cbranch_scc1 L_ok_76
    s_mov_b32 s11, 0
L_pl_77:
    buffer_load_dword v10, v7, s[32:35], 0 offen sc1
    s_waitcnt vmcnt(0)
    v_cmp_ne_u32 vcc, s10, v10
    s_add_u32 s11, s11, 1
    s_nop 0
    s_and_b32 s12, vcc_lo, 0x11001100
    s_cmp_eq_u32 s12, 0
    s_cbranch_scc1 L_pld_78
    s_sleep 4
    s_cmp_lt_u32 s11, 131072
    s_cbranch_scc1 L_pl_77
L_pld_78:
L_ok_76:
    s_add_u32 s14, s72, 0
    buffer_load_dwordx4 v[96:99], v1, s[32:35], s14 offen sc1
    s_add_u32 s14, s72, 147456
    buffer_load_dwordx4 v[100:103], v1, s[32:35], s14 offen sc1
    s_add_u32 s14, s72, 1024
    buffer_load_dwordx4 v[104:107], v1, s[32:35], s14 offen sc1
    s_add_u32 s14, s72, 148480
    buffer_load_dwordx4 v[108:111], v1, s[32:35], s14 offen sc1
    s_add_u32 s14, s72, 8192
    buffer_load_dwordx4 v[112:115], v1, s[32:35], s14 offen sc1
    s_add_u32 s14, s72, 155648
    buffer_load_dwordx4 v[116:119], v1, s[32:35], s14 offen sc1
    s_add_u32 s14, s72, 9216
    buffer_load_dwordx4 v[120:123], v1, s[32:35], s14 offen sc1
    s_add_u32 s14, s72, 156672
    buffer_load_dwordx4 v[124:127], v1, s[32:35], s14 offen sc1
    v_cmp_ne_u32 vcc, s10, v10
    s_nop 1
    s_and_b32 s12, vcc_lo, 0x22002200
    s_cmp_eq_u32 s12, 0
    s_cbranch_scc1 L_ok_79
    s_mov_b32 s11, 0
L_pl_80:
    buffer_load_dword v10, v7, s[32:35], 0 offen sc1
    s_waitcnt vmcnt(0)
    v_cmp_ne_u32 vcc, s10, v10
    s_add_u32 s11, s11, 1
    s_nop 0
    s_and_b32 s12, vcc_lo, 0x22002200
    s_cmp_eq_u32 s12, 0
    s_cbranch_scc1 L_pld_81
    s_sleep 4
    s_cmp_lt_u32 s11, 131072
    s_cbranch_scc1 L_pl_80
L_pld_81:
L_ok_79:
    s_add_u32 s14, s72, 2048
    buffer_load_dwordx4 v[128:131], v1, s[32:35], s14 offen sc1
    s_add_u32 s14, s72, 149504
    buffer_load_dwordx4 v[132:135], v1, s[32:35], s14 offen sc1
    ds_read_b64_tr_b16 v[80:81], v2 offset:16384
    ds_read_b64_tr_b16 v[82:83], v2 offset:17408
    ds_read_b64_tr_b16 v[84:85], v3 offset:16384
    ds_read_b64_tr_b16 v[86:87], v3 offset:17408
    s_waitcnt vmcnt(8) lgkmcnt(0)
    v_mfma_f32_32x32x16_bf16 v[16:31], v[80:83], v[96:99], 0
    ds_read_b64_tr_b16 v[88:89], v2 offset:24576
    ds_read_b64_tr_b16 v[90:91], v2 offset:25600
    ds_read_b64_tr_b16 v[92:93], v3 offset:24576
    ds_read_b64_tr_b16 v[94:95], v3 offset:25600
    v_mfma_f32_32x32x16_bf16 v[32:47], v[84:87], v[96:99], 0
    v_mfma_f32_32x32x16_bf16 v[48:63], v[80:83], v[100:103], 0
    v_mfma_f32_32x32x16_bf16 v[64:79], v[84:87], v[100:103], 0
    s_add_u32 s14, s72, 3072
    buffer_load_dwordx4 v[96:99], v1, s[32:35], s14 offen sc1
    s_add_u32 s14, s72, 150528
    buffer_load_dwordx4 v[100:103], v1, s[32:35], s14 offen sc1
    s_waitcnt vmcnt(8) lgkmcnt(0)
    v_mfma_f32_32x32x16_bf16 v[16:31], v[88:91], v[104:107], v[16:31]
    ds_read_b64_tr_b16 v[80:81], v2 offset:32768
    ds_read_b64_tr_b16 v[82:83], v2 offset:33792
    ds_read_b64_tr_b16 v[84:85], v3 offset:32768
    ds_read_b64_tr_b16 v[86:87], v3 offset:33792
    v_mfma_f32_32x32x16_bf16 v[32:47], v[92:95], v[104:107], v[32:47]
    v_mfma_f32_32x32x16_bf16 v[48:63], v[88:91], v[108:111], v[48:63]
    v_mfma_f32_32x32x16_bf16 v[64:79], v[92:95], v[108:111], v[64:79]
    s_add_u32 s14, s72, 10240
    buffer_load_dwordx4 v[104:107], v1, s[32:35], s14 offen sc1
    s_add_u32 s14, s72, 157696
    buffer_load_dwordx4 v[108:111], v1, s[32:35], s14 offen sc1
    s_waitcnt vmcnt(8) lgkmcnt(0)
    v_mfma_f32_32x32x16_bf16 v[16:31], v[80:83], v[112:115], v[16:31]
    ds_read_b64_tr_b16 v[88:89], v2 offset:40960
    ds_read_b64_tr_b16 v[90:91], v2 offset:41984
    ds_read_b64_tr_b16 v[92:93], v3 offset:40960
    ds_read_b64_tr_b16 v[94:95], v3 offset:41984
    v_mfma_f32_32x32x16_bf16 v[32:47], v[84:87], v[112:115], v[32:47]
    v_mfma_f32_32x32x16_bf16 v[48:63], v[80:83], v[116:119], v[48:63]
    s_add_u32 m0, s76, 0
    s_add_u32 s13, s68, 245760
    buffer_load_dwordx4 v5, s[52:55], s13 offen lds
    s_add_u32 m0, s76, 1024
    s_add_u32 s13, s68, 253952
    buffer_load_dwordx4 v5, s[52:55], s13 offen lds
    v_mfma_f32_32x32x16_bf16 v[64:79], v[84:87], v[116:119], v[64:79]
    s_add_u32 s14, s72, 11264
    buffer_load_dwordx4 v[112:115], v1, s[32:35], s14 offen sc1
    s_add_u32 s14, s72, 158720
    buffer_load_dwordx4 v[116:119], v1, s[32:35], s14 offen sc1
    s_waitcnt vmcnt(10) lgkmcnt(0)
    v_mfma_f32_32x32x16_bf16 v[16:31], v[88:91], v[120:123], v[16:31]
    ds_read_b64_tr_b16 v[80:81], v4 offset:18432
    ds_read_b64_tr_b16 v[82:83], v4 offset:19456
    ds_read_b64_tr_b16 v[84:85], v9 offset:18432
    ds_read_b64_tr_b16 v[86:87], v9 offset:19456
    v_mfma_f32_32x32x16_bf16 v[32:47], v[92:95], v[120:123], v[32:47]
    v_mfma_f32_32x32x16_bf16 v[48:63], v[88:91], v[124:127], v[48:63]
    s_add_u32 m0, s76, 8192
    s_add_u32 s13, s69, 32768
    buffer_load_dwordx4 v5, s[52:55], s13 offen lds
    s_add_u32 m0, s76, 9216
    s_add_u32 s13, s69, 40960
    buffer_load_dwordx4 v5, s[52:55], s13 offen lds
    v_mfma_f32_32x32x16_bf16 v[64:79], v[92:95], v[124:127], v[64:79]
    v_cmp_ne_u32 vcc, s10, v10
    s_nop 1
    s_and_b32 s12, vcc_lo, 0x44114411
    s_cmp_eq_u32 s12, 0
    s_cbranch_scc1 L_ok_82
    s_mov_b32 s11, 0
L_pl_83:
    buffer_load_dword v10, v7, s[32:35], 0 offen sc1
    s_waitcnt vmcnt(0)
    v_cmp_ne_u32 vcc, s10, v10
    s_add_u32 s11, s11, 1
    s_nop 0
    s_and_b32 s12, vcc_lo, 0x44114411
    s_cmp_eq_u32 s12, 0
    s_cbranch_scc1 L_pld_84
    s_sleep 4
    s_cmp_lt_u32 s11, 131072
    s_cbranch_scc1 L_pl_83
L_pld_84:
L_ok_82:
    s_add_u32 s14, s72, 4096
    buffer_load_dwordx4 v[120:123], v1, s[32:35], s14 offen sc1
    s_add_u32 s14, s72, 151552
    buffer_load_dwordx4 v[124:127], v1, s[32:35], s14 offen sc1
    s_waitcnt vmcnt(12) lgkmcnt(0)
    v_mfma_f32_32x32x16_bf16 v[16:31], v[80:83], v[128:131], v[16:31]
    ds_read_b64_tr_b16 v[88:89], v2 offset:49152
    ds_read_b64_tr_b16 v[90:91], v2 offset:50176
    ds_read_b64_tr_b16 v[92:93], v3 offset:49152
    ds_read_b64_tr_b16 v[94:95], v3 offset:50176
    v_mfma_f32_32x32x16_bf16 v[32:47], v[84:87], v[128:131], v[32:47]
    v_mfma_f32_32x32x16_bf16 v[48:63], v[80:83], v[132:135], v[48:63]
    s_add_u32 m0, s76, 16384
    s_add_u32 s13, s69, 49152
    buffer_load_dwordx4 v5, s[52:55], s13 offen lds
    s_add_u32 m0, s76, 17408
    s_add_u32 s13, s69, 57344
    buffer_load_dwordx4 v5, s[52:55], s13 offen lds
    v_mfma_f32_32x32x16_bf16 v[64:79], v[84:87], v[132:135], v[64:79]
    s_add_u32 s14, s72, 5120
    buffer_load_dwordx4 v[128:131], v1, s[32:35], s14 offen sc1
    s_add_u32 s14, s72, 152576
    buffer_load_dwordx4 v[132:135], v1, s[32:35], s14 offen sc1
    s_waitcnt vmcnt(14) lgkmcnt(0)
    v_mfma_f32_32x32x16_bf16 v[16:31], v[88:91], v[96:99], v[16:31]
    ds_write_b128 v6, v[136:139] offset:0
    ds_write_b128 v6, v[140:143] offset:1024
    ds_read_b64_tr_b16 v[80:81], v2 offset:57344
    ds_read_b64_tr_b16 v[82:83], v2 offset:58368
    ds_read_b64_tr_b16 v[84:85], v3 offset:57344
    ds_read_b64_tr_b16 v[86:87], v3 offset:58368
    v_mfma_f32_32x32x16_bf16 v[32:47], v[92:95], v[96:99], v[32:47]
    v_mfma_f32_32x32x16_bf16 v[48:63], v[88:91], v[100:103], v[48:63]
    s_add_u32 m0, s76, 24576
    s_add_u32 s13, s69, 98304
    buffer_load_dwordx4 v5, s[52:55], s13 offen lds
    s_add_u32 m0, s76, 25600
    s_add_u32 s13, s69, 106496
    buffer_load_dwordx4 v5, s[52:55], s13 offen lds
    v_mfma_f32_32x32x16_bf16 v[64:79], v[92:95], v[100:103], v[64:79]
    s_add_u32 s14, s72, 12288
    buffer_load_dwordx4 v[96:99], v1, s[32:35], s14 offen sc1
    s_add_u32 s14, s72, 159744
    buffer_load_dwordx4 v[100:103], v1, s[32:35], s14 offen sc1
    s_waitcnt vmcnt(16) lgkmcnt(0)
    v_mfma_f32_32x32x16_bf16 v[16:31], v[80:83], v[104:107], v[16:31]
    ds_write_b128 v6, v[144:147] offset:8192
    ds_write_b128 v6, v[148:151] offset:9216
    ds_read_b64_tr_b16 v[88:89], v2 offset:16384
    ds_read_b64_tr_b16 v[90:91], v2 offset:17408
    ds_read_b64_tr_b16 v[92:93], v3 offset:16384
    ds_read_b64_tr_b16 v[94:95], v3 offset:17408
    v_mfma_f32_32x32x16_bf16 v[32:47], v[84:87], v[104:107], v[32:47]
    v_mfma_f32_32x32x16_bf16 v[48:63], v[80:83], v[108:111], v[48:63]
    s_add_u32 m0, s76, 32768
    s_add_u32 s13, s69, 114688
    buffer_load_dwordx4 v5, s[52:55], s13 offen lds
    s_add_u32 m0, s76, 33792
    s_add_u32 s13, s69, 122880
    buffer_load_dwordx4 v5, s[52:55], s13 offen lds
    v_mfma_f32_32x32x16_bf16 v[64:79], v[84:87], v[108:111], v[64:79]
    s_add_u32 s14, s72, 13312
    buffer_load_dwordx4 v[136:139], v1, s[32:35], s14 offen sc1
    s_add_u32 s14, s72, 160768
    buffer_load_dwordx4 v[140:143], v1, s[32:35], s14 offen sc1
    s_add_u32 s14, s73, 0
    buffer_load_dwordx4 v[104:107], v1, s[32:35], s14 offen sc1
    s_add_u32 s14, s73, 147456
    buffer_load_dwordx4 v[108:111], v1, s[32:35], s14 offen sc1
    s_waitcnt vmcnt(18) lgkmcnt(0)
    v_mfma_f32_32x32x16_bf16 v[16:31], v[88:91], v[112:115], v[16:31]
    ds_write_b128 v6, v[152:155] offset:16384
    ds_write_b128 v6, v[156:159] offset:17408
    ds_read_b64_tr_b16 v[80:81], v2 offset:24576
    ds_read_b64_tr_b16 v[82:83], v2 offset:25600
    ds_read_b64_tr_b16 v[84:85], v3 offset:24576
    ds_read_b64_tr_b16 v[86:87], v3 offset:25600
    v_mfma_f32_32x32x16_bf16 v[32:47], v[92:95], v[112:115], v[32:47]
    v_mfma_f32_32x32x16_bf16 v[48:63], v[88:91], v[116:119], v[48:63]
    s_add_u32 m0, s76, 40960
    s_add_u32 s13, s70, 0
    buffer_load_dwordx4 v5, s[52:55], s13 offen lds
    s_add_u32 m0, s76, 41984
    s_add_u32 s13, s70, 8192
    buffer_load_dwordx4 v5, s[52:55], s13 offen lds
    v_mfma_f32_32x32x16_bf16 v[64:79], v[92:95], v[116:119], v[64:79]
    s_add_u32 s14, s73, 1024
    buffer_load_dwordx4 v[144:147], v1, s[32:35], s14 offen sc1
    s_add_u32 s14, s73, 148480
    buffer_load_dwordx4 v[148:151], v1, s[32:35], s14 offen sc1
    s_add_u32 s14, s73, 4096
    buffer_load_dwordx4 v[112:115], v1, s[32:35], s14 offen sc1
    s_add_u32 s14, s73, 151552
    buffer_load_dwordx4 v[116:119], v1, s[32:35], s14 offen sc1
    s_waitcnt vmcnt(20) lgkmcnt(0)
    v_mfma_f32_32x32x16_bf16 v[16:31], v[80:83], v[120:123], v[16:31]
    ds_write_b128 v6, v[160:163] offset:24576
    ds_write_b128 v6, v[164:167] offset:25600
    ds_read_b64_tr_b16 v[88:89], v2 offset:32768
    ds_read_b64_tr_b16 v[90:91], v2 offset:33792
    ds_read_b64_tr_b16 v[92:93], v3 offset:32768
    ds_read_b64_tr_b16 v[94:95], v3 offset:33792
    v_mfma_f32_32x32x16_bf16 v[32:47], v[84:87], v[120:123], v[32:47]
    v_mfma_f32_32x32x16_bf16 v[48:63], v[80:83], v[124:127], v[48:63]
    s_add_u32 m0, s76, 49152
    s_add_u32 s13, s70, 16384
    buffer_load_dwordx4 v5, s[52:55], s13 offen lds
    s_add_u32 m0, s76, 50176
    s_add_u32 s13, s70, 24576
    buffer_load_dwordx4 v5, s[52:55], s13 offen lds
    v_mfma_f32_32x32x16_bf16 v[64:79], v[84:87], v[124:127], v[64:79]
    s_add_u32 s14, s73, 5120
    buffer_load_dwordx4 v[152:155], v1, s[32:35], s14 offen sc1
    s_add_u32 s14, s73, 152576
    buffer_load_dwordx4 v[156:159], v1, s[32:35], s14 offen sc1
    v_cmp_ne_u32 vcc, s10, v10
    s_nop 1
    s_and_b32 s12, vcc_lo, 0x88228822
    s_cmp_eq_u32 s12, 0
    s_cbranch_scc1 L_ok_85
    s_mov_b32 s11, 0
L_pl_86:
    buffer_load_dword v10, v7, s[32:35], 0 offen sc1
    s_waitcnt vmcnt(0)
    v_cmp_ne_u32 vcc, s10, v10
    s_add_u32 s11, s11, 1
    s_nop 0
    s_and_b32 s12, vcc_lo, 0x88228822
    s_cmp_eq_u32 s12, 0
    s_cbranch_scc1 L_pld_87
    s_sleep 4
    s_cmp_lt_u32 s11, 131072
    s_cbranch_scc1 L_pl_86
L_pld_87:
L_ok_85:
    s_add_u32 s14, s72, 6144
    buffer_load_dwordx4 v[120:123], v1, s[32:35], s14 offen sc1
    s_add_u32 s14, s72, 153600
    buffer_load_dwordx4 v[124:127], v1, s[32:35], s14 offen sc1
    s_waitcnt vmcnt(22) lgkmcnt(0)
    v_mfma_f32_32x32x16_bf16 v[16:31], v[88:91], v[128:131], v[16:31]
    v_add_u32 v13, 67584, v6
    ds_write_b128 v13, v[168:171] offset:0
    ds_write_b128 v13, v[172:175] offset:1024
    ds_read_b64_tr_b16 v[80:81], v2 offset:40960
    ds_read_b64_tr_b16 v[82:83], v2 offset:41984
    ds_read_b64_tr_b16 v[84:85], v3 offset:40960
    ds_read_b64_tr_b16 v[86:87], v3 offset:41984
    v_mfma_f32_32x32x16_bf16 v[32:47], v[92:95], v[128:131], v[32:47]
    v_mfma_f32_32x32x16_bf16 v[48:63], v[88:91], v[132:135], v[48:63]
    s_add_u32 m0, s76, 57344
    s_add_u32 s13, s70, 32768
    buffer_load_dwordx4 v5, s[52:55], s13 offen lds
    s_add_u32 m0, s76, 58368
    s_add_u32 s13, s70, 40960
    buffer_load_dwordx4 v5, s[52:55], s13 offen lds
    v_mfma_f32_32x32x16_bf16 v[64:79], v[92:95], v[132:135], v[64:79]
    s_add_u32 s14, s72, 7168
    buffer_load_dwordx4 v[160:163], v1, s[32:35], s14 offen sc1
    s_add_u32 s14, s72, 154624
    buffer_load_dwordx4 v[164:167], v1, s[32:35], s14 offen sc1
    s_add_u32 s14, s72, 14336
    buffer_load_dwordx4 v[128:131], v1, s[32:35], s14 offen sc1
    s_add_u32 s14, s72, 161792
    buffer_load_dwordx4 v[132:135], v1, s[32:35], s14 offen sc1
    s_waitcnt vmcnt(24) lgkmcnt(0)
    v_mfma_f32_32x32x16_bf16 v[16:31], v[80:83], v[96:99], v[16:31]
    ds_write_b128 v6, v[176:179] offset:32768
    ds_write_b128 v6, v[180:183] offset:33792
    ds_read_b64_tr_b16 v[88:89], v4 offset:18432
    ds_read_b64_tr_b16 v[90:91], v4 offset:19456
    ds_read_b64_tr_b16 v[92:93], v9 offset:18432
    ds_read_b64_tr_b16 v[94:95], v9 offset:19456
    v_mfma_f32_32x32x16_bf16 v[32:47], v[84:87], v[96:99], v[32:47]
    v_mfma_f32_32x32x16_bf16 v[48:63], v[80:83], v[100:103], v[48:63]
    s_add_u32 m0, s76, 65536
    s_add_u32 s13, s70, 49152
    buffer_load_dwordx4 v5, s[52:55], s13 offen lds
    s_add_u32 m0, s76, 66560
    s_add_u32 s13, s70, 57344
    buffer_load_dwordx4 v5, s[52:55], s13 offen lds
    v_mfma_f32_32x32x16_bf16 v[64:79], v[84:87], v[100:103], v[64:79]
    s_add_u32 s14, s72, 15360
    buffer_load_dwordx4 v[168:171], v1, s[32:35], s14 offen sc1
    s_add_u32 s14, s72, 162816
    buffer_load_dwordx4 v[172:175], v1, s[32:35], s14 offen sc1
    s_add_u32 s14, s73, 2048
    buffer_load_dwordx4 v[96:99], v1, s[32:35], s14 offen sc1
    s_add_u32 s14, s73, 149504
    buffer_load_dwordx4 v[100:103], v1, s[32:35], s14 offen sc1
    s_waitcnt vmcnt(26) lgkmcnt(0)
    v_mfma_f32_32x32x16_bf16 v[16:31], v[88:91], v[136:139], v[16:31]
    ds_write_b128 v6, v[184:187] offset:40960
    ds_write_b128 v6, v[188:191] offset:41984
    ds_read_b64_tr_b16 v[80:81], v2 offset:49152
    ds_read_b64_tr_b16 v[82:83], v2 offset:50176
    ds_read_b64_tr_b16 v[84:85], v3 offset:49152
    ds_read_b64_tr_b16 v[86:87], v3 offset:50176
    v_mfma_f32_32x32x16_bf16 v[32:47], v[92:95], v[136:139], v[32:47]
    v_mfma_f32_32x32x16_bf16 v[48:63], v[88:91], v[140:143], v[48:63]
    s_add_u32 m0, s76, 73728
    s_add_u32 s13, s71, 0
    buffer_load_dwordx4 v5, s[56:59], s13 offen lds
    s_add_u32 m0, s76, 74752
    s_add_u32 s13, s71, 8192
    buffer_load_dwordx4 v5, s[56:59], s13 offen lds
    v_mfma_f32_32x32x16_bf16 v[64:79], v[92:95], v[140:143], v[64:79]
    s_add_u32 s14, s73, 3072
    buffer_load_dwordx4 v[176:179], v1, s[32:35], s14 offen sc1
    s_add_u32 s14, s73, 150528
    buffer_load_dwordx4 v[180:183], v1, s[32:35], s14 offen sc1
    s_add_u32 s14, s73, 6144
    buffer_load_dwordx4 v[136:139], v1, s[32:35], s14 offen sc1
    s_add_u32 s14, s73, 153600
    buffer_load_dwordx4 v[140:143], v1, s[32:35], s14 offen sc1
    s_waitcnt vmcnt(30) lgkmcnt(0)
    v_mfma_f32_32x32x16_bf16 v[16:31], v[80:83], v[104:107], v[16:31]
    ds_write_b128 v6, v[192:195] offset:0
    ds_write_b128 v6, v[196:199] offset:1024
    ds_read_b64_tr_b16 v[88:89], v2 offset:57344
    ds_read_b64_tr_b16 v[90:91], v2 offset:58368
    ds_read_b64_tr_b16 v[92:93], v3 offset:57344
    ds_read_b64_tr_b16 v[94:95], v3 offset:58368
    v_mfma_f32_32x32x16_bf16 v[32:47], v[84:87], v[104:107], v[32:47]
    v_mfma_f32_32x32x16_bf16 v[48:63], v[80:83], v[108:111], v[48:63]
    s_add_u32 m0, s76, 131072
    s_add_u32 s13, s71, 16384
    buffer_load_dwordx4 v5, s[56:59], s13 offen lds
    s_add_u32 m0, s76, 132096
    s_add_u32 s13, s71, 24576
    buffer_load_dwordx4 v5, s[56:59], s13 offen lds
    v_mfma_f32_32x32x16_bf16 v[64:79], v[84:87], v[108:111], v[64:79]
    s_add_u32 s14, s73, 7168
    buffer_load_dwordx4 v[184:187], v1, s[32:35], s14 offen sc1
    s_add_u32 s14, s73, 154624
    buffer_load_dwordx4 v[188:191], v1, s[32:35], s14 offen sc1
    s_waitcnt vmcnt(30) lgkmcnt(0)
    v_mfma_f32_32x32x16_bf16 v[16:31], v[88:91], v[144:147], v[16:31]
    ds_write_b128 v6, v[200:203] offset:8192
    ds_write_b128 v6, v[204:207] offset:9216
    ds_read_b64_tr_b16 v[80:81], v2 offset:16384
    ds_read_b64_tr_b16 v[82:83], v2 offset:17408
    ds_read_b64_tr_b16 v[84:85], v3 offset:16384
    ds_read_b64_tr_b16 v[86:87], v3 offset:17408
    v_mfma_f32_32x32x16_bf16 v[32:47], v[92:95], v[144:147], v[32:47]
    v_mfma_f32_32x32x16_bf16 v[48:63], v[88:91], v[148:151], v[48:63]
    s_add_u32 m0, s76, 139264
    s_add_u32 s13, s71, 32768
    buffer_load_dwordx4 v5, s[56:59], s13 offen lds
    s_add_u32 m0, s76, 140288
    s_add_u32 s13, s71, 40960
    buffer_load_dwordx4 v5, s[56:59], s13 offen lds
    v_mfma_f32_32x32x16_bf16 v[64:79], v[92:95], v[148:151], v[64:79]
    s_waitcnt vmcnt(30) lgkmcnt(0)
    v_mfma_f32_32x32x16_bf16 v[16:31], v[80:83], v[112:115], v[16:31]
    ds_write_b128 v6, v[208:211] offset:16384
    ds_write_b128 v6, v[212:215] offset:17408
    ds_read_b64_tr_b16 v[88:89], v2 offset:24576
    ds_read_b64_tr_b16 v[90:91], v2 offset:25600
    ds_read_b64_tr_b16 v[92:93], v3 offset:24576
    ds_read_b64_tr_b16 v[94:95], v3 offset:25600
    v_mfma_f32_32x32x16_bf16 v[32:47], v[84:87], v[112:115], v[32:47]
    v_mfma_f32_32x32x16_bf16 v[48:63], v[80:83], v[116:119], v[48:63]
    v_mfma_f32_32x32x16_bf16 v[64:79], v[84:87], v[116:119], v[64:79]
    s_waitcnt vmcnt(26) lgkmcnt(0)
    v_mfma_f32_32x32x16_bf16 v[16:31], v[88:91], v[152:155], v[16:31]
    ds_write_b128 v6, v[216:219] offset:24576
    ds_write_b128 v6, v[220:223] offset:25600
    ds_read_b64_tr_b16 v[80:81], v2 offset:32768
    ds_read_b64_tr_b16 v[82:83], v2 offset:33792
    ds_read_b64_tr_b16 v[84:85], v3 offset:32768
    ds_read_b64_tr_b16 v[86:87], v3 offset:33792
    v_mfma_f32_32x32x16_bf16 v[32:47], v[92:95], v[152:155], v[32:47]
    v_mfma_f32_32x32x16_bf16 v[48:63], v[88:91], v[156:159], v[48:63]
    v_mfma_f32_32x32x16_bf16 v[64:79], v[92:95], v[156:159], v[64:79]
    s_waitcnt vmcnt(24) lgkmcnt(0)
    v_mfma_f32_32x32x16_bf16 v[16:31], v[80:83], v[120:123], v[16:31]
    v_add_u32 v13, 67584, v6
    ds_write_b128 v13, v[224:227] offset:0
    ds_write_b128 v13, v[228:231] offset:1024
    ds_read_b64_tr_b16 v[88:89], v2 offset:40960
    ds_read_b64_tr_b16 v[90:91], v2 offset:41984
    ds_read_b64_tr_b16 v[92:93], v3 offset:40960
    ds_read_b64_tr_b16 v[94:95], v3 offset:41984
    v_mfma_f32_32x32x16_bf16 v[32:47], v[84:87], v[120:123], v[32:47]
    v_mfma_f32_32x32x16_bf16 v[48:63], v[80:83], v[124:127], v[48:63]
    v_mfma_f32_32x32x16_bf16 v[64:79], v[84:87], v[124:127], v[64:79]
    buffer_load_dword v10, v7, s[32:35], 0 offen sc1
    s_waitcnt vmcnt(21) lgkmcnt(0)
    v_mfma_f32_32x32x16_bf16 v[16:31], v[88:91], v[160:163], v[16:31]
    ds_read_b64_tr_b16 v[80:81], v4 offset:18432
    ds_read_b64_tr_b16 v[82:83], v4 offset:19456
    ds_read_b64_tr_b16 v[84:85], v9 offset:18432
    ds_read_b64_tr_b16 v[86:87], v9 offset:19456
    v_mfma_f32_32x32x16_bf16 v[32:47], v[92:95], v[160:163], v[32:47]
    v_mfma_f32_32x32x16_bf16 v[48:63], v[88:91], v[164:167], v[48:63]
    v_mfma_f32_32x32x16_bf16 v[64:79], v[92:95], v[164:167], v[64:79]
    s_waitcnt vmcnt(19) lgkmcnt(0)
    v_mfma_f32_32x32x16_bf16 v[16:31], v[80:83], v[128:131], v[16:31]
    ds_read_b64_tr_b16 v[88:89], v14 offset:0
    ds_read_b64_tr_b16 v[90:91], v14 offset:1024
    ds_read_b64_tr_b16 v[92:93], v15 offset:0
    ds_read_b64_tr_b16 v[94:95], v15 offset:1024
    v_mfma_f32_32x32x16_bf16 v[32:47], v[84:87], v[128:131], v[32:47]
    v_mfma_f32_32x32x16_bf16 v[48:63], v[80:83], v[132:135], v[48:63]
    v_mfma_f32_32x32x16_bf16 v[64:79], v[84:87], v[132:135], v[64:79]
    s_waitcnt vmcnt(0)
    v_cmp_ne_u32 vcc, s10, v10
    s_nop 1
    s_and_b32 s12, vcc_lo, 0x440044
    s_cmp_eq_u32 s12, 0
    s_cbranch_scc1 L_ok_88
    s_mov_b32 s11, 0
L_pl_89:
    buffer_load_dword v10, v7, s[32:35], 0 offen sc1
    s_waitcnt vmcnt(0)
    v_cmp_ne_u32 vcc, s10, v10
    s_add_u32 s11, s11, 1
    s_nop 0
    s_and_b32 s12, vcc_lo, 0x440044
    s_cmp_eq_u32 s12, 0
    s_cbranch_scc1 L_pld_90
    s_sleep 4
    s_cmp_lt_u32 s11, 131072
    s_cbranch_scc1 L_pl_89
L_pld_90:
L_ok_88:
    s_add_u32 s14, s74, 0
    buffer_load_dwordx4 v[104:107], v1, s[32:35], s14 offen sc1
    s_add_u32 s14, s74, 147456
    buffer_load_dwordx4 v[108:111], v1, s[32:35], s14 offen sc1
    s_add_u32 s14, s74, 1024
    buffer_load_dwordx4 v[192:195], v1, s[32:35], s14 offen sc1
    s_add_u32 s14, s74, 148480
    buffer_load_dwordx4 v[196:199], v1, s[32:35], s14 offen sc1
    s_add_u32 s14, s74, 2048
    buffer_load_dwordx4 v[144:147], v1, s[32:35], s14 offen sc1
    s_add_u32 s14, s74, 149504
    buffer_load_dwordx4 v[148:151], v1, s[32:35], s14 offen sc1
    s_add_u32 s14, s74, 3072
    buffer_load_dwordx4 v[200:203], v1, s[32:35], s14 offen sc1
    s_add_u32 s14, s74, 150528
    buffer_load_dwordx4 v[204:207], v1, s[32:35], s14 offen sc1
    s_waitcnt lgkmcnt(0)
    v_mfma_f32_32x32x16_bf16 v[16:31], v[88:91], v[168:171], v[16:31]
    ds_read_b64_tr_b16 v[80:81], v14 offset:8192
    ds_read_b64_tr_b16 v[82:83], v14 offset:9216
    ds_read_b64_tr_b16 v[84:85], v15 offset:8192
    ds_read_b64_tr_b16 v[86:87], v15 offset:9216
    v_mfma_f32_32x32x16_bf16 v[32:47], v[92:95], v[168:171], v[32:47]
    v_mfma_f32_32x32x16_bf16 v[48:63], v[88:91], v[172:175], v[48:63]
    v_mfma_f32_32x32x16_bf16 v[64:79], v[92:95], v[172:175], v[64:79]
    s_waitcnt lgkmcnt(0)
    v_mfma_f32_32x32x16_bf16 v[16:31], v[80:83], v[96:99], v[16:31]
    ds_read_b64_tr_b16 v[88:89], v14 offset:16384
    ds_read_b64_tr_b16 v[90:91], v14 offset:17408
    ds_read_b64_tr_b16 v[92:93], v15 offset:16384
    ds_read_b64_tr_b16 v[94:95], v15 offset:17408
    v_mfma_f32_32x32x16_bf16 v[32:47], v[84:87], v[96:99], v[32:47]
    v_mfma_f32_32x32x16_bf16 v[48:63], v[80:83], v[100:103], v[48:63]
    v_mfma_f32_32x32x16_bf16 v[64:79], v[84:87], v[100:103], v[64:79]
    s_waitcnt lgkmcnt(0)
    v_mfma_f32_32x32x16_bf16 v[16:31], v[88:91], v[176:179], v[16:31]
    ds_read_b64_tr_b16 v[80:81], v14 offset:24576
    ds_read_b64_tr_b16 v[82:83], v14 offset:25600
    ds_read_b64_tr_b16 v[84:85], v15 offset:24576
    ds_read_b64_tr_b16 v[86:87], v15 offset:25600
    v_mfma_f32_32x32x16_bf16 v[32:47], v[92:95], v[176:179], v[32:47]
    s_add_u32 m0, s76, 106496
    s_add_u32 s13, s71, 49152
    buffer_load_dwordx4 v5, s[56:59], s13 offen lds
    s_add_u32 m0, s76, 107520
    s_add_u32 s13, s71, 57344
    buffer_load_dwordx4 v5, s[56:59], s13 offen lds
    v_mfma_f32_32x32x16_bf16 v[48:63], v[88:91], v[180:183], v[48:63]
    v_mfma_f32_32x32x16_bf16 v[64:79], v[92:95], v[180:183], v[64:79]
    s_waitcnt lgkmcnt(0)
    v_mfma_f32_32x32x16_bf16 v[16:31], v[80:83], v[136:139], v[16:31]
    ds_read_b64_tr_b16 v[88:89], v14 offset:32768
    ds_read_b64_tr_b16 v[90:91], v14 offset:33792
    ds_read_b64_tr_b16 v[92:93], v15 offset:32768
    ds_read_b64_tr_b16 v[94:95], v15 offset:33792
    v_mfma_f32_32x32x16_bf16 v[32:47], v[84:87], v[136:139], v[32:47]
    s_add_u32 m0, s76, 149504
    s_add_u32 s13, s71, 65536
    buffer_load_dwordx4 v5, s[56:59], s13 offen lds
    s_add_u32 m0, s76, 150528
    s_add_u32 s13, s71, 73728
    buffer_load_dwordx4 v5, s[56:59], s13 offen lds
    v_mfma_f32_32x32x16_bf16 v[48:63], v[80:83], v[140:143], v[48:63]
    v_mfma_f32_32x32x16_bf16 v[64:79], v[84:87], v[140:143], v[64:79]
    s_waitcnt lgkmcnt(0)
    v_mfma_f32_32x32x16_bf16 v[16:31], v[88:91], v[184:187], v[16:31]
    ds_read_b64_tr_b16 v[80:81], v14 offset:40960
    ds_read_b64_tr_b16 v[82:83], v14 offset:41984
    ds_read_b64_tr_b16 v[84:85], v15 offset:40960
    ds_read_b64_tr_b16 v[86:87], v15 offset:41984
    v_mfma_f32_32x32x16_bf16 v[32:47], v[92:95], v[184:187], v[32:47]
    s_add_u32 m0, s76, 114688
    s_add_u32 s13, s71, 81920
    buffer_load_dwordx4 v5, s[56:59], s13 offen lds
    s_add_u32 m0, s76, 115712
    s_add_u32 s13, s71, 90112
    buffer_load_dwordx4 v5, s[56:59], s13 offen lds
    v_mfma_f32_32x32x16_bf16 v[48:63], v[88:91], v[188:191], v[48:63]
    v_mfma_f32_32x32x16_bf16 v[64:79], v[92:95], v[188:191], v[64:79]
    s_waitcnt vmcnt(12) lgkmcnt(0)
    v_mfma_f32_32x32x16_bf16 v[16:31], v[80:83], v[104:107], v[16:31]
    ds_read_b64_tr_b16 v[88:89], v14 offset:49152
    ds_read_b64_tr_b16 v[90:91], v14 offset:50176
    ds_read_b64_tr_b16 v[92:93], v15 offset:49152
    ds_read_b64_tr_b16 v[94:95], v15 offset:50176
    v_mfma_f32_32x32x16_bf16 v[32:47], v[84:87], v[104:107], v[32:47]
    s_add_u32 m0, s76, 122880
    s_add_u32 s13, s71, 98304
    buffer_load_dwordx4 v5, s[56:59], s13 offen lds
    s_add_u32 m0, s76, 123904
    s_add_u32 s13, s71, 106496
    buffer_load_dwordx4 v5, s[56:59], s13 offen lds
    v_mfma_f32_32x32x16_bf16 v[48:63], v[80:83], v[108:111], v[48:63]
    v_mfma_f32_32x32x16_bf16 v[64:79], v[84:87], v[108:111], v[64:79]
    s_waitcnt vmcnt(12) lgkmcnt(0)
    v_mfma_f32_32x32x16_bf16 v[16:31], v[88:91], v[192:195], v[16:31]
    ds_read_b64_tr_b16 v[80:81], v14 offset:57344
    ds_read_b64_tr_b16 v[82:83], v14 offset:58368
    ds_read_b64_tr_b16 v[84:85], v15 offset:57344
    ds_read_b64_tr_b16 v[86:87], v15 offset:58368
    v_mfma_f32_32x32x16_bf16 v[32:47], v[92:95], v[192:195], v[32:47]
    s_add_u32 m0, s76, 81920
    s_add_u32 s13, s71, 114688
    buffer_load_dwordx4 v5, s[56:59], s13 offen lds
    s_add_u32 m0, s76, 82944
    s_add_u32 s13, s71, 122880
    buffer_load_dwordx4 v5, s[56:59], s13 offen lds
    v_mfma_f32_32x32x16_bf16 v[48:63], v[88:91], v[196:199], v[48:63]
    v_mfma_f32_32x32x16_bf16 v[64:79], v[92:95], v[196:199], v[64:79]
    s_waitcnt vmcnt(12) lgkmcnt(0)
    v_mfma_f32_32x32x16_bf16 v[16:31], v[80:83], v[144:147], v[16:31]
    ds_read_b64_tr_b16 v[88:89], v2 offset:0
    ds_read_b64_tr_b16 v[90:91], v2 offset:1024
    ds_read_b64_tr_b16 v[92:93], v3 offset:0
    ds_read_b64_tr_b16 v[94:95], v3 offset:1024
    v_mfma_f32_32x32x16_bf16 v[32:47], v[84:87], v[144:147], v[32:47]
    v_mfma_f32_32x32x16_bf16 v[48:63], v[80:83], v[148:151], v[48:63]
    v_mfma_f32_32x32x16_bf16 v[64:79], v[84:87], v[148:151], v[64:79]
    s_waitcnt vmcnt(10) lgkmcnt(0)
    v_mfma_f32_32x32x16_bf16 v[16:31], v[88:91], v[200:203], v[16:31]
    ds_read_b64_tr_b16 v[80:81], v2 offset:8192
    ds_read_b64_tr_b16 v[82:83], v2 offset:9216
    ds_read_b64_tr_b16 v[84:85], v3 offset:8192
    ds_read_b64_tr_b16 v[86:87], v3 offset:9216
    v_mfma_f32_32x32x16_bf16 v[32:47], v[92:95], v[200:203], v[32:47]
    v_mfma_f32_32x32x16_bf16 v[48:63], v[88:91], v[204:207], v[48:63]
    v_mfma_f32_32x32x16_bf16 v[64:79], v[92:95], v[204:207], v[64:79]
    s_mov_b32 s11, 0
L_lw2_92:
    ds_read_b32 v10, v11 offset:176
    s_waitcnt lgkmcnt(0)
    v_readfirstlane_b32 s12, v10
    s_add_u32 s11, s11, 1
    s_nop 0
    s_cmp_ge_u32 s12, 4
    s_cbranch_scc1 L_lg_91
    s_sleep 1
    s_cmp_lt_u32 s11, 2097152
    s_cbranch_scc1 L_lw2_92
L_lg_91:
    buffer_load_dword v10, v8, s[32:35], 0 offen sc1
    s_waitcnt vmcnt(0)
    v_cmp_ne_u32 vcc, s10, v10
    s_nop 1
    s_and_b32 s12, vcc_lo, 0xff
    s_cmp_eq_u32 s12, 0
    s_cbranch_scc1 L_ok_93
    s_mov_b32 s11, 0
L_pl_94:
    buffer_load_dword v10, v8, s[32:35], 0 offen sc1
    s_waitcnt vmcnt(0)
    v_cmp_ne_u32 vcc, s10, v10
    s_add_u32 s11, s11, 1
    s_nop 0
    s_and_b32 s12, vcc_lo, 0xff
    s_cmp_eq_u32 s12, 0
    s_cbranch_scc1 L_pld_95
    s_sleep 4
    s_cmp_lt_u32 s11, 131072
    s_cbranch_scc1 L_pl_94
L_pld_95:
L_ok_93:
    s_add_u32 s14, s75, 0
    buffer_load_dwordx4 v[112:115], v1, s[32:35], s14 offen sc1
    s_add_u32 s14, s75, 147456
    buffer_load_dwordx4 v[116:119], v1, s[32:35], s14 offen sc1
    s_add_u32 s14, s75, 1024
    buffer_load_dwordx4 v[208:211], v1, s[32:35], s14 offen sc1
    s_add_u32 s14, s75, 148480
    buffer_load_dwordx4 v[212:215], v1, s[32:35], s14 offen sc1
    s_add_u32 s14, s75, 2048
    buffer_load_dwordx4 v[152:155], v1, s[32:35], s14 offen sc1
    s_add_u32 s14, s75, 149504
    buffer_load_dwordx4 v[156:159], v1, s[32:35], s14 offen sc1
    s_add_u32 s14, s75, 3072
    buffer_load_dwordx4 v[216:219], v1, s[32:35], s14 offen sc1
    s_add_u32 s14, s75, 150528
    buffer_load_dwordx4 v[220:223], v1, s[32:35], s14 offen sc1
    s_add_u32 s14, s75, 4096
    buffer_load_dwordx4 v[120:123], v1, s[32:35], s14 offen sc1
    s_add_u32 s14, s75, 151552
    buffer_load_dwordx4 v[124:127], v1, s[32:35], s14 offen sc1
    s_add_u32 s14, s75, 5120
    buffer_load_dwordx4 v[224:227], v1, s[32:35], s14 offen sc1
    s_add_u32 s14, s75, 152576
    buffer_load_dwordx4 v[228:231], v1, s[32:35], s14 offen sc1
    s_add_u32 s14, s75, 6144
    buffer_load_dwordx4 v[160:163], v1, s[32:35], s14 offen sc1
    s_add_u32 s14, s75, 153600
    buffer_load_dwordx4 v[164:167], v1, s[32:35], s14 offen sc1
    s_add_u32 s14, s75, 7168
    buffer_load_dwordx4 v[128:131], v1, s[32:35], s14 offen sc1
    s_add_u32 s14, s75, 154624
    buffer_load_dwordx4 v[132:135], v1, s[32:35], s14 offen sc1
    s_waitcnt vmcnt(14)
    v_mfma_f32_32x32x16_bf16 v[16:31], v[80:83], v[112:115], v[16:31]
    ds_read_b64_tr_b16 v[88:89], v4 offset:0
    ds_read_b64_tr_b16 v[90:91], v4 offset:1024
    ds_read_b64_tr_b16 v[92:93], v9 offset:0
    ds_read_b64_tr_b16 v[94:95], v9 offset:1024
    v_mfma_f32_32x32x16_bf16 v[32:47], v[84:87], v[112:115], v[32:47]
    v_mfma_f32_32x32x16_bf16 v[48:63], v[80:83], v[116:119], v[48:63]
    v_mfma_f32_32x32x16_bf16 v[64:79], v[84:87], v[116:119], v[64:79]
    s_waitcnt vmcnt(12) lgkmcnt(0)
    v_mfma_f32_32x32x16_bf16 v[16:31], v[88:91], v[208:211], v[16:31]
    ds_read_b64_tr_b16 v[80:81], v4 offset:8192
    ds_read_b64_tr_b16 v[82:83], v4 offset:9216
    ds_read_b64_tr_b16 v[84:85], v9 offset:8192
    ds_read_b64_tr_b16 v[86:87], v9 offset:9216
    v_mfma_f32_32x32x16_bf16 v[32:47], v[92:95], v[208:211], v[32:47]
    v_mfma_f32_32x32x16_bf16 v[48:63], v[88:91], v[212:215], v[48:63]
    v_mfma_f32_32x32x16_bf16 v[64:79], v[92:95], v[212:215], v[64:79]
    s_waitcnt vmcnt(10) lgkmcnt(0)
    v_mfma_f32_32x32x16_bf16 v[16:31], v[80:83], v[152:155], v[16:31]
    ds_read_b64_tr_b16 v[88:89], v2 offset:40960
    ds_read_b64_tr_b16 v[90:91], v2 offset:41984
    ds_read_b64_tr_b16 v[92:93], v3 offset:40960
    ds_read_b64_tr_b16 v[94:95], v3 offset:41984
    v_mfma_f32_32x32x16_bf16 v[32:47], v[84:87], v[152:155], v[32:47]
    v_mfma_f32_32x32x16_bf16 v[48:63], v[80:83], v[156:159], v[48:63]
    v_mfma_f32_32x32x16_bf16 v[64:79], v[84:87], v[156:159], v[64:79]
    s_waitcnt vmcnt(8) lgkmcnt(0)
    v_mfma_f32_32x32x16_bf16 v[16:31], v[88:91], v[216:219], v[16:31]
    ds_read_b64_tr_b16 v[80:81], v4 offset:18432
    ds_read_b64_tr_b16 v[82:83], v4 offset:19456
    ds_read_b64_tr_b16 v[84:85], v9 offset:18432
    ds_read_b64_tr_b16 v[86:87], v9 offset:19456
    v_mfma_f32_32x32x16_bf16 v[32:47], v[92:95], v[216:219], v[32:47]
    v_mfma_f32_32x32x16_bf16 v[48:63], v[88:91], v[220:223], v[48:63]
    v_mfma_f32_32x32x16_bf16 v[64:79], v[92:95], v[220:223], v[64:79]
    s_waitcnt vmcnt(6) lgkmcnt(0)
    v_mfma_f32_32x32x16_bf16 v[16:31], v[80:83], v[120:123], v[16:31]
    ds_read_b64_tr_b16 v[88:89], v2 offset:49152
    ds_read_b64_tr_b16 v[90:91], v2 offset:50176
    ds_read_b64_tr_b16 v[92:93], v3 offset:49152
    ds_read_b64_tr_b16 v[94:95], v3 offset:50176
    v_mfma_f32_32x32x16_bf16 v[32:47], v[84:87], v[120:123], v[32:47]
    v_mfma_f32_32x32x16_bf16 v[48:63], v[80:83], v[124:127], v[48:63]
    v_mfma_f32_32x32x16_bf16 v[64:79], v[84:87], v[124:127], v[64:79]
    s_waitcnt vmcnt(4) lgkmcnt(0)
    v_mfma_f32_32x32x16_bf16 v[16:31], v[88:91], v[224:227], v[16:31]
    ds_read_b64_tr_b16 v[80:81], v2 offset:57344
    ds_read_b64_tr_b16 v[82:83], v2 offset:58368
    ds_read_b64_tr_b16 v[84:85], v3 offset:57344
    ds_read_b64_tr_b16 v[86:87], v3 offset:58368
    v_mfma_f32_32x32x16_bf16 v[32:47], v[92:95], v[224:227], v[32:47]
    v_mfma_f32_32x32x16_bf16 v[48:63], v[88:91], v[228:231], v[48:63]
    v_mfma_f32_32x32x16_bf16 v[64:79], v[92:95], v[228:231], v[64:79]
    s_waitcnt vmcnt(2) lgkmcnt(0)
    v_mfma_f32_32x32x16_bf16 v[16:31], v[80:83], v[160:163], v[16:31]
    ds_read_b64_tr_b16 v[88:89], v2 offset:16384
    ds_read_b64_tr_b16 v[90:91], v2 offset:17408
    ds_read_b64_tr_b16 v[92:93], v3 offset:16384
    ds_read_b64_tr_b16 v[94:95], v3 offset:17408
    v_mfma_f32_32x32x16_bf16 v[32:47], v[84:87], v[160:163], v[32:47]
    v_mfma_f32_32x32x16_bf16 v[48:63], v[80:83], v[164:167], v[48:63]
    v_mfma_f32_32x32x16_bf16 v[64:79], v[84:87], v[164:167], v[64:79]
    s_waitcnt vmcnt(0) lgkmcnt(0)
    v_mfma_f32_32x32x16_bf16 v[16:31], v[88:91], v[128:131], v[16:31]
    v_mfma_f32_32x32x16_bf16 v[32:47], v[92:95], v[128:131], v[32:47]
    v_mfma_f32_32x32x16_bf16 v[48:63], v[88:91], v[132:135], v[48:63]
    v_mfma_f32_32x32x16_bf16 v[64:79], v[92:95], v[132:135], v[64:79]
    s_barrier
    s_nop 7
    ds_write_b128 v250, v[16:19] offset:0
    ds_write_b128 v250, v[20:23] offset:1088
    ds_write_b128 v250, v[24:27] offset:2176
    ds_write_b128 v250, v[28:31] offset:3264
    ds_write_b128 v250, v[32:35] offset:4352
    ds_write_b128 v250, v[36:39] offset:5440
    ds_write_b128 v250, v[40:43] offset:6528
    ds_write_b128 v250, v[44:47] offset:7616
    ds_write_b128 v250, v[48:51] offset:8704
    ds_write_b128 v250, v[52:55] offset:9792
    ds_write_b128 v250, v[56:59] offset:10880
    ds_write_b128 v250, v[60:63] offset:11968
    ds_write_b128 v250, v[64:67] offset:13056
    ds_write_b128 v250, v[68:71] offset:14144
    ds_write_b128 v250, v[72:75] offset:15232
    ds_write_b128 v250, v[76:79] offset:16320
    s_waitcnt lgkmcnt(0)
    s_barrier
    ds_read_b128 v[96:99], v249 offset:0
    ds_read_b128 v[100:103], v249 offset:512
    ds_read_b128 v[104:107], v249 offset:17408
    ds_read_b128 v[108:111], v249 offset:17920
    ds_read_b128 v[112:115], v249 offset:34816
    ds_read_b128 v[116:119], v249 offset:35328
    ds_read_b128 v[120:123], v249 offset:52224
    ds_read_b128 v[124:127], v249 offset:52736
    ds_read_b128 v[128:131], v249 offset:8704
    ds_read_b128 v[132:135], v249 offset:9216
    ds_read_b128 v[136:139], v249 offset:26112
    ds_read_b128 v[140:143], v249 offset:26624
    ds_read_b128 v[144:147], v249 offset:43520
    ds_read_b128 v[148:151], v249 offset:44032
    ds_read_b128 v[152:155], v249 offset:60928
    ds_read_b128 v[156:159], v249 offset:61440
    s_waitcnt lgkmcnt(8)
    v_add_f32 v96, v96, v104
    v_add_f32 v112, v112, v120
    v_add_f32 v97, v97, v105
    v_add_f32 v113, v113, v121
    v_add_f32 v98, v98, v106
    v_add_f32 v114, v114, v122
    v_add_f32 v99, v99, v107
    v_add_f32 v115, v115, v123
    v_add_f32 v100, v100, v108
    v_add_f32 v116, v116, v124
    v_add_f32 v101, v101, v109
    v_add_f32 v117, v117, v125
    v_add_f32 v102, v102, v110
    v_add_f32 v118, v118, v126
    v_add_f32 v103, v103, v111
    v_add_f32 v119, v119, v127
    v_add_f32 v96, v96, v232
    v_add_f32 v97, v97, v233
    v_add_f32 v98, v98, v234
    v_add_f32 v99, v99, v235
    v_add_f32 v100, v100, v236
    v_add_f32 v101, v101, v237
    v_add_f32 v102, v102, v238
    v_add_f32 v103, v103, v239
    v_add_f32 v96, v96, v112
    v_add_f32 v97, v97, v113
    v_add_f32 v98, v98, v114
    v_add_f32 v99, v99, v115
    v_add_f32 v100, v100, v116
    v_add_f32 v101, v101, v117
    v_add_f32 v102, v102, v118
    v_add_f32 v103, v103, v119
    v_cvt_pk_bf16_f32 v104, v96, v97
    v_cvt_pk_bf16_f32 v105, v98, v99
    v_cvt_pk_bf16_f32 v106, v100, v101
    v_cvt_pk_bf16_f32 v107, v102, v103
    s_add_u32 s11, s16, 0
    buffer_store_dwordx4 v[104:107], v248, s[64:67], s11 offen
    s_waitcnt lgkmcnt(0)
    v_add_f32 v128, v128, v136
    v_add_f32 v144, v144, v152
    v_add_f32 v129, v129, v137
    v_add_f32 v145, v145, v153
    v_add_f32 v130, v130, v138
    v_add_f32 v146, v146, v154
    v_add_f32 v131, v131, v139
    v_add_f32 v147, v147, v155
    v_add_f32 v132, v132, v140
    v_add_f32 v148, v148, v156
    v_add_f32 v133, v133, v141
    v_add_f32 v149, v149, v157
    v_add_f32 v134, v134, v142
    v_add_f32 v150, v150, v158
    v_add_f32 v135, v135, v143
    v_add_f32 v151, v151, v159
    v_add_f32 v128, v128, v240
    v_add_f32 v129, v129, v241
    v_add_f32 v130, v130, v242
    v_add_f32 v131, v131, v243
    v_add_f32 v132, v132, v244
    v_add_f32 v133, v133, v245
    v_add_f32 v134, v134, v246
    v_add_f32 v135, v135, v247
    v_add_f32 v128, v128, v144
    v_add_f32 v129, v129, v145
    v_add_f32 v130, v130, v146
    v_add_f32 v131, v131, v147
    v_add_f32 v132, v132, v148
    v_add_f32 v133, v133, v149
    v_add_f32 v134, v134, v150
    v_add_f32 v135, v135, v151
    v_cvt_pk_bf16_f32 v136, v128, v129
    v_cvt_pk_bf16_f32 v137, v130, v131
    v_cvt_pk_bf16_f32 v138, v132, v133
    v_cvt_pk_bf16_f32 v139, v134, v135
    s_add_u32 s11, s16, 32768
    buffer_store_dwordx4 v[136:139], v248, s[64:67], s11 offen
    s_endpgm
L_end:
    s_endpgm
L_code_end:
.section .rodata,"a"
.p2align 6
.amdhsa_kernel parallel_sum__sliding_block__dense_activation_gelu__prompt_kernel
  .amdhsa_next_free_vgpr 256
  .amdhsa_next_free_sgpr 102
  .amdhsa_accum_offset 256
  .amdhsa_group_segment_fixed_size 0
  .amdhsa_kernarg_size 88
  .amdhsa_user_sgpr_count 2
  .amdhsa_user_sgpr_kernarg_segment_ptr 1
  .amdhsa_system_sgpr_workgroup_id_x 1
.end_amdhsa_kernel
```
